```python
import torch

def _softmax(x, axis=-1):
    return torch.softmax(x, dim=axis)
def _gelu(x):
    return torch.nn.functional.gelu(x, approximate="tanh")
def _silu(x):
    return torch.nn.functional.silu(x)
def _sigmoid(x):
    return torch.sigmoid(x)
def _layernorm(x, axis=-1, eps=1e-5):
    m = x.mean(dim=axis, keepdim=True)
    v = x.var(dim=axis, keepdim=True, unbiased=False)
    return (x - m) / torch.sqrt(v + eps)
def _scatter_add(tgt, idx, src, axis=0):
    return tgt.clone().index_add_(axis, idx, src)
def _segment_sum(src, seg, n):
    out = torch.zeros((n,) + src.shape[1:], dtype=src.dtype)
    return out.index_add_(0, seg, src)
def _pad(x, pw):
    flat = tuple(v for pair in reversed(pw) for v in pair)
    return torch.nn.functional.pad(x, flat)

kernel_name = 'interleave_layers__linear_kernel_hedgehog__ssm_conv_h3__prompt'

def setup_inputs():

    _w = (lambda a: (lambda t: t.to(torch.bfloat16) if t.is_floating_point() else t)(torch.as_tensor(a)))
    def _A_setup():
        B, S, D, H = 1, 2048, 576, 32
        Dh = D // H
        return {
            "x": _w((lambda *s: torch.randn(*s, dtype=torch.bfloat16) * 0.05)(B, S, D)),
            "wqkv": _w((lambda *s: torch.randn(*s, dtype=torch.bfloat16) * 0.4)(D, 3 * D)),
            "w_phi": _w((lambda *s: torch.randn(*s, dtype=torch.bfloat16) * 0.4)(H, Dh, Dh) * (Dh ** -0.5)),
            "wo": _w((lambda *s: torch.randn(*s, dtype=torch.bfloat16) * 0.05)(D, D)),
        }
    _A_in = _A_setup()

    def _B_setup():
        B, S, D = 1, 2048, 576
        ks = 4
        return {
            "q": _w((lambda *s: torch.randn(*s, dtype=torch.bfloat16) * 0.05)(B, S, D)),
            "k": _w((lambda *s: torch.randn(*s, dtype=torch.bfloat16) * 0.8)(B, S, D)),
            "v": _w((lambda *s: torch.randn(*s, dtype=torch.bfloat16) * 0.8)(B, S, D)),
            "shift_k": _w((lambda *s: torch.randn(*s, dtype=torch.bfloat16) * 0.8)(D, ks) * 0.5),
            "ssm_k": _w((lambda *s: torch.randn(*s, dtype=torch.bfloat16) * 1.6)(D, S) * (1.0 / S ** 0.5)),
            "ssm_D": _w((lambda *s: torch.randn(*s, dtype=torch.bfloat16) * 0.8)(D)),
        }
    _B_in = _B_setup()

    return {
        "A_x": _A_in["x"],
        "A_wqkv": _A_in["wqkv"],
        "A_w_phi": _A_in["w_phi"],
        "A_wo": _A_in["wo"],
        "B_q": _B_in["q"],
        "B_k": _B_in["k"],
        "B_v": _B_in["v"],
        "B_shift_k": _B_in["shift_k"],
        "B_ssm_k": _B_in["ssm_k"],
        "B_ssm_D": _B_in["ssm_D"],
    }

def reference(A_x, A_wqkv, A_w_phi, A_wo, B_q, B_k, B_v, B_shift_k, B_ssm_k, B_ssm_D):
    def _A_ref(x, wqkv, w_phi, wo):
        B, S, D = x.shape
        H = 32; Dh = D // H
        qkv = (lambda x, *d: x.permute(*d))((x @ wqkv).reshape(B, S, 3, H, Dh), 2, 0, 3, 1, 4)
        q, k, v = qkv[0], qkv[1], qkv[2]
        pq = torch.einsum("bhsd,hdf->bhsf", q, w_phi)
        pk = torch.einsum("bhsd,hdf->bhsf", k, w_phi)
        phi_q = torch.concatenate([_softmax(pq, axis=-1), _softmax(-pq, axis=-1)], axis=-1)
        phi_k = torch.concatenate([_softmax(pk, axis=-1), _softmax(-pk, axis=-1)], axis=-1)
        kv = torch.einsum("bhsf,bhsd->bhfd", phi_k, v)
        z  = torch.einsum("bhsf->bhf", phi_k)
        num = torch.einsum("bhqf,bhfd->bhqd", phi_q, kv)
        den = torch.einsum("bhqf,bhf->bhq", phi_q, z)[..., None] + 1e-6
        o = num / den
        return (lambda x, *d: x.permute(*d))(o, 0, 2, 1, 3).reshape(B, S, D) @ wo

    def _B_ref(q, k, v, shift_k, ssm_k, ssm_D):
        B, S, D = q.shape
        ks = shift_k.shape[-1]
        k_pad = _pad(k, ((0, 0), (ks - 1, 0), (0, 0)))
        k_shift = torch.zeros_like(k)
        for t in range(ks):
            k_shift = k_shift + k_pad[:, t:t + S, :] * shift_k[:, ks - 1 - t][None, None, :]
        kv = k_shift * v
        L = 2 * S
        kv_pad = _pad(kv, ((0, 0), (0, S), (0, 0)))
        kf_pad = _pad(ssm_k, ((0, 0), (0, S)))
        kv_f = (lambda x, axes=(-2,-1): torch.fft.rfft2(x.float(), dim=axes))(kv_pad[:, None, :, :], axes=(1, 2))
        kf_f = (lambda x, axes=(-2,-1): torch.fft.rfft2(x.float(), dim=axes))(kf_pad[:, None, :], axes=(1, 2))
        kf_f = (lambda x, *d: x.permute(*d))(kf_f, 1, 2, 0)
        y_f = kv_f * kf_f[None, :, :, :]
        y = (lambda x, s, axes=(-2,-1): torch.fft.irfft2(x, s=s, dim=axes).to(torch.bfloat16))(y_f, (1, L), axes=(1, 2))[:, 0, :S, :]
        y = y + kv * ssm_D[None, None, :]
        return q * y

    x = A_x
    x = x + _A_ref(_layernorm(x, axis=-1), A_wqkv, A_w_phi, A_wo)
    x = x + _B_ref(_layernorm(x, axis=-1), B_k, B_v, B_shift_k, B_ssm_k, B_ssm_D)
    x = x + _A_ref(_layernorm(x, axis=-1), A_wqkv, A_w_phi, A_wo)
    x = x + _B_ref(_layernorm(x, axis=-1), B_k, B_v, B_shift_k, B_ssm_k, B_ssm_D)
    return x
```

```asm
; @launch grid=(256,1,1) block=(256,1,1) lds=163840
.amdgcn_target "amdgcn-amd-amdhsa--gfx950"
.text
.globl interleave_layers__linear_kernel_hedgehog__ssm_conv_h3__prompt_kernel
.p2align 8
.type interleave_layers__linear_kernel_hedgehog__ssm_conv_h3__prompt_kernel,@function
interleave_layers__linear_kernel_hedgehog__ssm_conv_h3__prompt_kernel:
    s_cmp_ge_u32 s2, 256
    s_cbranch_scc1 M_end
    s_load_dwordx8 s[52:59], s[0:1], 0
    s_load_dwordx8 s[76:83], s[0:1], 40
    s_load_dwordx8 s[16:23], s[0:1], 72
    s_memrealtime s[88:89]
    v_lshrrev_b32 v2, 6, v0
    v_and_b32 v1, 63, v0
    v_readfirstlane_b32 s3, v2
    v_lshlrev_b32_e64 v2, 4, v1
    s_getpc_b64 s[12:13]
M_pc:
    s_lshr_b32 s14, s2, 1
    s_and_b32 s14, s14, -4
    s_add_u32 s14, s14, s3
    s_mul_i32 s15, s14, 1366
    s_lshr_b32 s15, s15, 16
    s_mul_i32 s15, s15, 48
    s_sub_u32 s14, s14, s15
    s_lshl_b32 s14, s14, 10
    s_min_u32 s14, s14, M_end - M_pc - 1024
    v_add_u32_e64 v5, s14, v2
    global_load_dwordx4 a[116:119], v5, s[12:13]
    s_and_b32 s6, s2, 7
    s_lshl_b32 s6, s6, 1
    s_lshr_b32 s7, s2, 7
    s_add_u32 s6, s6, s7
    s_bfe_u32 s7, s2, 0x40003
    s_lshl_b32 s8, s6, 4
    s_add_u32 s8, s8, s7
    v_and_b32 v3, 15, v1
    v_lshrrev_b32 v4, 4, v1
    v_mov_b32 v241, 0x7fffff00
    s_mul_i32 s60, s6, 3
    s_add_u32 s60, s60, s3
    s_sub_u32 s60, s60, 1
    s_add_u32 s4, s6, 48
    s_cmp_eq_u32 s3, 0
    s_cselect_b32 s60, s4, s60
    s_mul_i32 s45, s60, 171
    s_lshr_b32 s45, s45, 9
    s_mul_i32 s5, s45, 3
    s_sub_u32 s44, s60, s5
    s_mul_i32 s15, s44, 1152
    s_mul_i32 s12, s7, 72
    s_add_u32 s15, s15, s12
    s_mul_i32 s12, s45, 36
    s_sub_u32 s13, s45, 16
    s_mul_i32 s13, s13, 288
    s_cmp_ge_u32 s45, 16
    s_cselect_b32 s12, s13, s12
    s_cselect_b32 s13, 36, 4
    s_cselect_b64 s[62:63], -1, 0
    s_mul_i32 s12, s12, 3456
    s_add_u32 s15, s15, s12
    s_mul_i32 s13, s13, 3456
    v_lshrrev_b32 v8, 3, v3
    v_mul_u32_u24_e64 v8, 18, v8
    v_bfe_u32 v9, v3, 2, 1
    v_lshl_add_u32 v8, v9, 3, v8
    v_and_b32 v10, 3, v3
    v_add_u32 v6, v8, v10
    v_and_b32_e64 v8, 12, v3
    v_bfe_u32 v9, v3, 1, 1
    v_add_u32 v8, v8, v9
    v_mul_u32_u24 v8, 18, v8
    v_and_b32_e64 v9, 1, v3
    v_add3_u32 v7, v8, v9, 16
    v_cndmask_b32 v8, v6, v7, s[62:63]
    v_mul_u32_u24 v8, 3456, v8
    v_lshl_add_u32 v8, v4, 4, v8
    v_cmp_gt_u32 vcc, 3, v4
    s_nop 1
    v_cndmask_b32 v8, v241, v8, vcc
    v_add_u32_e64 v9, s13, v8
    s_cmp_lt_u32 s60, 54
    s_cselect_b32 s15, s15, 0x40000000
    s_waitcnt lgkmcnt(0)
    s_mov_b32 s64, s54
    s_mov_b32 s65, s55
    s_mov_b32 s66, 0x1e6000
    s_mov_b32 s67, 0x20000
    s_or_b32 s4, s2, s3
    s_cbranch_scc1 M_noep
    s_mov_b32 s84, s20
    s_mov_b32 s85, s21
    s_mov_b32 s86, 0x100
    s_mov_b32 s87, 0x20000
    s_or_b32 s88, s88, 1
    v_mov_b32 v238, s88
    v_mov_b32_e64 v239, s89
    buffer_store_dwordx2 v[238:239], off, s[84:87], 0 sc1
M_noep:
    buffer_load_dwordx4 v[16:19], v8, s[64:67], s15 offen offset:0
    buffer_load_dwordx4 v[20:23], v9, s[64:67], s15 offen offset:0
    buffer_load_dwordx4 v[24:27], v8, s[64:67], s15 offen offset:36
    buffer_load_dwordx4 v[28:31], v9, s[64:67], s15 offen offset:36
    v_lshrrev_b32_e64 v8, 2, v3
    v_lshl_add_u32 v8, v8, 3, v10
    v_mul_u32_u24_e64 v9, 36, v8
    v_lshl_add_u32 v9, v4, 4, v9
    v_cndmask_b32 v9, v241, v9, vcc
    v_cmp_gt_u32 vcc, 18, v8
    s_nop 1
    v_cndmask_b32 v13, v241, v9, vcc
    v_add_u32 v9, 144, v9
    v_cmp_gt_u32 vcc, 14, v8
    s_nop 1
    v_cndmask_b32_e64 v14, v241, v9, vcc
    s_mov_b32 s68, s56
    s_mov_b32 s69, s57
    s_mov_b32 s70, 0x5100
    s_mov_b32 s71, 0x20000
    s_mul_i32 s14, s7, 1296
    buffer_load_dwordx4 v[32:35], v13, s[68:71], s14 offen offset:0
    buffer_load_dwordx4 v[36:39], v14, s[68:71], s14 offen offset:0
    buffer_load_dwordx4 v[40:43], v13, s[68:71], s14 offen offset:648
    buffer_load_dwordx4 v[44:47], v14, s[68:71], s14 offen offset:648
    s_mov_b32 s28, s52
    s_mov_b32 s29, s53
    s_mov_b32 s30, 0x240000
    s_mov_b32 s31, 0x20000
    s_cmp_eq_u32 s3, 0
    s_cbranch_scc0 M_loaded
    v_and_b32 v8, 7, v1
    v_lshrrev_b32 v9, 3, v1
    s_lshl_b32 s4, s8, 3
    v_add_u32 v10, s4, v8
    v_mul_u32_u24 v10, 1152, v10
    v_mul_u32_u24 v11, 144, v9
    v_add_u32 v11, v11, v10
    v_lshrrev_b32 v15, 1, v9
    v_mad_u32_u24 v10, v15, 36, v10
    v_and_b32_e64 v15, 1, v9
    v_lshl_add_u32 v10, v15, 4, v10
    buffer_load_dwordx4 v[72:75], v10, s[28:31], 0 offen offset:0
    buffer_load_dwordx4 v[76:79], v10, s[28:31], 0 offen offset:144
    buffer_load_dwordx4 v[80:83], v10, s[28:31], 0 offen offset:288
    buffer_load_dwordx4 v[84:87], v10, s[28:31], 0 offen offset:432
    buffer_load_dwordx4 v[88:91], v10, s[28:31], 0 offen offset:576
    buffer_load_dwordx4 v[92:95], v10, s[28:31], 0 offen offset:720
    buffer_load_dwordx4 v[96:99], v10, s[28:31], 0 offen offset:864
    buffer_load_dwordx4 v[100:103], v10, s[28:31], 0 offen offset:1008
    buffer_load_dword v104, v11, s[28:31], 0 offen offset:32
    buffer_load_dword v105, v11, s[28:31], 0 offen offset:68
    buffer_load_dword v106, v11, s[28:31], 0 offen offset:104
    buffer_load_dword v107, v11, s[28:31], 0 offen offset:140
M_loaded:
    s_mov_b32 s24, s22
    s_mov_b32 s25, s23
    s_mov_b32 s26, 0x1a00000
    s_mov_b32 s27, 0x20000
    s_mov_b32 s84, s20
    s_mov_b32 s85, s21
    s_mov_b32 s86, 0x100
    s_mov_b32 s87, 0x20000
    v_lshlrev_b32 v242, 3, v3
    v_cmp_gt_u32 vcc, 16, v1
    s_nop 1
    v_cndmask_b32 v242, v241, v242, vcc
    v_lshlrev_b32 v8, 3, v4
    v_sub_u32 v8, v3, v8
    v_mov_b32 v9, 0x3f80
    v_mov_b32 v10, 0x3f800000
    v_cmp_eq_i32 vcc, 0, v8
    s_nop 1
    v_cndmask_b32 v224, 0, v9, vcc
    v_cmp_eq_i32 vcc, 1, v8
    s_nop 1
    v_cndmask_b32 v224, v224, v10, vcc
    v_cmp_eq_i32 vcc, 2, v8
    s_nop 1
    v_cndmask_b32 v225, 0, v9, vcc
    v_cmp_eq_i32 vcc, 3, v8
    s_nop 1
    v_cndmask_b32 v225, v225, v10, vcc
    v_cmp_eq_i32 vcc, 4, v8
    s_nop 1
    v_cndmask_b32 v226, 0, v9, vcc
    v_cmp_eq_i32 vcc, 5, v8
    s_nop 1
    v_cndmask_b32 v226, v226, v10, vcc
    v_cmp_eq_i32 vcc, 6, v8
    s_nop 1
    v_cndmask_b32 v227, 0, v9, vcc
    v_cmp_eq_i32 vcc, 7, v8
    s_nop 1
    v_cndmask_b32 v227, v227, v10, vcc
    v_cmp_eq_i32 vcc, -16, v8
    s_nop 1
    v_cndmask_b32 v228, 0, v9, vcc
    v_cmp_eq_i32 vcc, -15, v8
    s_nop 1
    v_cndmask_b32 v228, v228, v10, vcc
    v_cmp_eq_i32 vcc, -14, v8
    s_nop 1
    v_cndmask_b32 v229, 0, v9, vcc
    v_cmp_eq_i32 vcc, -13, v8
    s_nop 1
    v_cndmask_b32 v229, v229, v10, vcc
    v_cmp_eq_i32 vcc, -12, v8
    s_nop 1
    v_cndmask_b32 v230, 0, v9, vcc
    v_cmp_eq_i32 vcc, -11, v8
    s_nop 1
    v_cndmask_b32 v230, v230, v10, vcc
    v_cmp_eq_i32 vcc, -10, v8
    s_nop 1
    v_cndmask_b32 v231, 0, v9, vcc
    v_cmp_eq_i32 vcc, -9, v8
    s_nop 1
    v_cndmask_b32 v231, v231, v10, vcc
    s_mul_i32 s12, s44, 9
    s_sub_u32 s12, 27, s12
    s_cmp_eq_u32 s44, 1
    s_cselect_b32 s12, 0, s12
    s_cmp_eq_u32 s44, 0
    s_cselect_b32 s12, 18, s12
    v_cmp_lt_u32_e64 vcc, 8, v3
    s_nop 1
    v_cndmask_b32 v11, 0, 1, vcc
    v_mul_u32_u24_e64 v14, 9, v11
    v_add3_u32 v10, v3, s12, 0
    v_sub_u32 v10, v10, v14
    v_lshrrev_b32 v14, 2, v10
    v_and_b32_e64 v10, 3, v10
    v_lshl_add_u32 v10, v11, 2, v10
    v_lshl_add_u32 v10, v4, 4, v10
    v_lshlrev_b32_e64 v10, 4, v10
    v_lshl_add_u32 v8, v14, 10, v10
    v_mov_b32 v11, 1
    v_mul_u32_u24 v14, 9, v11
    v_add3_u32 v10, v3, s12, 16
    v_sub_u32 v10, v10, v14
    v_lshrrev_b32 v14, 2, v10
    v_and_b32_e64 v10, 3, v10
    v_lshl_add_u32 v10, v11, 2, v10
    v_lshl_add_u32 v10, v4, 4, v10
    v_lshlrev_b32_e64 v10, 4, v10
    v_lshl_add_u32 v9, v14, 10, v10
    v_cmp_gt_u32 vcc, 2, v3
    s_nop 1
    v_cndmask_b32_e64 v9, v241, v9, vcc
    s_mul_i32 s46, s45, 7168
    s_mul_i32 s4, s7, 129024
    s_add_u32 s46, s46, s4
    s_cmp_lt_u32 s60, 54
    s_cselect_b32 s46, s46, 0x40000000
    v_cmp_lt_u32_e64 vcc, 17, v1
    s_nop 1
    v_cndmask_b32 v11, 0, 1, vcc
    v_mul_u32_u24 v13, 18, v11
    v_sub_u32 v10, v1, v13
    s_and_b32 s4, s8, 31
    s_lshl_b32 s4, s4, 6
    s_lshl_b32 s5, s3, 4
    s_add_u32 s4, s4, s5
    v_lshl_add_u32 v11, v11, 3, s4
    v_mul_u32_u24 v13, 1152, v11
    v_lshl_add_u32 v13, v10, 3, v13
    s_lshr_b32 s47, s8, 5
    s_mul_i32 s5, s47, 144
    v_add_u32 v13, s5, v13
    v_cmp_gt_u32 vcc, 36, v1
    s_nop 1
    v_cndmask_b32_e64 v13, v241, v13, vcc
    v_accvgpr_write_b32 a49, v13
    v_lshlrev_b32 v13, 5, v10
    v_cndmask_b32 v13, v241, v13, vcc
    v_accvgpr_write_b32 a50, v13
    s_mul_i32 s51, s47, 576
    s_mul_i32 s5, s47, 294912
    s_add_u32 s5, s5, 0x400ff0
    v_lshlrev_b32 v15, 14, v10
    v_lshlrev_b32 v11, 1, v11
    v_sub_u32 v15, v15, v11
    v_add_u32 v15, s5, v15
    v_cndmask_b32_e64 v15, v241, v15, vcc
    v_accvgpr_write_b32 a51, v15
    s_lshr_b32 s4, s8, 1
    s_mul_i32 s4, s4, 18432
    s_and_b32 s5, s8, 1
    s_lshl_b32 s5, s5, 7
    s_add_u32 s4, s4, s5
    s_add_u32 s4, s4, 0x700000
    v_lshrrev_b32 v10, 3, v1
    v_and_b32 v11, 7, v1
    v_lshlrev_b32_e64 v10, 8, v10
    v_lshl_add_u32 v10, v11, 4, v10
    v_add_u32 v134, s4, v10
    s_lshl_b32 s21, s8, 7
    s_add_u32 s21, s21, 0x1900000
    s_cmp_eq_u32 s3, 0
    s_cselect_b32 s21, s21, 0x40000000
    s_mov_b32 s20, 0x1900000
    s_mov_b64 s[100:101], s[18:19]
    s_mov_b32 s32, s76
    s_mov_b32 s33, s77
    s_mov_b32 s34, 0x240000
    s_mov_b32 s35, 0x20000
    s_mov_b32 s36, s82
    s_mov_b32 s37, s83
    s_mov_b32 s38, 0x240000
    s_mov_b32 s39, 0x20000
    s_mov_b32 s40, s80
    s_mov_b32 s41, s81
    s_mov_b32 s42, 0x1200
    s_mov_b32 s43, 0x20000
    s_mov_b32 s52, s78
    s_mov_b32 s53, s79
    s_mov_b32 s54, 0x240000
    s_mov_b32 s55, 0x20000
    s_mov_b32 s56, s58
    s_mov_b32 s57, s59
    s_mov_b32 s58, 0xa2000
    s_mov_b32 s59, 0x20000
    s_mul_i32 s79, s47, 72
    s_and_b32 s5, s8, 31
    s_lshl_b32 s64, s5, 1
    s_add_u32 s64, s64, s79
    s_lshr_b32 s4, s3, 1
    s_add_u32 s64, s64, s4
    s_add_u32 s79, s79, 64
    s_lshr_b32 s5, s5, 2
    s_add_u32 s79, s79, s5
    s_mul_i32 s65, s4, 17664
    s_add_u32 s65, s65, 100352
    s_and_b32 s66, s3, 1
    s_lshl_b32 s67, s64, 12
    s_lshl_b32 s4, s66, 11
    s_add_u32 s67, s67, s4
    s_lshl_b32 s68, s79, 12
    s_and_b32 s5, s7, 3
    s_lshl_b32 s5, s5, 9
    s_add_u32 s78, s68, s5
    s_add_u32 s78, s78, 0x1500000
    s_lshl_b32 s4, s3, 10
    s_add_u32 s68, s68, s4
    s_lshl_b32 s4, s64, 1
    s_and_b32 s4, s4, -4
    s_load_dword s76, s[16:17], s4
    s_lshl_b32 s4, s79, 1
    s_and_b32 s4, s4, -4
    s_load_dword s77, s[16:17], s4
    s_cmp_eq_u32 s3, 0
    s_cselect_b32 s4, 0, 0x40000000
    buffer_load_dwordx2 v[234:235], off, s[84:87], s4 sc1
    s_and_b32 s69, s7, 3
    s_lshl_b32 s4, s6, 3
    s_lshl_b32 s9, s3, 1
    s_add_u32 s4, s4, s9
    s_mul_i32 s9, s4, 18432
    s_lshl_b32 s70, s7, 7
    s_add_u32 s70, s70, s9
    s_add_u32 s70, s70, 16384
    s_lshl_b32 s74, s7, 4
    s_add_u32 s73, s74, s6
    s_mul_i32 s73, s73, 3072
    s_mul_i32 s74, s74, 3072
    s_add_u32 s73, s73, 0xa00000
    s_add_u32 s74, s74, 0xa00000
    s_cmp_eq_u32 s44, 2
    s_cselect_b64 s[62:63], -1, 0
    s_getreg_b32 s13, hwreg(HW_REG_XCC_ID, 0, 4)
    s_mov_b32 s75, 0
    s_waitcnt vmcnt(1)
    v_mfma_f32_16x16x32_bf16 v[136:139], v[32:35], v[224:227], 0
    v_mfma_f32_16x16x32_bf16 v[140:143], v[36:39], v[224:227], 0
    v_mfma_f32_16x16x32_bf16 v[144:147], v[32:35], v[228:231], 0
    v_mfma_f32_16x16x32_bf16 v[148:151], v[36:39], v[228:231], 0
    v_mfma_f32_16x16x32_bf16 v[152:155], v[40:43], v[224:227], 0
    v_mfma_f32_16x16x32_bf16 v[156:159], v[44:47], v[224:227], 0
    v_mfma_f32_16x16x32_bf16 v[160:163], v[40:43], v[228:231], 0
    v_mfma_f32_16x16x32_bf16 v[164:167], v[44:47], v[228:231], 0
    s_nop 0
    s_nop 0
    v_cvt_pk_bf16_f32 v32, v136, v137
    v_cvt_pk_bf16_f32 v33, v138, v139
    v_cvt_pk_bf16_f32 v34, v140, v141
    v_cvt_pk_bf16_f32 v35, v142, v143
    v_cvt_pk_bf16_f32 v36, v144, v145
    v_cvt_pk_bf16_f32 v37, v146, v147
    v_cvt_pk_bf16_f32 v38, v148, v149
    v_cvt_pk_bf16_f32 v39, v150, v151
    v_cndmask_b32 v32, v32, v224, s[62:63]
    v_cndmask_b32 v33, v33, v225, s[62:63]
    v_cndmask_b32 v34, v34, v226, s[62:63]
    v_cndmask_b32 v35, v35, v227, s[62:63]
    v_cndmask_b32 v36, v36, v228, s[62:63]
    v_cndmask_b32 v37, v37, v229, s[62:63]
    v_cndmask_b32 v38, v38, v230, s[62:63]
    v_cndmask_b32 v39, v39, v231, s[62:63]
    v_mfma_f32_16x16x32_bf16 v[168:171], v[16:19], v[32:35], 0
    v_mfma_f32_16x16x32_bf16 v[172:175], v[20:23], v[32:35], 0
    v_mfma_f32_16x16x32_bf16 v[176:179], v[16:19], v[36:39], 0
    v_mfma_f32_16x16x32_bf16 v[180:183], v[20:23], v[36:39], 0
    v_cvt_pk_bf16_f32 v40, v152, v153
    v_cvt_pk_bf16_f32 v41, v154, v155
    v_cvt_pk_bf16_f32 v42, v156, v157
    v_cvt_pk_bf16_f32 v43, v158, v159
    v_cvt_pk_bf16_f32 v44, v160, v161
    v_cvt_pk_bf16_f32 v45, v162, v163
    v_cvt_pk_bf16_f32 v46, v164, v165
    v_cvt_pk_bf16_f32 v47, v166, v167
    v_cndmask_b32 v40, v40, v224, s[62:63]
    v_cndmask_b32 v41, v41, v225, s[62:63]
    v_cndmask_b32 v42, v42, v226, s[62:63]
    v_cndmask_b32 v43, v43, v227, s[62:63]
    v_cndmask_b32 v44, v44, v228, s[62:63]
    v_cndmask_b32 v45, v45, v229, s[62:63]
    v_cndmask_b32 v46, v46, v230, s[62:63]
    v_cndmask_b32 v47, v47, v231, s[62:63]
    v_mfma_f32_16x16x32_bf16 v[184:187], v[24:27], v[40:43], 0
    v_mfma_f32_16x16x32_bf16 v[188:191], v[28:31], v[40:43], 0
    v_mfma_f32_16x16x32_bf16 v[192:195], v[24:27], v[44:47], 0
    v_mfma_f32_16x16x32_bf16 v[196:199], v[28:31], v[44:47], 0
    v_cvt_pk_bf16_f32 v16, v168, v169
    v_cvt_pk_bf16_f32 v17, v170, v171
    v_cvt_pk_bf16_f32 v18, v172, v173
    v_cvt_pk_bf16_f32 v19, v174, v175
    buffer_store_dwordx4 v[16:19], v8, s[24:27], s46 offen offset:0 sc1
    v_cvt_pk_bf16_f32 v20, v176, v177
    v_cvt_pk_bf16_f32 v21, v178, v179
    v_cvt_pk_bf16_f32 v22, v180, v181
    v_cvt_pk_bf16_f32 v23, v182, v183
    buffer_store_dwordx4 v[20:23], v9, s[24:27], s46 offen offset:0 sc1
    v_cvt_pk_bf16_f32 v24, v184, v185
    v_cvt_pk_bf16_f32 v25, v186, v187
    v_cvt_pk_bf16_f32 v26, v188, v189
    v_cvt_pk_bf16_f32 v27, v190, v191
    buffer_store_dwordx4 v[24:27], v8, s[24:27], s46 offen offset:128 sc1
    v_cvt_pk_bf16_f32 v28, v192, v193
    v_cvt_pk_bf16_f32 v29, v194, v195
    v_cvt_pk_bf16_f32 v30, v196, v197
    v_cvt_pk_bf16_f32 v31, v198, v199
    buffer_store_dwordx4 v[28:31], v9, s[24:27], s46 offen offset:128 sc1
    s_cmp_eq_u32 s3, 0
    s_cbranch_scc0 M_fdone
    v_lshlrev_b32_e64 v136, 16, v72
    v_and_b32 v137, 0xffff0000, v72
    v_lshlrev_b32_e64 v138, 16, v73
    v_and_b32 v139, 0xffff0000, v73
    v_lshlrev_b32_e64 v140, 16, v74
    v_and_b32 v141, 0xffff0000, v74
    v_lshlrev_b32_e64 v142, 16, v75
    v_and_b32 v143, 0xffff0000, v75
    v_pk_mul_f32 v[216:217], v[136:137], v[136:137]
    v_pk_mul_f32 v[218:219], v[138:139], v[138:139]
    v_pk_mul_f32 v[220:221], v[140:141], v[140:141]
    v_pk_mul_f32 v[222:223], v[142:143], v[142:143]
    v_lshlrev_b32_e64 v144, 16, v76
    v_and_b32 v145, 0xffff0000, v76
    v_lshlrev_b32_e64 v146, 16, v77
    v_and_b32 v147, 0xffff0000, v77
    v_lshlrev_b32_e64 v148, 16, v78
    v_and_b32 v149, 0xffff0000, v78
    v_lshlrev_b32_e64 v150, 16, v79
    v_and_b32 v151, 0xffff0000, v79
    v_pk_add_f32 v[208:209], v[136:137], v[144:145]
    v_pk_fma_f32 v[216:217], v[144:145], v[144:145], v[216:217]
    v_pk_add_f32 v[210:211], v[138:139], v[146:147]
    v_pk_fma_f32 v[218:219], v[146:147], v[146:147], v[218:219]
    v_pk_add_f32 v[212:213], v[140:141], v[148:149]
    v_pk_fma_f32 v[220:221], v[148:149], v[148:149], v[220:221]
    v_pk_add_f32 v[214:215], v[142:143], v[150:151]
    v_pk_fma_f32 v[222:223], v[150:151], v[150:151], v[222:223]
    v_lshlrev_b32_e64 v152, 16, v80
    v_and_b32 v153, 0xffff0000, v80
    v_lshlrev_b32_e64 v154, 16, v81
    v_and_b32 v155, 0xffff0000, v81
    v_lshlrev_b32_e64 v156, 16, v82
    v_and_b32 v157, 0xffff0000, v82
    v_lshlrev_b32_e64 v158, 16, v83
    v_and_b32 v159, 0xffff0000, v83
    v_pk_add_f32 v[208:209], v[208:209], v[152:153]
    v_pk_fma_f32 v[216:217], v[152:153], v[152:153], v[216:217]
    v_pk_add_f32 v[210:211], v[210:211], v[154:155]
    v_pk_fma_f32 v[218:219], v[154:155], v[154:155], v[218:219]
    v_pk_add_f32 v[212:213], v[212:213], v[156:157]
    v_pk_fma_f32 v[220:221], v[156:157], v[156:157], v[220:221]
    v_pk_add_f32 v[214:215], v[214:215], v[158:159]
    v_pk_fma_f32 v[222:223], v[158:159], v[158:159], v[222:223]
    v_lshlrev_b32_e64 v160, 16, v84
    v_and_b32 v161, 0xffff0000, v84
    v_lshlrev_b32_e64 v162, 16, v85
    v_and_b32 v163, 0xffff0000, v85
    v_lshlrev_b32_e64 v164, 16, v86
    v_and_b32 v165, 0xffff0000, v86
    v_lshlrev_b32_e64 v166, 16, v87
    v_and_b32 v167, 0xffff0000, v87
    v_pk_add_f32 v[208:209], v[208:209], v[160:161]
    v_pk_fma_f32 v[216:217], v[160:161], v[160:161], v[216:217]
    v_pk_add_f32 v[210:211], v[210:211], v[162:163]
    v_pk_fma_f32 v[218:219], v[162:163], v[162:163], v[218:219]
    v_pk_add_f32 v[212:213], v[212:213], v[164:165]
    v_pk_fma_f32 v[220:221], v[164:165], v[164:165], v[220:221]
    v_pk_add_f32 v[214:215], v[214:215], v[166:167]
    v_pk_fma_f32 v[222:223], v[166:167], v[166:167], v[222:223]
    v_lshlrev_b32_e64 v168, 16, v88
    v_and_b32 v169, 0xffff0000, v88
    v_lshlrev_b32_e64 v170, 16, v89
    v_and_b32 v171, 0xffff0000, v89
    v_lshlrev_b32_e64 v172, 16, v90
    v_and_b32 v173, 0xffff0000, v90
    v_lshlrev_b32_e64 v174, 16, v91
    v_and_b32 v175, 0xffff0000, v91
    v_pk_add_f32 v[208:209], v[208:209], v[168:169]
    v_pk_fma_f32 v[216:217], v[168:169], v[168:169], v[216:217]
    v_pk_add_f32 v[210:211], v[210:211], v[170:171]
    v_pk_fma_f32 v[218:219], v[170:171], v[170:171], v[218:219]
    v_pk_add_f32 v[212:213], v[212:213], v[172:173]
    v_pk_fma_f32 v[220:221], v[172:173], v[172:173], v[220:221]
    v_pk_add_f32 v[214:215], v[214:215], v[174:175]
    v_pk_fma_f32 v[222:223], v[174:175], v[174:175], v[222:223]
    v_lshlrev_b32_e64 v176, 16, v92
    v_and_b32 v177, 0xffff0000, v92
    v_lshlrev_b32_e64 v178, 16, v93
    v_and_b32 v179, 0xffff0000, v93
    v_lshlrev_b32_e64 v180, 16, v94
    v_and_b32 v181, 0xffff0000, v94
    v_lshlrev_b32_e64 v182, 16, v95
    v_and_b32 v183, 0xffff0000, v95
    v_pk_add_f32 v[208:209], v[208:209], v[176:177]
    v_pk_fma_f32 v[216:217], v[176:177], v[176:177], v[216:217]
    v_pk_add_f32 v[210:211], v[210:211], v[178:179]
    v_pk_fma_f32 v[218:219], v[178:179], v[178:179], v[218:219]
    v_pk_add_f32 v[212:213], v[212:213], v[180:181]
    v_pk_fma_f32 v[220:221], v[180:181], v[180:181], v[220:221]
    v_pk_add_f32 v[214:215], v[214:215], v[182:183]
    v_pk_fma_f32 v[222:223], v[182:183], v[182:183], v[222:223]
    v_lshlrev_b32_e64 v184, 16, v96
    v_and_b32 v185, 0xffff0000, v96
    v_lshlrev_b32_e64 v186, 16, v97
    v_and_b32 v187, 0xffff0000, v97
    v_lshlrev_b32_e64 v188, 16, v98
    v_and_b32 v189, 0xffff0000, v98
    v_lshlrev_b32_e64 v190, 16, v99
    v_and_b32 v191, 0xffff0000, v99
    v_pk_add_f32 v[208:209], v[208:209], v[184:185]
    v_pk_fma_f32 v[216:217], v[184:185], v[184:185], v[216:217]
    v_pk_add_f32 v[210:211], v[210:211], v[186:187]
    v_pk_fma_f32 v[218:219], v[186:187], v[186:187], v[218:219]
    v_pk_add_f32 v[212:213], v[212:213], v[188:189]
    v_pk_fma_f32 v[220:221], v[188:189], v[188:189], v[220:221]
    v_pk_add_f32 v[214:215], v[214:215], v[190:191]
    v_pk_fma_f32 v[222:223], v[190:191], v[190:191], v[222:223]
    v_lshlrev_b32_e64 v192, 16, v100
    v_and_b32 v193, 0xffff0000, v100
    v_lshlrev_b32_e64 v194, 16, v101
    v_and_b32 v195, 0xffff0000, v101
    v_lshlrev_b32_e64 v196, 16, v102
    v_and_b32 v197, 0xffff0000, v102
    v_lshlrev_b32_e64 v198, 16, v103
    v_and_b32 v199, 0xffff0000, v103
    v_pk_add_f32 v[208:209], v[208:209], v[192:193]
    v_pk_fma_f32 v[216:217], v[192:193], v[192:193], v[216:217]
    v_pk_add_f32 v[210:211], v[210:211], v[194:195]
    v_pk_fma_f32 v[218:219], v[194:195], v[194:195], v[218:219]
    v_pk_add_f32 v[212:213], v[212:213], v[196:197]
    v_pk_fma_f32 v[220:221], v[196:197], v[196:197], v[220:221]
    v_pk_add_f32 v[214:215], v[214:215], v[198:199]
    v_pk_fma_f32 v[222:223], v[198:199], v[198:199], v[222:223]
    v_lshlrev_b32_e64 v200, 16, v104
    v_and_b32 v201, 0xffff0000, v104
    v_lshlrev_b32_e64 v202, 16, v105
    v_and_b32 v203, 0xffff0000, v105
    v_lshlrev_b32_e64 v204, 16, v106
    v_and_b32 v205, 0xffff0000, v106
    v_lshlrev_b32_e64 v206, 16, v107
    v_and_b32 v207, 0xffff0000, v107
    v_pk_add_f32 v[208:209], v[208:209], v[200:201]
    v_pk_fma_f32 v[216:217], v[200:201], v[200:201], v[216:217]
    v_pk_add_f32 v[210:211], v[210:211], v[202:203]
    v_pk_fma_f32 v[218:219], v[202:203], v[202:203], v[218:219]
    v_pk_add_f32 v[212:213], v[212:213], v[204:205]
    v_pk_fma_f32 v[220:221], v[204:205], v[204:205], v[220:221]
    v_pk_add_f32 v[214:215], v[214:215], v[206:207]
    v_pk_fma_f32 v[222:223], v[206:207], v[206:207], v[222:223]
    v_pk_add_f32 v[208:209], v[208:209], v[210:211]
    v_pk_add_f32 v[212:213], v[212:213], v[214:215]
    v_pk_add_f32 v[216:217], v[216:217], v[218:219]
    v_pk_add_f32 v[220:221], v[220:221], v[222:223]
    v_pk_add_f32 v[208:209], v[208:209], v[212:213]
    v_pk_add_f32 v[216:217], v[216:217], v[220:221]
    v_add_f32 v208, v208, v209
    v_add_f32_e64 v216, v216, v217
    s_nop 0
    v_add_f32_dpp v209, v208, v208 row_ror:8 row_mask:0xf bank_mask:0xf
    v_add_f32_dpp v217, v216, v216 row_ror:8 row_mask:0xf bank_mask:0xf
    v_mov_b32 v210, v209
    v_mov_b32 v218, v217
    s_nop 0
    v_permlane16_swap_b32 v209, v210
    v_add_f32 v211, v209, v210
    v_permlane16_swap_b32 v217, v218
    v_add_f32 v219, v217, v218
    v_mov_b32 v212, v211
    v_mov_b32 v220, v219
    s_nop 0
    v_permlane32_swap_b32 v211, v212
    v_add_f32 v213, v211, v212
    v_permlane32_swap_b32 v219, v220
    v_add_f32 v221, v219, v220
    v_mul_f32 v208, 0x3ae38e39, v213
    v_mul_f32 v209, 0x3ae38e39, v221
    v_fma_f32 v209, -v208, v208, v209
    v_max_f32_e64 v209, 0, v209
    v_add_f32 v209, 0x3727c5ac, v209
    v_rsq_f32 v210, v209
    s_nop 0
    v_mul_f32 v211, -v210, v208
    v_pk_fma_f32 v[136:137], v[136:137], v[210:211], v[210:211] op_sel:[0,0,1] op_sel_hi:[1,0,1]
    v_pk_fma_f32 v[138:139], v[138:139], v[210:211], v[210:211] op_sel:[0,0,1] op_sel_hi:[1,0,1]
    v_pk_fma_f32 v[140:141], v[140:141], v[210:211], v[210:211] op_sel:[0,0,1] op_sel_hi:[1,0,1]
    v_pk_fma_f32 v[142:143], v[142:143], v[210:211], v[210:211] op_sel:[0,0,1] op_sel_hi:[1,0,1]
    v_cvt_pk_bf16_f32 v72, v136, v137
    v_cvt_pk_bf16_f32 v73, v138, v139
    v_cvt_pk_bf16_f32 v74, v140, v141
    v_cvt_pk_bf16_f32 v75, v142, v143
    buffer_store_dwordx4 v[72:75], v134, s[24:27], 0 offen offset:0 sc1
    v_pk_fma_f32 v[144:145], v[144:145], v[210:211], v[210:211] op_sel:[0,0,1] op_sel_hi:[1,0,1]
    v_pk_fma_f32 v[146:147], v[146:147], v[210:211], v[210:211] op_sel:[0,0,1] op_sel_hi:[1,0,1]
    v_pk_fma_f32 v[148:149], v[148:149], v[210:211], v[210:211] op_sel:[0,0,1] op_sel_hi:[1,0,1]
    v_pk_fma_f32 v[150:151], v[150:151], v[210:211], v[210:211] op_sel:[0,0,1] op_sel_hi:[1,0,1]
    v_cvt_pk_bf16_f32 v76, v144, v145
    v_cvt_pk_bf16_f32 v77, v146, v147
    v_cvt_pk_bf16_f32 v78, v148, v149
    v_cvt_pk_bf16_f32 v79, v150, v151
    buffer_store_dwordx4 v[76:79], v134, s[24:27], 0 offen offset:2048 sc1
    v_pk_fma_f32 v[152:153], v[152:153], v[210:211], v[210:211] op_sel:[0,0,1] op_sel_hi:[1,0,1]
    v_pk_fma_f32 v[154:155], v[154:155], v[210:211], v[210:211] op_sel:[0,0,1] op_sel_hi:[1,0,1]
    v_pk_fma_f32 v[156:157], v[156:157], v[210:211], v[210:211] op_sel:[0,0,1] op_sel_hi:[1,0,1]
    v_pk_fma_f32 v[158:159], v[158:159], v[210:211], v[210:211] op_sel:[0,0,1] op_sel_hi:[1,0,1]
    v_cvt_pk_bf16_f32 v80, v152, v153
    v_cvt_pk_bf16_f32 v81, v154, v155
    v_cvt_pk_bf16_f32 v82, v156, v157
    v_cvt_pk_bf16_f32 v83, v158, v159
    v_add_u32 v134, 4096, v134
    buffer_store_dwordx4 v[80:83], v134, s[24:27], 0 offen offset:0 sc1
    v_pk_fma_f32 v[160:161], v[160:161], v[210:211], v[210:211] op_sel:[0,0,1] op_sel_hi:[1,0,1]
    v_pk_fma_f32 v[162:163], v[162:163], v[210:211], v[210:211] op_sel:[0,0,1] op_sel_hi:[1,0,1]
    v_pk_fma_f32 v[164:165], v[164:165], v[210:211], v[210:211] op_sel:[0,0,1] op_sel_hi:[1,0,1]
    v_pk_fma_f32 v[166:167], v[166:167], v[210:211], v[210:211] op_sel:[0,0,1] op_sel_hi:[1,0,1]
    v_cvt_pk_bf16_f32 v84, v160, v161
    v_cvt_pk_bf16_f32 v85, v162, v163
    v_cvt_pk_bf16_f32 v86, v164, v165
    v_cvt_pk_bf16_f32 v87, v166, v167
    buffer_store_dwordx4 v[84:87], v134, s[24:27], 0 offen offset:2048 sc1
    v_pk_fma_f32 v[168:169], v[168:169], v[210:211], v[210:211] op_sel:[0,0,1] op_sel_hi:[1,0,1]
    v_pk_fma_f32 v[170:171], v[170:171], v[210:211], v[210:211] op_sel:[0,0,1] op_sel_hi:[1,0,1]
    v_pk_fma_f32 v[172:173], v[172:173], v[210:211], v[210:211] op_sel:[0,0,1] op_sel_hi:[1,0,1]
    v_pk_fma_f32 v[174:175], v[174:175], v[210:211], v[210:211] op_sel:[0,0,1] op_sel_hi:[1,0,1]
    v_cvt_pk_bf16_f32 v88, v168, v169
    v_cvt_pk_bf16_f32 v89, v170, v171
    v_cvt_pk_bf16_f32 v90, v172, v173
    v_cvt_pk_bf16_f32 v91, v174, v175
    v_add_u32 v134, 4096, v134
    buffer_store_dwordx4 v[88:91], v134, s[24:27], 0 offen offset:0 sc1
    v_pk_fma_f32 v[176:177], v[176:177], v[210:211], v[210:211] op_sel:[0,0,1] op_sel_hi:[1,0,1]
    v_pk_fma_f32 v[178:179], v[178:179], v[210:211], v[210:211] op_sel:[0,0,1] op_sel_hi:[1,0,1]
    v_pk_fma_f32 v[180:181], v[180:181], v[210:211], v[210:211] op_sel:[0,0,1] op_sel_hi:[1,0,1]
    v_pk_fma_f32 v[182:183], v[182:183], v[210:211], v[210:211] op_sel:[0,0,1] op_sel_hi:[1,0,1]
    v_cvt_pk_bf16_f32 v92, v176, v177
    v_cvt_pk_bf16_f32 v93, v178, v179
    v_cvt_pk_bf16_f32 v94, v180, v181
    v_cvt_pk_bf16_f32 v95, v182, v183
    buffer_store_dwordx4 v[92:95], v134, s[24:27], 0 offen offset:2048 sc1
    v_pk_fma_f32 v[184:185], v[184:185], v[210:211], v[210:211] op_sel:[0,0,1] op_sel_hi:[1,0,1]
    v_pk_fma_f32 v[186:187], v[186:187], v[210:211], v[210:211] op_sel:[0,0,1] op_sel_hi:[1,0,1]
    v_pk_fma_f32 v[188:189], v[188:189], v[210:211], v[210:211] op_sel:[0,0,1] op_sel_hi:[1,0,1]
    v_pk_fma_f32 v[190:191], v[190:191], v[210:211], v[210:211] op_sel:[0,0,1] op_sel_hi:[1,0,1]
    v_cvt_pk_bf16_f32 v96, v184, v185
    v_cvt_pk_bf16_f32 v97, v186, v187
    v_cvt_pk_bf16_f32 v98, v188, v189
    v_cvt_pk_bf16_f32 v99, v190, v191
    v_add_u32 v134, 4096, v134
    buffer_store_dwordx4 v[96:99], v134, s[24:27], 0 offen offset:0 sc1
    v_pk_fma_f32 v[192:193], v[192:193], v[210:211], v[210:211] op_sel:[0,0,1] op_sel_hi:[1,0,1]
    v_pk_fma_f32 v[194:195], v[194:195], v[210:211], v[210:211] op_sel:[0,0,1] op_sel_hi:[1,0,1]
    v_pk_fma_f32 v[196:197], v[196:197], v[210:211], v[210:211] op_sel:[0,0,1] op_sel_hi:[1,0,1]
    v_pk_fma_f32 v[198:199], v[198:199], v[210:211], v[210:211] op_sel:[0,0,1] op_sel_hi:[1,0,1]
    v_cvt_pk_bf16_f32 v100, v192, v193
    v_cvt_pk_bf16_f32 v101, v194, v195
    v_cvt_pk_bf16_f32 v102, v196, v197
    v_cvt_pk_bf16_f32 v103, v198, v199
    buffer_store_dwordx4 v[100:103], v134, s[24:27], 0 offen offset:2048 sc1
    v_pk_fma_f32 v[200:201], v[200:201], v[210:211], v[210:211] op_sel:[0,0,1] op_sel_hi:[1,0,1]
    v_pk_fma_f32 v[202:203], v[202:203], v[210:211], v[210:211] op_sel:[0,0,1] op_sel_hi:[1,0,1]
    v_pk_fma_f32 v[204:205], v[204:205], v[210:211], v[210:211] op_sel:[0,0,1] op_sel_hi:[1,0,1]
    v_pk_fma_f32 v[206:207], v[206:207], v[210:211], v[210:211] op_sel:[0,0,1] op_sel_hi:[1,0,1]
    v_cvt_pk_bf16_f32 v104, v200, v201
    v_cvt_pk_bf16_f32 v105, v202, v203
    v_cvt_pk_bf16_f32 v106, v204, v205
    v_cvt_pk_bf16_f32 v107, v206, v207
    v_add_u32 v134, 4096, v134
    buffer_store_dwordx4 v[104:107], v134, s[24:27], 0 offen offset:0 sc1
    v_accvgpr_read_b32 v130, a49
    v_accvgpr_read_b32 v232, a50
    v_add_u32 v131, 4608, v130
    v_subrev_u32 v132, 3456, v130
    v_subrev_u32 v133, 2304, v130
    v_subrev_u32 v135, 1152, v130
    buffer_load_dwordx2 v[108:109], v132, s[32:35], 0 offen
    buffer_load_dwordx2 v[110:111], v133, s[32:35], 0 offen
    buffer_load_dwordx2 v[112:113], v135, s[32:35], 0 offen
    buffer_load_dwordx2 v[114:115], v130, s[32:35], 0 offen offset:0
    buffer_load_dwordx2 v[116:117], v130, s[32:35], 0 offen offset:1152
    buffer_load_dwordx2 v[118:119], v130, s[32:35], 0 offen offset:2304
    buffer_load_dwordx2 v[120:121], v130, s[32:35], 0 offen offset:3456
    buffer_load_dwordx2 v[122:123], v131, s[32:35], 0 offen offset:0
    buffer_load_dwordx2 v[124:125], v131, s[32:35], 0 offen offset:1152
    buffer_load_dwordx2 v[126:127], v131, s[32:35], 0 offen offset:2304
    buffer_load_dwordx2 v[128:129], v131, s[32:35], 0 offen offset:3456
    buffer_load_dwordx4 a[128:131], v232, s[40:43], s51 offen offset:0
    buffer_load_dwordx4 a[132:135], v232, s[40:43], s51 offen offset:16
    buffer_load_dwordx2 a[136:137], v130, s[52:55], 0 offen offset:0
    buffer_load_dwordx2 a[138:139], v130, s[52:55], 0 offen offset:1152
    buffer_load_dwordx2 a[140:141], v130, s[52:55], 0 offen offset:2304
    buffer_load_dwordx2 a[142:143], v130, s[52:55], 0 offen offset:3456
    buffer_load_dwordx2 a[144:145], v131, s[52:55], 0 offen offset:0
    buffer_load_dwordx2 a[146:147], v131, s[52:55], 0 offen offset:1152
    buffer_load_dwordx2 a[148:149], v131, s[52:55], 0 offen offset:2304
    buffer_load_dwordx2 a[150:151], v131, s[52:55], 0 offen offset:3456
    s_waitcnt vmcnt(21)
M_epoch:
    v_readfirstlane_b32 s88, v234
    v_readfirstlane_b32 s89, v235
    s_cmp_lg_u32 s88, 0
    s_cbranch_scc0 M_epoch_retry
M_epoch_ok:
    s_lshl_b32 s89, s89, 4
    s_or_b32 s4, s89, s13
    v_mov_b32 v238, s88
    v_mov_b32_e64 v239, s4
    v_mov_b32 v11, 163520
    ds_write_b64 v11, v[238:239]
    s_branch M_place
M_fdone:
    s_nop 0
    v_accvgpr_read_b32 v130, a49
    v_accvgpr_read_b32 v232, a50
    v_add_u32 v131, 4608, v130
    v_subrev_u32 v132, 3456, v130
    v_subrev_u32 v133, 2304, v130
    v_subrev_u32 v135, 1152, v130
    buffer_load_dwordx2 v[108:109], v132, s[32:35], 0 offen
    buffer_load_dwordx2 v[110:111], v133, s[32:35], 0 offen
    buffer_load_dwordx2 v[112:113], v135, s[32:35], 0 offen
    buffer_load_dwordx2 v[114:115], v130, s[32:35], 0 offen offset:0
    buffer_load_dwordx2 v[116:117], v130, s[32:35], 0 offen offset:1152
    buffer_load_dwordx2 v[118:119], v130, s[32:35], 0 offen offset:2304
    buffer_load_dwordx2 v[120:121], v130, s[32:35], 0 offen offset:3456
    buffer_load_dwordx2 v[122:123], v131, s[32:35], 0 offen offset:0
    buffer_load_dwordx2 v[124:125], v131, s[32:35], 0 offen offset:1152
    buffer_load_dwordx2 v[126:127], v131, s[32:35], 0 offen offset:2304
    buffer_load_dwordx2 v[128:129], v131, s[32:35], 0 offen offset:3456
    buffer_load_dwordx4 a[128:131], v232, s[40:43], s51 offen offset:0
    buffer_load_dwordx4 a[132:135], v232, s[40:43], s51 offen offset:16
    buffer_load_dwordx2 a[136:137], v130, s[52:55], 0 offen offset:0
    buffer_load_dwordx2 a[138:139], v130, s[52:55], 0 offen offset:1152
    buffer_load_dwordx2 a[140:141], v130, s[52:55], 0 offen offset:2304
    buffer_load_dwordx2 a[142:143], v130, s[52:55], 0 offen offset:3456
    buffer_load_dwordx2 a[144:145], v131, s[52:55], 0 offen offset:0
    buffer_load_dwordx2 a[146:147], v131, s[52:55], 0 offen offset:1152
    buffer_load_dwordx2 a[148:149], v131, s[52:55], 0 offen offset:2304
    buffer_load_dwordx2 a[150:151], v131, s[52:55], 0 offen offset:3456
    s_waitcnt vmcnt(21)
M_place:
    v_mov_b32 v11, 163520
    s_waitcnt lgkmcnt(0)
    s_barrier
    buffer_store_dwordx2 v[238:239], v242, s[24:27], s21 offen sc1
    ds_read_b64 v[234:235], v11
    s_cmp_eq_u32 s3, 0
    s_cbranch_scc0 M_kvd
    s_mov_b32 s17, s47
    s_and_b32 s15, s8, 31
    s_mul_i32 s12, s15, 36
    s_sub_u32 s14, s15, 16
    s_mul_i32 s14, s14, 288
    s_cmp_ge_u32 s15, 16
    s_cselect_b32 s12, s14, s12
    s_cselect_b32 s18, 36, 4
    s_cselect_b64 vcc, -1, 0
    s_mul_i32 s12, s12, 1152
    s_mul_i32 s18, s18, 1152
    s_mul_i32 s14, s17, 144
    s_add_u32 s12, s12, s14
    s_mul_i32 s4, s15, 5120
    s_mul_i32 s5, s17, 92160
    s_add_u32 s4, s4, s5
    s_add_u32 s46, s4, 0x200000
    s_cmp_lt_u32 s15, 18
    s_cselect_b32 s12, s12, 0x40000000
    s_cselect_b32 s46, s46, 0x40000000
    v_cndmask_b32_e64 v8, v6, v7, vcc
    v_mul_u32_u24 v8, 1152, v8
    v_mad_u32_u24 v8, v4, 36, v8
    v_add_u32_e64 v9, s18, v8
    buffer_load_dwordx4 v[48:51], v8, s[56:59], s12 offen offset:0
    buffer_load_dwordx4 v[52:55], v9, s[56:59], s12 offen offset:0
    buffer_load_dwordx4 v[56:59], v8, s[56:59], s12 offen offset:16
    buffer_load_dwordx4 v[60:63], v9, s[56:59], s12 offen offset:16
    buffer_load_dwordx4 v[64:67], v8, s[56:59], s12 offen offset:32
    buffer_load_dwordx4 v[68:71], v9, s[56:59], s12 offen offset:32
M_kvd:
    v_mov_b32 v32, -1
    v_mov_b32 v33, -1
    v_mov_b32 v34, -1
    v_mov_b32 v35, -1
    s_mul_i32 s4, s3, 768
    v_add_u32 v28, s4, v2
    v_cmp_gt_u32 vcc, 48, v1
    s_nop 1
    v_cndmask_b32 v28, v241, v28, vcc
    buffer_store_dwordx4 v[32:35], v28, s[24:27], s73 offen sc1
    s_add_u32 s4, s67, 0x1500000
    buffer_store_dwordx4 v[32:35], v2, s[24:27], s4 offen sc1
    buffer_store_dwordx4 v[32:35], v2, s[24:27], s4 offen offset:1024 sc1
    s_lshl_b32 s4, s69, 10
    s_sub_u32 s4, 3072, s4
    v_lshrrev_b32 v29, 5, v1
    v_mad_u32_u24 v29, v29, s4, v2
    s_cmp_eq_u32 s3, 0
    s_cselect_b32 s4, s78, 0x40000000
    buffer_store_dwordx4 v[32:35], v29, s[24:27], s4 offen sc1
    s_add_u32 s4, s73, 0x400000
    buffer_store_dwordx4 v[32:35], v28, s[24:27], s4 offen sc1
    s_mul_i32 s11, s3, 7168
    v_add_u32 v5, 0x10000, v2
    v_add_u32 v12, 0x20000, v2
    v_add_u32 v0, 18432, v2
    v_lshlrev_b32_e64 v176, 3, v3
    v_lshl_add_u32 v251, v4, 8, v176
    s_mov_b32 s90, 0xffff
    s_mov_b32 s91, 0xffff
    v_and_b32 v188, 1, v4
    v_lshrrev_b32 v194, 1, v4
    s_lshl_b32 s80, s3, 5
    v_add_u32 v176, s80, v3
    v_mul_u32_u24 v176, 232, v176
    v_mul_u32_u24_e64 v177, 20, v4
    v_add3_u32 v177, v177, v176, 64
    v_add_u32 v177, 80, v177
    v_mul_u32_u24 v195, 72, v194
    v_add_u32_e64 v176, v176, v195
    v_lshl_add_u32 v250, v188, 2, v176
    v_lshl_add_u32 v176, v188, 5, v176
    v_bfe_u32 v178, v1, 2, 2
    v_lshl_add_u32 v178, v188, 2, v178
    v_lshlrev_b32 v178, 2, v178
    v_and_b32 v179, 2, v4
    v_add_u32_e64 v178, v178, v179
    v_mul_u32_u24 v178, 232, v178
    v_and_b32_e64 v179, 3, v1
    v_lshl_add_u32 v178, v179, 3, v178
    s_lshr_b32 s80, s3, 1
    s_and_b32 s81, s3, 1
    s_mul_i32 s82, s80, 72
    v_add_u32 v179, s82, v178
    s_mul_i32 s82, s80, 40
    s_lshl_b32 s83, s81, 5
    s_add_u32 s82, s82, s83
    s_add_u32 s82, s82, 144
    v_add_u32 v178, s82, v178
    s_mul_i32 s82, s80, 19
    s_lshl_b32 s83, s81, 4
    s_add_u32 s82, s82, s83
    v_add_u32_e64 v180, s82, v3
    v_mul_u32_u24 v180, 80, v180
    s_cmp_eq_u32 s81, 0
    s_cselect_b32 s83, 16, 3
    v_cmp_gt_u32 vcc, s83, v3
    s_nop 1
    v_cndmask_b32 v180, v241, v180, vcc
    v_cmp_eq_u32 vcc, 0, v4
    s_nop 1
    v_cndmask_b32 v181, v241, v180, vcc
    v_lshl_add_u32 v180, v188, 5, v180
    v_lshl_add_u32 v180, v194, 4, v180
    v_lshrrev_b32 v192, 2, v3
    v_and_b32 v193, 3, v3
    v_and_b32 v195, 1, v192
    v_lshrrev_b32 v196, 1, v192
    v_mul_u32_u24_e64 v189, 19, v196
    v_cmp_eq_u32 s[62:63], 1, v195
    v_add_u32 v190, 9, v193
    v_cmp_eq_u32 vcc, 0, v193
    v_mov_b32 v191, 8
    s_nop 0
    v_cndmask_b32_e64 v190, v190, v191, vcc
    v_cndmask_b32 v183, v193, v190, s[62:63]
    v_add_u32 v190, 13, v193
    v_add_u32 v191, 4, v193
    v_cndmask_b32 v184, v191, v190, s[62:63]
    v_add_u32 v190, 17, v193
    v_mov_b32 v191, 9
    v_cmp_eq_u32 vcc, 2, v193
    s_nop 1
    v_cndmask_b32 v185, v190, v191, vcc
    v_lshlrev_b32 v197, 5, v188
    v_add_u32 v197, 159744, v197
    v_add_u32_e64 v183, v183, v189
    v_mul_u32_u24 v183, 80, v183
    v_add_u32 v183, v183, v197
    v_add_u32 v184, v184, v189
    v_mul_u32_u24 v184, 80, v184
    v_add_u32 v184, v184, v197
    v_add_u32 v185, v185, v189
    v_mul_u32_u24 v185, 80, v185
    v_add_u32_e64 v185, v185, v197
    v_mov_b32 v191, 162816
    v_cmp_eq_u32 vcc, 3, v193
    s_nop 1
    v_cndmask_b32 v185, v185, v191, vcc
    v_lshlrev_b32 v190, 1, v195
    v_cmp_lt_u32 vcc, v193, v190
    s_nop 1
    v_cndmask_b32 v185, v185, v191, vcc
    v_cmp_ne_u32 vcc, v196, v194
    s_nop 1
    v_cndmask_b32 v183, v183, v191, vcc
    v_cndmask_b32 v184, v184, v191, vcc
    v_cndmask_b32 v185, v185, v191, vcc
    v_cmp_eq_u32 vcc, 0, v188
    s_nop 1
    v_cndmask_b32 v240, 0, 1.0, vcc
    v_lshlrev_b32_e64 v190, 4, v3
    v_lshl_add_u32 v244, v4, 9, v190
    v_lshl_add_u32 v245, v4, 2, v190
    v_mul_u32_u24_e64 v189, 18, v192
    v_lshl_add_u32 v189, v194, 2, v189
    v_add_u32 v189, v189, v193
    v_lshlrev_b32 v189, 12, v189
    v_lshl_add_u32 v246, v188, 4, v189
    v_cmp_gt_u32 vcc, 2, v4
    s_nop 1
    v_cndmask_b32_e64 v247, v241, v246, vcc
    s_mul_i32 s80, s3, 768
    v_lshl_add_u32 v249, v4, 3, v190
    s_add_u32 s81, s80, 159744
    v_add_u32_e64 v249, s81, v249
    v_mov_b32 v189, 162944
    v_cndmask_b32_e64 v249, v189, v249, vcc
    v_mul_u32_u24 v252, 3072, v4
    v_add3_u32 v252, v252, v190, s80
    s_cmp_eq_u32 s3, 3
    s_cselect_b32 s81, 14, 16
    v_cmp_gt_u32 vcc, s81, v3
    s_nop 1
    v_cndmask_b32 v253, v241, v252, vcc
    s_lshl_b32 s80, s3, 9
    v_lshlrev_b32_e64 v248, 5, v3
    v_lshl_add_u32 v248, v4, 3, v248
    v_add_u32 v248, s80, v248
    v_and_b32 v189, 1, v3
    v_lshlrev_b32_e64 v189, 4, v189
    v_mov_b32 v191, 0x3f80
    v_lshlrev_b32 v191, v189, v191
    v_lshrrev_b32 v189, 1, v3
    v_cmp_eq_u32 vcc, 0, v189
    s_nop 1
    v_cndmask_b32_e64 v190, 0, v191, vcc
    v_accvgpr_write_b32 a112, v190
    v_cmp_eq_u32 vcc, 1, v189
    s_nop 1
    v_cndmask_b32_e64 v190, 0, v191, vcc
    v_accvgpr_write_b32 a113, v190
    v_cmp_eq_u32 vcc, 2, v189
    s_nop 1
    v_cndmask_b32_e64 v190, 0, v191, vcc
    v_accvgpr_write_b32 a114, v190
    v_cmp_eq_u32 vcc, 3, v189
    s_nop 1
    v_cndmask_b32_e64 v190, 0, v191, vcc
    v_accvgpr_write_b32 a115, v190
    v_lshrrev_b32 v190, 3, v3
    v_xor_b32 v193, v190, v4
    v_sub_u32_e64 v190, v4, v190
    v_bfe_u32 v192, v3, 1, 2
    v_lshl_add_u32 v190, v190, 1, v192
    v_and_b32 v193, 1, v193
    v_cmp_eq_u32 vcc, 0, v193
    s_nop 1
    v_cndmask_b32 v191, 0, v191, vcc
    v_cmp_eq_u32 vcc, 0, v190
    s_nop 1
    v_cndmask_b32_e64 v189, 0, v191, vcc
    v_accvgpr_write_b32 a20, v189
    v_cmp_eq_u32 vcc, 1, v190
    s_nop 1
    v_cndmask_b32_e64 v189, 0, v191, vcc
    v_accvgpr_write_b32 a21, v189
    v_cmp_eq_u32 vcc, 2, v190
    s_nop 1
    v_cndmask_b32_e64 v189, 0, v191, vcc
    v_accvgpr_write_b32 a22, v189
    v_cmp_eq_u32 vcc, 3, v190
    s_nop 1
    v_cndmask_b32_e64 v189, 0, v191, vcc
    v_accvgpr_write_b32 a23, v189
    v_cmp_eq_u32 vcc, 4, v190
    s_nop 1
    v_cndmask_b32_e64 v189, 0, v191, vcc
    v_accvgpr_write_b32 a24, v189
    v_cmp_eq_u32 vcc, 5, v190
    s_nop 1
    v_cndmask_b32_e64 v189, 0, v191, vcc
    v_accvgpr_write_b32 a25, v189
    v_cmp_eq_u32 vcc, 6, v190
    s_nop 1
    v_cndmask_b32_e64 v189, 0, v191, vcc
    v_accvgpr_write_b32 a26, v189
    v_cmp_eq_u32 vcc, 7, v190
    s_nop 1
    v_cndmask_b32_e64 v189, 0, v191, vcc
    v_accvgpr_write_b32 a27, v189
    v_accvgpr_write_b32 a40, v176
    v_accvgpr_write_b32 a41, v177
    v_accvgpr_write_b32 a42, v178
    v_accvgpr_write_b32 a43, v179
    v_accvgpr_write_b32 a44, v180
    v_accvgpr_write_b32 a45, v181
    v_accvgpr_write_b32 a46, v183
    v_accvgpr_write_b32 a47, v184
    v_accvgpr_write_b32 a48, v185
    s_lshl_b32 s80, s66, 8
    s_add_u32 s80, s80, s65
    v_and_b32 v178, 1, v3
    v_lshrrev_b32 v179, 1, v3
    v_lshlrev_b32_e64 v180, 4, v4
    v_mul_u32_u24 v176, 4224, v178
    v_sub_u32 v176, 4280, v176
    v_lshl_add_u32 v176, v179, 3, v176
    v_sub_u32 v176, v176, v180
    v_add_u32 v176, s80, v176
    v_mul_u32_u24 v177, 4576, v178
    v_add_u32 v177, 8944, v177
    v_lshlrev_b32 v181, 6, v179
    v_sub_u32 v177, v177, v181
    v_sub_u32 v177, v177, v180
    v_add_u32 v177, s80, v177
    v_accvgpr_write_b32 a38, v176
    v_accvgpr_write_b32 a39, v177
    s_lshl_b32 s81, s3, 7
    s_add_u32 s81, s81, 135680
    s_sub_u32 s81, s81, s80
    s_add_u32 s82, s67, 0x400000
    s_add_u32 s83, s68, 0x400000
    v_mov_b32 v176, 0
    v_mov_b32 v177, 0
    v_mov_b32 v178, 0
    v_mov_b32 v179, 0
    v_add_u32 v180, 162816, v2
    s_mov_b64 exec, 0x1f
    ds_write_b128 v180, v[176:179]
    s_mov_b64 exec, -1
    s_waitcnt lgkmcnt(0)
    s_and_b32 s4, s64, 1
    s_lshl_b32 s4, s4, 4
    s_lshr_b32 s76, s76, s4
    s_lshl_b32 s76, s76, 16
    v_mov_b32 v176, s76
    v_accvgpr_write_b32 a18, v176
    s_and_b32 s4, s79, 1
    s_lshl_b32 s4, s4, 4
    s_lshr_b32 s77, s77, s4
    s_lshl_b32 s77, s77, 16
    v_mov_b32_e64 v176, s77
    v_accvgpr_write_b32 a19, v176
    s_lshl_b32 s4, s7, 7
    v_lshl_add_u32 v140, v3, 11, s4
    s_lshl_b32 s4, s47, 12
    s_sub_u32 s4, s4, 4096
    v_lshl_add_u32 v141, v1, 7, s4
    v_cmp_gt_u32 vcc, 32, v1
    s_nop 1
    v_cndmask_b32_e64 v233, v141, v140, vcc
    s_mul_i32 s10, s7, 129024
    s_and_b32 s17, s7, 7
    s_lshr_b32 s16, s7, 3
    s_lshl_b32 s18, s6, 1
    s_add_u32 s16, s16, s18
    s_lshl_b32 s18, s16, 2
    s_add_u32 s18, s18, s3
    s_mul_i32 s19, s18, 18432
    s_mul_i32 s61, s17, 92160
    s_add_u32 s61, s61, 0x200000
    s_lshl_b32 s71, s17, 11
    s_add_u32 s71, s71, s19
    s_add_u32 s71, s71, 0x1200000
    s_lshl_b32 s72, s17, 8
    s_add_u32 s72, s72, s19
    s_add_u32 s72, s72, 0x1204000
    s_lshl_b32 s80, s18, 4
    v_add_u32 v243, s80, v3
    v_mul_u32_u24 v243, 1152, v243
    v_mad_u32_u24 v243, v4, 36, v243
    v_accvgpr_read_b32 v6, a40
    v_accvgpr_read_b32 v7, a41
    v_accvgpr_read_b32 v8, a42
    v_accvgpr_read_b32 v9, a43
    v_accvgpr_read_b32 v10, a44
    v_accvgpr_read_b32 v11, a45
    v_accvgpr_read_b32 v13, a46
    v_accvgpr_read_b32 v14, a47
    v_accvgpr_read_b32 v15, a48
    s_add_u32 s58, s9, 0x700000
    s_mov_b32 s59, 0
    s_mov_b32 s44, 0x3fb8aa3b
    s_mov_b32 s45, 0x3fb8aa3b
    s_mov_b32 s60, 0
    s_mul_i32 s48, s17, 144
    s_mul_i32 s49, s17, 294912
    s_lshl_b32 s80, s18, 5
    s_add_u32 s49, s49, s80
    s_add_u32 s49, s49, 0x1500000
    s_lshl_b32 s50, s16, 14
    s_add_u32 s50, s50, 0x1800000
    v_mov_b32 v32, -1
    v_mov_b32 v33, -1
    v_mov_b32 v34, -1
    v_mov_b32_e64 v35, -1
    s_lshl_b32 s4, s7, 10
    s_add_u32 s4, s4, s9
    s_add_u32 s4, s4, 0xac0000
    buffer_store_dwordx4 v[32:35], v2, s[24:27], s4 offen
    buffer_store_dwordx4 v[32:35], v0, s[24:27], s4 offen
    s_add_u32 s4, s70, 0xac0000
    buffer_store_dwordx2 v[32:33], v242, s[24:27], s4 offen
    s_add_u32 s4, s4, 18432
    buffer_store_dwordx2 v[32:33], v242, s[24:27], s4 offen
    s_waitcnt vmcnt(10)
    v_lshlrev_b32 v136, 16, v108
    v_and_b32 v137, 0xffff0000, v108
    v_lshlrev_b32_e64 v138, 16, v109
    v_and_b32 v139, 0xffff0000, v109
    v_lshlrev_b32_e64 v140, 16, v110
    v_and_b32 v141, 0xffff0000, v110
    v_lshlrev_b32_e64 v142, 16, v111
    v_and_b32 v143, 0xffff0000, v111
    v_lshlrev_b32_e64 v144, 16, v112
    v_and_b32 v145, 0xffff0000, v112
    v_lshlrev_b32_e64 v146, 16, v113
    v_and_b32 v147, 0xffff0000, v113
    v_lshlrev_b32_e64 v148, 16, v114
    v_and_b32 v149, 0xffff0000, v114
    v_lshlrev_b32_e64 v150, 16, v115
    v_and_b32 v151, 0xffff0000, v115
    v_lshlrev_b32_e64 v152, 16, v116
    v_and_b32 v153, 0xffff0000, v116
    v_lshlrev_b32_e64 v154, 16, v117
    v_and_b32 v155, 0xffff0000, v117
    v_lshlrev_b32_e64 v156, 16, v118
    v_and_b32 v157, 0xffff0000, v118
    v_lshlrev_b32_e64 v158, 16, v119
    v_and_b32 v159, 0xffff0000, v119
    v_lshlrev_b32_e64 v160, 16, v120
    v_and_b32 v161, 0xffff0000, v120
    v_lshlrev_b32_e64 v162, 16, v121
    v_and_b32 v163, 0xffff0000, v121
    v_lshlrev_b32_e64 v164, 16, v122
    v_and_b32 v165, 0xffff0000, v122
    v_lshlrev_b32_e64 v166, 16, v123
    v_and_b32 v167, 0xffff0000, v123
    v_lshlrev_b32_e64 v168, 16, v124
    v_and_b32 v169, 0xffff0000, v124
    v_lshlrev_b32_e64 v170, 16, v125
    v_and_b32 v171, 0xffff0000, v125
    v_lshlrev_b32_e64 v172, 16, v126
    v_and_b32 v173, 0xffff0000, v126
    v_lshlrev_b32_e64 v174, 16, v127
    v_and_b32 v175, 0xffff0000, v127
    v_lshlrev_b32_e64 v176, 16, v128
    v_and_b32 v177, 0xffff0000, v128
    v_lshlrev_b32_e64 v178, 16, v129
    v_and_b32 v179, 0xffff0000, v129
    v_accvgpr_read_b32 v196, a128
    v_accvgpr_read_b32 v197, a129
    v_accvgpr_read_b32 v198, a130
    v_accvgpr_read_b32 v199, a131
    v_accvgpr_read_b32 v200, a132
    v_accvgpr_read_b32 v201, a133
    v_accvgpr_read_b32 v202, a134
    v_accvgpr_read_b32 v203, a135
    v_accvgpr_read_b32 v124, a51
    v_lshlrev_b32_e64 v180, 16, v196
    v_and_b32 v184, 0xffff0000, v196
    v_lshlrev_b32_e64 v188, 16, v197
    v_and_b32 v192, 0xffff0000, v197
    v_lshlrev_b32_e64 v181, 16, v198
    v_and_b32 v185, 0xffff0000, v198
    v_lshlrev_b32_e64 v189, 16, v199
    v_and_b32 v193, 0xffff0000, v199
    v_lshlrev_b32_e64 v182, 16, v200
    v_and_b32 v186, 0xffff0000, v200
    v_lshlrev_b32_e64 v190, 16, v201
    v_and_b32 v194, 0xffff0000, v201
    v_lshlrev_b32_e64 v183, 16, v202
    v_and_b32 v187, 0xffff0000, v202
    v_lshlrev_b32_e64 v191, 16, v203
    v_and_b32 v195, 0xffff0000, v203
    v_accvgpr_read_b32 v108, a136
    v_accvgpr_read_b32 v109, a137
    v_accvgpr_read_b32 v110, a138
    v_accvgpr_read_b32 v111, a139
    v_accvgpr_read_b32 v112, a140
    v_accvgpr_read_b32 v113, a141
    v_accvgpr_read_b32 v114, a142
    v_accvgpr_read_b32 v115, a143
    v_accvgpr_read_b32 v116, a144
    v_accvgpr_read_b32 v117, a145
    v_accvgpr_read_b32 v118, a146
    v_accvgpr_read_b32 v119, a147
    v_accvgpr_read_b32 v120, a148
    v_accvgpr_read_b32 v121, a149
    v_accvgpr_read_b32 v122, a150
    v_accvgpr_read_b32 v123, a151
    v_pk_mul_f32 v[136:137], v[136:137], v[192:193]
    v_pk_mul_f32 v[138:139], v[138:139], v[194:195]
    v_pk_fma_f32 v[136:137], v[140:141], v[188:189], v[136:137]
    v_pk_fma_f32 v[138:139], v[142:143], v[190:191], v[138:139]
    v_pk_fma_f32 v[136:137], v[144:145], v[184:185], v[136:137]
    v_pk_fma_f32 v[138:139], v[146:147], v[186:187], v[138:139]
    v_pk_fma_f32 v[136:137], v[148:149], v[180:181], v[136:137]
    v_pk_fma_f32 v[138:139], v[150:151], v[182:183], v[138:139]
    v_pk_mul_f32 v[140:141], v[140:141], v[192:193]
    v_pk_mul_f32 v[142:143], v[142:143], v[194:195]
    v_pk_fma_f32 v[140:141], v[144:145], v[188:189], v[140:141]
    v_pk_fma_f32 v[142:143], v[146:147], v[190:191], v[142:143]
    v_pk_fma_f32 v[140:141], v[148:149], v[184:185], v[140:141]
    v_pk_fma_f32 v[142:143], v[150:151], v[186:187], v[142:143]
    v_pk_fma_f32 v[140:141], v[152:153], v[180:181], v[140:141]
    v_pk_fma_f32 v[142:143], v[154:155], v[182:183], v[142:143]
    v_pk_mul_f32 v[144:145], v[144:145], v[192:193]
    v_pk_mul_f32 v[146:147], v[146:147], v[194:195]
    v_pk_fma_f32 v[144:145], v[148:149], v[188:189], v[144:145]
    v_pk_fma_f32 v[146:147], v[150:151], v[190:191], v[146:147]
    v_pk_fma_f32 v[144:145], v[152:153], v[184:185], v[144:145]
    v_pk_fma_f32 v[146:147], v[154:155], v[186:187], v[146:147]
    v_pk_fma_f32 v[144:145], v[156:157], v[180:181], v[144:145]
    v_pk_fma_f32 v[146:147], v[158:159], v[182:183], v[146:147]
    v_pk_mul_f32 v[148:149], v[148:149], v[192:193]
    v_pk_mul_f32 v[150:151], v[150:151], v[194:195]
    v_pk_fma_f32 v[148:149], v[152:153], v[188:189], v[148:149]
    v_pk_fma_f32 v[150:151], v[154:155], v[190:191], v[150:151]
    v_pk_fma_f32 v[148:149], v[156:157], v[184:185], v[148:149]
    v_pk_fma_f32 v[150:151], v[158:159], v[186:187], v[150:151]
    v_pk_fma_f32 v[148:149], v[160:161], v[180:181], v[148:149]
    v_pk_fma_f32 v[150:151], v[162:163], v[182:183], v[150:151]
    v_pk_mul_f32 v[152:153], v[152:153], v[192:193]
    v_pk_mul_f32 v[154:155], v[154:155], v[194:195]
    v_pk_fma_f32 v[152:153], v[156:157], v[188:189], v[152:153]
    v_pk_fma_f32 v[154:155], v[158:159], v[190:191], v[154:155]
    v_pk_fma_f32 v[152:153], v[160:161], v[184:185], v[152:153]
    v_pk_fma_f32 v[154:155], v[162:163], v[186:187], v[154:155]
    v_pk_fma_f32 v[152:153], v[164:165], v[180:181], v[152:153]
    v_pk_fma_f32 v[154:155], v[166:167], v[182:183], v[154:155]
    v_pk_mul_f32 v[156:157], v[156:157], v[192:193]
    v_pk_mul_f32 v[158:159], v[158:159], v[194:195]
    v_pk_fma_f32 v[156:157], v[160:161], v[188:189], v[156:157]
    v_pk_fma_f32 v[158:159], v[162:163], v[190:191], v[158:159]
    v_pk_fma_f32 v[156:157], v[164:165], v[184:185], v[156:157]
    v_pk_fma_f32 v[158:159], v[166:167], v[186:187], v[158:159]
    v_pk_fma_f32 v[156:157], v[168:169], v[180:181], v[156:157]
    v_pk_fma_f32 v[158:159], v[170:171], v[182:183], v[158:159]
    v_pk_mul_f32 v[160:161], v[160:161], v[192:193]
    v_pk_mul_f32 v[162:163], v[162:163], v[194:195]
    v_pk_fma_f32 v[160:161], v[164:165], v[188:189], v[160:161]
    v_pk_fma_f32 v[162:163], v[166:167], v[190:191], v[162:163]
    v_pk_fma_f32 v[160:161], v[168:169], v[184:185], v[160:161]
    v_pk_fma_f32 v[162:163], v[170:171], v[186:187], v[162:163]
    v_pk_fma_f32 v[160:161], v[172:173], v[180:181], v[160:161]
    v_pk_fma_f32 v[162:163], v[174:175], v[182:183], v[162:163]
    v_pk_mul_f32 v[164:165], v[164:165], v[192:193]
    v_pk_mul_f32 v[166:167], v[166:167], v[194:195]
    v_pk_fma_f32 v[164:165], v[168:169], v[188:189], v[164:165]
    v_pk_fma_f32 v[166:167], v[170:171], v[190:191], v[166:167]
    v_pk_fma_f32 v[164:165], v[172:173], v[184:185], v[164:165]
    v_pk_fma_f32 v[166:167], v[174:175], v[186:187], v[166:167]
    v_pk_fma_f32 v[164:165], v[176:177], v[180:181], v[164:165]
    v_pk_fma_f32 v[166:167], v[178:179], v[182:183], v[166:167]
    v_lshlrev_b32_e64 v196, 16, v108
    v_and_b32 v197, 0xffff0000, v108
    v_lshlrev_b32_e64 v198, 16, v109
    v_and_b32 v199, 0xffff0000, v109
    v_pk_mul_f32 v[136:137], v[136:137], v[196:197]
    v_pk_mul_f32 v[138:139], v[138:139], v[198:199]
    v_lshlrev_b32_e64 v200, 16, v110
    v_and_b32 v201, 0xffff0000, v110
    v_lshlrev_b32_e64 v202, 16, v111
    v_and_b32 v203, 0xffff0000, v111
    v_pk_mul_f32 v[140:141], v[140:141], v[200:201]
    v_pk_mul_f32 v[142:143], v[142:143], v[202:203]
    v_lshlrev_b32_e64 v204, 16, v112
    v_and_b32 v205, 0xffff0000, v112
    v_lshlrev_b32_e64 v206, 16, v113
    v_and_b32 v207, 0xffff0000, v113
    v_pk_mul_f32 v[144:145], v[144:145], v[204:205]
    v_pk_mul_f32 v[146:147], v[146:147], v[206:207]
    v_lshlrev_b32_e64 v208, 16, v114
    v_and_b32 v209, 0xffff0000, v114
    v_lshlrev_b32_e64 v210, 16, v115
    v_and_b32 v211, 0xffff0000, v115
    v_pk_mul_f32 v[148:149], v[148:149], v[208:209]
    v_pk_mul_f32 v[150:151], v[150:151], v[210:211]
    v_lshlrev_b32_e64 v196, 16, v116
    v_and_b32 v197, 0xffff0000, v116
    v_lshlrev_b32_e64 v198, 16, v117
    v_and_b32 v199, 0xffff0000, v117
    v_pk_mul_f32 v[152:153], v[152:153], v[196:197]
    v_pk_mul_f32 v[154:155], v[154:155], v[198:199]
    v_lshlrev_b32_e64 v200, 16, v118
    v_and_b32 v201, 0xffff0000, v118
    v_lshlrev_b32_e64 v202, 16, v119
    v_and_b32 v203, 0xffff0000, v119
    v_pk_mul_f32 v[156:157], v[156:157], v[200:201]
    v_pk_mul_f32 v[158:159], v[158:159], v[202:203]
    v_lshlrev_b32_e64 v204, 16, v120
    v_and_b32 v205, 0xffff0000, v120
    v_lshlrev_b32_e64 v206, 16, v121
    v_and_b32 v207, 0xffff0000, v121
    v_pk_mul_f32 v[160:161], v[160:161], v[204:205]
    v_pk_mul_f32 v[162:163], v[162:163], v[206:207]
    v_lshlrev_b32_e64 v208, 16, v122
    v_and_b32 v209, 0xffff0000, v122
    v_lshlrev_b32_e64 v210, 16, v123
    v_and_b32 v211, 0xffff0000, v123
    v_pk_mul_f32 v[164:165], v[164:165], v[208:209]
    v_pk_mul_f32 v[166:167], v[166:167], v[210:211]
    v_cvt_pk_bf16_f32 v108, v164, v160
    v_cvt_pk_bf16_f32 v109, v156, v152
    v_cvt_pk_bf16_f32 v110, v148, v144
    v_cvt_pk_bf16_f32 v111, v140, v136
    s_movk_i32 s5, 0
    buffer_store_dwordx4 v[108:111], v124, s[24:27], s5 offen
    v_cvt_pk_bf16_f32 v112, v165, v161
    v_cvt_pk_bf16_f32 v113, v157, v153
    v_cvt_pk_bf16_f32 v114, v149, v145
    v_cvt_pk_bf16_f32 v115, v141, v137
    s_movk_i32 s5, 4096
    buffer_store_dwordx4 v[112:115], v124, s[24:27], s5 offen
    v_cvt_pk_bf16_f32 v116, v166, v162
    v_cvt_pk_bf16_f32 v117, v158, v154
    v_cvt_pk_bf16_f32 v118, v150, v146
    v_cvt_pk_bf16_f32 v119, v142, v138
    s_movk_i32 s5, 8192
    buffer_store_dwordx4 v[116:119], v124, s[24:27], s5 offen
    v_cvt_pk_bf16_f32 v120, v167, v163
    v_cvt_pk_bf16_f32 v121, v159, v155
    v_cvt_pk_bf16_f32 v122, v151, v147
    v_cvt_pk_bf16_f32 v123, v143, v139
    s_movk_i32 s5, 12288
    buffer_store_dwordx4 v[120:123], v124, s[24:27], s5 offen
    s_cmp_eq_u32 s3, 0
    s_cbranch_scc0 M_udone
    v_mov_b32 v20, 0
    v_mov_b32 v21, 0
    v_mov_b32 v24, 0
    v_mov_b32 v25, 0
    v_and_b32 v18, 1, v3
    v_lshlrev_b32 v18, 4, v18
    v_mov_b32 v19, 0x3f80
    v_lshlrev_b32 v19, v18, v19
    v_lshrrev_b32 v18, 2, v3
    v_cmp_eq_u32 vcc, v18, v4
    s_nop 1
    v_cndmask_b32 v19, 0, v19, vcc
    v_and_b32 v18, 2, v3
    v_cmp_eq_u32 vcc, 0, v18
    s_nop 1
    v_cndmask_b32 v22, 0, v19, vcc
    v_cndmask_b32 v23, v19, v20, vcc
    s_add_u32 s5, s46, 4096
    s_waitcnt vmcnt(13)
    v_mfma_f32_16x16x32_bf16 v[148:151], v[48:51], v[22:25], 0
    v_mfma_f32_16x16x32_bf16 v[152:155], v[52:55], v[22:25], 0
    v_mfma_f32_16x16x32_bf16 v[156:159], v[48:51], v[20:23], 0
    v_mfma_f32_16x16x32_bf16 v[160:163], v[52:55], v[20:23], 0
    v_mfma_f32_16x16x32_bf16 v[164:167], v[56:59], v[22:25], 0
    v_mfma_f32_16x16x32_bf16 v[168:171], v[60:63], v[22:25], 0
    v_mfma_f32_16x16x32_bf16 v[172:175], v[56:59], v[20:23], 0
    v_mfma_f32_16x16x32_bf16 v[176:179], v[60:63], v[20:23], 0
    v_mfma_f32_16x16x32_bf16 v[180:183], v[64:67], v[22:25], 0
    v_mfma_f32_16x16x32_bf16 v[184:187], v[68:71], v[22:25], 0
    s_nop 0
    v_cvt_pk_bf16_f32 v48, v148, v149
    v_cvt_pk_bf16_f32 v49, v150, v151
    v_cvt_pk_bf16_f32 v50, v152, v153
    v_cvt_pk_bf16_f32 v51, v154, v155
    buffer_store_dwordx4 v[48:51], v2, s[24:27], s46 offen offset:0 sc1
    v_cvt_pk_bf16_f32 v52, v156, v157
    v_cvt_pk_bf16_f32 v53, v158, v159
    v_cvt_pk_bf16_f32 v54, v160, v161
    v_cvt_pk_bf16_f32 v55, v162, v163
    buffer_store_dwordx4 v[52:55], v2, s[24:27], s46 offen offset:1024 sc1
    v_cvt_pk_bf16_f32 v56, v164, v165
    v_cvt_pk_bf16_f32 v57, v166, v167
    v_cvt_pk_bf16_f32 v58, v168, v169
    v_cvt_pk_bf16_f32 v59, v170, v171
    buffer_store_dwordx4 v[56:59], v2, s[24:27], s46 offen offset:2048 sc1
    v_cvt_pk_bf16_f32 v60, v172, v173
    v_cvt_pk_bf16_f32 v61, v174, v175
    v_cvt_pk_bf16_f32 v62, v176, v177
    v_cvt_pk_bf16_f32 v63, v178, v179
    buffer_store_dwordx4 v[60:63], v2, s[24:27], s46 offen offset:3072 sc1
    v_cvt_pk_bf16_f32 v64, v180, v181
    v_cvt_pk_bf16_f32 v65, v182, v183
    v_cvt_pk_bf16_f32 v66, v184, v185
    v_cvt_pk_bf16_f32 v67, v186, v187
    buffer_store_dwordx4 v[64:67], v2, s[24:27], s5 offen offset:0 sc1
M_udone:
    s_waitcnt lgkmcnt(0)
    v_readfirstlane_b32 s88, v234
    v_readfirstlane_b32 s89, v235
    s_mov_b32 s75, 0
M_flag:
    buffer_load_dwordx2 v[16:17], v233, s[24:27], s20 offen sc1
    s_add_u32 s75, s75, 1
    s_waitcnt vmcnt(0)
    v_xor_b32 v18, s89, v17
    v_cmp_ne_u32 vcc, s88, v16
    v_cmp_lt_u32 s[62:63], 15, v18
    v_cmp_ne_u32 s[4:5], 0, v18
    s_or_b64 vcc, vcc, s[62:63]
    s_cmp_lt_u32 s75, 20000
    s_cbranch_scc0 M_flag_ok
    s_cbranch_vccnz M_flag
M_flag_ok:
    s_mov_b32 s8, s5
    s_cmp_lg_u32 s8, 0
    s_cbranch_scc1 M_pfg
M_pfb:
    s_lshl_b32 s14, s3, 12
    s_min_u32 s14, s14, 10240
    s_add_u32 s13, s14, 0
    s_add_u32 s14, s14, s10
    s_mov_b32 m0, s13
    s_nop 0
    buffer_load_dwordx4 v2, s[24:27], s14 offen offset:0 lds
    buffer_load_dwordx4 v2, s[24:27], s14 offen offset:1024 lds
    buffer_load_dwordx4 v2, s[24:27], s14 offen offset:2048 lds
    buffer_load_dwordx4 v2, s[24:27], s14 offen offset:3072 lds
    s_add_u32 s12, s58, 0
    buffer_load_dwordx4 v[232:235], v2, s[24:27], s12 offen offset:0
    buffer_load_dwordx4 v[236:239], v0, s[24:27], s12 offen offset:0
    buffer_load_dwordx4 v[224:227], v2, s[24:27], s12 offen offset:1024
    buffer_load_dwordx4 v[228:231], v0, s[24:27], s12 offen offset:1024
    s_add_u32 s13, s11, 14336
    s_add_u32 s14, s11, 14336
    s_add_u32 s14, s14, s10
    s_mov_b32 m0, s13
    s_nop 0
    s_nop 0
    buffer_load_dwordx4 v2, s[24:27], s14 offen offset:0 lds
    buffer_load_dwordx4 v2, s[24:27], s14 offen offset:1024 lds
    buffer_load_dwordx4 v2, s[24:27], s14 offen offset:2048 lds
    buffer_load_dwordx4 v2, s[24:27], s14 offen offset:3072 lds
    s_add_u32 s13, s13, 4096
    s_add_u32 s14, s14, 4096
    s_mov_b32 m0, s13
    s_nop 0
    buffer_load_dwordx4 v2, s[24:27], s14 offen offset:0 lds
    buffer_load_dwordx4 v2, s[24:27], s14 offen offset:1024 lds
    buffer_load_dwordx4 v2, s[24:27], s14 offen offset:2048 lds
    s_add_u32 s12, s58, 0
    s_nop 0
    buffer_load_dwordx4 v[216:219], v2, s[24:27], s12 offen offset:2048
    buffer_load_dwordx4 v[220:223], v0, s[24:27], s12 offen offset:2048
    buffer_load_dwordx4 v[208:211], v2, s[24:27], s12 offen offset:3072
    buffer_load_dwordx4 v[212:215], v0, s[24:27], s12 offen offset:3072
    s_add_u32 s12, s58, 4096
    buffer_load_dwordx4 v[200:203], v2, s[24:27], s12 offen offset:0
    s_waitcnt vmcnt(16)
    v_mov_b32 v34, s88
    v_mov_b32_e64 v35, s89
    s_add_u32 s4, s21, 0x8000
    s_barrier
    s_nop 0
    buffer_store_dwordx2 v[34:35], v242, s[24:27], s4 offen sc1
    ds_read_b128 a[72:75], v2 offset:0
    ds_read_b128 a[76:79], v2 offset:1024
    ds_read_b128 a[80:83], v2 offset:2048
    ds_read_b128 a[84:87], v2 offset:3072
    ds_read_b128 a[88:91], v2 offset:4096
    ds_read_b128 a[92:95], v2 offset:5120
    ds_read_b128 a[96:99], v2 offset:6144
    ds_read_b128 a[100:103], v2 offset:7168
    ds_read_b128 a[104:107], v2 offset:8192
    s_waitcnt vmcnt(15)
    s_waitcnt lgkmcnt(7)
    v_mfma_f32_16x16x32_bf16 v[40:43], a[72:75], v[232:235], 0
    v_mfma_f32_16x16x32_bf16 v[68:71], a[72:75], v[236:239], 0
    buffer_load_dwordx4 v[204:207], v0, s[24:27], s12 offen offset:0
    ds_read_b128 a[108:111], v2 offset:9216
    v_mfma_f32_16x16x32_bf16 v[44:47], a[76:79], v[232:235], 0
    v_mfma_f32_16x16x32_bf16 v[72:75], a[76:79], v[236:239], 0
    buffer_load_dwordx4 v[192:195], v2, s[24:27], s12 offen offset:1024
    ds_read_b128 a[72:75], v2 offset:10240
    s_waitcnt lgkmcnt(7)
    v_mfma_f32_16x16x32_bf16 v[48:51], a[80:83], v[232:235], 0
    v_mfma_f32_16x16x32_bf16 v[76:79], a[80:83], v[236:239], 0
    buffer_load_dwordx4 v[196:199], v0, s[24:27], s12 offen offset:1024
    ds_read_b128 a[76:79], v2 offset:11264
    v_mfma_f32_16x16x32_bf16 v[52:55], a[84:87], v[232:235], 0
    v_mfma_f32_16x16x32_bf16 v[80:83], a[84:87], v[236:239], 0
    s_add_u32 s13, s11, 100352
    s_add_u32 s14, s11, 100352
    s_add_u32 s14, s14, s10
    s_mov_b32 m0, s13
    s_nop 0
    buffer_load_dwordx4 v2, s[24:27], s14 offen offset:0 lds
    ds_read_b128 a[80:83], v2 offset:12288
    s_waitcnt lgkmcnt(7)
    v_mfma_f32_16x16x32_bf16 v[56:59], a[88:91], v[232:235], 0
    v_mfma_f32_16x16x32_bf16 v[84:87], a[88:91], v[236:239], 0
    buffer_load_dwordx4 v2, s[24:27], s14 offen offset:1024 lds
    ds_read_b128 a[84:87], v2 offset:13312
    v_mfma_f32_16x16x32_bf16 v[60:63], a[92:95], v[232:235], 0
    v_mfma_f32_16x16x32_bf16 v[88:91], a[92:95], v[236:239], 0
    buffer_load_dwordx4 v2, s[24:27], s14 offen offset:2048 lds
    s_waitcnt vmcnt(12)
    s_barrier
    ds_read_b128 a[88:91], v2 offset:14336
    s_waitcnt lgkmcnt(7)
    v_mfma_f32_16x16x32_bf16 v[64:67], a[96:99], v[232:235], 0
    v_mfma_f32_16x16x32_bf16 v[92:95], a[96:99], v[236:239], 0
    buffer_load_dwordx4 v2, s[24:27], s14 offen offset:3072 lds
    ds_read_b128 a[92:95], v2 offset:15360
    v_mfma_f32_16x16x32_bf16 v[40:43], a[100:103], v[224:227], v[40:43]
    v_mfma_f32_16x16x32_bf16 v[68:71], a[100:103], v[228:231], v[68:71]
    s_add_u32 s13, s13, 4096
    s_add_u32 s14, s14, 4096
    s_mov_b32 m0, s13
    s_nop 0
    buffer_load_dwordx4 v2, s[24:27], s14 offen offset:0 lds
    ds_read_b128 a[96:99], v2 offset:16384
    s_waitcnt lgkmcnt(7)
    v_mfma_f32_16x16x32_bf16 v[44:47], a[104:107], v[224:227], v[44:47]
    v_mfma_f32_16x16x32_bf16 v[72:75], a[104:107], v[228:231], v[72:75]
    buffer_load_dwordx4 v2, s[24:27], s14 offen offset:1024 lds
    ds_read_b128 a[100:103], v2 offset:17408
    v_mfma_f32_16x16x32_bf16 v[48:51], a[108:111], v[224:227], v[48:51]
    v_mfma_f32_16x16x32_bf16 v[76:79], a[108:111], v[228:231], v[76:79]
    buffer_load_dwordx4 v2, s[24:27], s14 offen offset:2048 lds
    ds_read_b128 a[104:107], v2 offset:18432
    s_waitcnt lgkmcnt(7)
    v_mfma_f32_16x16x32_bf16 v[52:55], a[72:75], v[224:227], v[52:55]
    v_mfma_f32_16x16x32_bf16 v[80:83], a[72:75], v[228:231], v[80:83]
    s_add_u32 s12, s58, 12288
    buffer_load_dwordx4 v[120:123], v2, s[24:27], s12 offen offset:2048
    ds_read_b128 a[108:111], v2 offset:19456
    v_mfma_f32_16x16x32_bf16 v[56:59], a[76:79], v[224:227], v[56:59]
    v_mfma_f32_16x16x32_bf16 v[84:87], a[76:79], v[228:231], v[84:87]
    buffer_load_dwordx4 v[124:127], v0, s[24:27], s12 offen offset:2048
    ds_read_b128 a[72:75], v2 offset:20480
    s_waitcnt lgkmcnt(7)
    v_mfma_f32_16x16x32_bf16 v[60:63], a[80:83], v[224:227], v[60:63]
    v_mfma_f32_16x16x32_bf16 v[88:91], a[80:83], v[228:231], v[88:91]
    buffer_load_dwordx4 v[112:115], v2, s[24:27], s12 offen offset:3072
    ds_read_b128 a[76:79], v2 offset:21504
    v_mfma_f32_16x16x32_bf16 v[64:67], a[84:87], v[224:227], v[64:67]
    v_mfma_f32_16x16x32_bf16 v[92:95], a[84:87], v[228:231], v[92:95]
    buffer_load_dwordx4 v[116:119], v0, s[24:27], s12 offen offset:3072
    ds_read_b128 a[80:83], v2 offset:22528
    s_waitcnt vmcnt(18)
    s_waitcnt lgkmcnt(7)
    v_mfma_f32_16x16x32_bf16 v[40:43], a[88:91], v[216:219], v[40:43]
    v_mfma_f32_16x16x32_bf16 v[68:71], a[88:91], v[220:223], v[68:71]
    s_add_u32 s12, s58, 16384
    buffer_load_dwordx4 v[104:107], v2, s[24:27], s12 offen offset:0
    ds_read_b128 a[84:87], v2 offset:23552
    v_mfma_f32_16x16x32_bf16 v[44:47], a[92:95], v[216:219], v[44:47]
    v_mfma_f32_16x16x32_bf16 v[72:75], a[92:95], v[220:223], v[72:75]
    buffer_load_dwordx4 v[108:111], v0, s[24:27], s12 offen offset:0
    ds_read_b128 a[88:91], v2 offset:24576
    s_waitcnt lgkmcnt(7)
    v_mfma_f32_16x16x32_bf16 v[48:51], a[96:99], v[216:219], v[48:51]
    v_mfma_f32_16x16x32_bf16 v[76:79], a[96:99], v[220:223], v[76:79]
    buffer_load_dwordx4 v[96:99], v2, s[24:27], s12 offen offset:1024
    ds_read_b128 a[92:95], v2 offset:25600
    v_mfma_f32_16x16x32_bf16 v[52:55], a[100:103], v[216:219], v[52:55]
    v_mfma_f32_16x16x32_bf16 v[80:83], a[100:103], v[220:223], v[80:83]
    buffer_load_dwordx4 v[100:103], v0, s[24:27], s12 offen offset:1024
    ds_read_b128 a[96:99], v2 offset:26624
    s_waitcnt lgkmcnt(7)
    v_mfma_f32_16x16x32_bf16 v[56:59], a[104:107], v[216:219], v[56:59]
    v_mfma_f32_16x16x32_bf16 v[84:87], a[104:107], v[220:223], v[84:87]
    s_add_u32 s13, s11, 43008
    s_add_u32 s14, s11, 43008
    s_add_u32 s14, s14, s10
    s_mov_b32 m0, s13
    s_nop 0
    buffer_load_dwordx4 v2, s[24:27], s14 offen offset:0 lds
    ds_read_b128 a[100:103], v2 offset:27648
    v_mfma_f32_16x16x32_bf16 v[60:63], a[108:111], v[216:219], v[60:63]
    v_mfma_f32_16x16x32_bf16 v[88:91], a[108:111], v[220:223], v[88:91]
    buffer_load_dwordx4 v2, s[24:27], s14 offen offset:1024 lds
    ds_read_b128 a[104:107], v2 offset:28672
    s_waitcnt lgkmcnt(7)
    v_mfma_f32_16x16x32_bf16 v[64:67], a[72:75], v[216:219], v[64:67]
    v_mfma_f32_16x16x32_bf16 v[92:95], a[72:75], v[220:223], v[92:95]
    buffer_load_dwordx4 v2, s[24:27], s14 offen offset:2048 lds
    ds_read_b128 a[108:111], v2 offset:29696
    s_waitcnt vmcnt(23)
    v_mfma_f32_16x16x32_bf16 v[40:43], a[76:79], v[208:211], v[40:43]
    v_mfma_f32_16x16x32_bf16 v[68:71], a[76:79], v[212:215], v[68:71]
    buffer_load_dwordx4 v2, s[24:27], s14 offen offset:3072 lds
    ds_read_b128 a[72:75], v2 offset:30720
    s_waitcnt lgkmcnt(7)
    v_mfma_f32_16x16x32_bf16 v[44:47], a[80:83], v[208:211], v[44:47]
    v_mfma_f32_16x16x32_bf16 v[72:75], a[80:83], v[212:215], v[72:75]
    s_add_u32 s13, s13, 4096
    s_add_u32 s14, s14, 4096
    s_mov_b32 m0, s13
    s_nop 0
    buffer_load_dwordx4 v2, s[24:27], s14 offen offset:0 lds
    ds_read_b128 a[76:79], v2 offset:31744
    v_mfma_f32_16x16x32_bf16 v[48:51], a[84:87], v[208:211], v[48:51]
    v_mfma_f32_16x16x32_bf16 v[76:79], a[84:87], v[212:215], v[76:79]
    buffer_load_dwordx4 v2, s[24:27], s14 offen offset:1024 lds
    ds_read_b128 a[80:83], v2 offset:32768
    s_waitcnt lgkmcnt(7)
    v_mfma_f32_16x16x32_bf16 v[52:55], a[88:91], v[208:211], v[52:55]
    v_mfma_f32_16x16x32_bf16 v[80:83], a[88:91], v[212:215], v[80:83]
    buffer_load_dwordx4 v2, s[24:27], s14 offen offset:2048 lds
    ds_read_b128 a[84:87], v2 offset:33792
    v_mfma_f32_16x16x32_bf16 v[56:59], a[92:95], v[208:211], v[56:59]
    v_mfma_f32_16x16x32_bf16 v[84:87], a[92:95], v[212:215], v[84:87]
    s_add_u32 s12, s58, 4096
    buffer_load_dwordx4 v[184:187], v2, s[24:27], s12 offen offset:2048
    ds_read_b128 a[88:91], v2 offset:34816
    s_waitcnt lgkmcnt(7)
    v_mfma_f32_16x16x32_bf16 v[60:63], a[96:99], v[208:211], v[60:63]
    v_mfma_f32_16x16x32_bf16 v[88:91], a[96:99], v[212:215], v[88:91]
    buffer_load_dwordx4 v[188:191], v0, s[24:27], s12 offen offset:2048
    ds_read_b128 a[92:95], v2 offset:35840
    v_mfma_f32_16x16x32_bf16 v[64:67], a[100:103], v[208:211], v[64:67]
    v_mfma_f32_16x16x32_bf16 v[92:95], a[100:103], v[212:215], v[92:95]
    buffer_load_dwordx4 v[176:179], v2, s[24:27], s12 offen offset:3072
    ds_read_b128 a[96:99], v2 offset:36864
    s_waitcnt vmcnt(27)
    s_waitcnt lgkmcnt(7)
    v_mfma_f32_16x16x32_bf16 v[40:43], a[104:107], v[200:203], v[40:43]
    v_mfma_f32_16x16x32_bf16 v[68:71], a[104:107], v[204:207], v[68:71]
    buffer_load_dwordx4 v[180:183], v0, s[24:27], s12 offen offset:3072
    ds_read_b128 a[100:103], v2 offset:37888
    v_mfma_f32_16x16x32_bf16 v[44:47], a[108:111], v[200:203], v[44:47]
    v_mfma_f32_16x16x32_bf16 v[72:75], a[108:111], v[204:207], v[72:75]
    s_add_u32 s12, s58, 8192
    buffer_load_dwordx4 v[168:171], v2, s[24:27], s12 offen offset:0
    ds_read_b128 a[104:107], v2 offset:38912
    s_waitcnt lgkmcnt(7)
    v_mfma_f32_16x16x32_bf16 v[48:51], a[72:75], v[200:203], v[48:51]
    v_mfma_f32_16x16x32_bf16 v[76:79], a[72:75], v[204:207], v[76:79]
    buffer_load_dwordx4 v[172:175], v0, s[24:27], s12 offen offset:0
    ds_read_b128 a[108:111], v2 offset:39936
    v_mfma_f32_16x16x32_bf16 v[52:55], a[76:79], v[200:203], v[52:55]
    v_mfma_f32_16x16x32_bf16 v[80:83], a[76:79], v[204:207], v[80:83]
    ds_read_b128 a[72:75], v2 offset:40960
    s_waitcnt lgkmcnt(7)
    v_mfma_f32_16x16x32_bf16 v[56:59], a[80:83], v[200:203], v[56:59]
    v_mfma_f32_16x16x32_bf16 v[84:87], a[80:83], v[204:207], v[84:87]
    buffer_load_dwordx4 v[160:163], v2, s[24:27], s12 offen offset:1024
    ds_read_b128 a[76:79], v2 offset:41984
    v_mfma_f32_16x16x32_bf16 v[60:63], a[84:87], v[200:203], v[60:63]
    v_mfma_f32_16x16x32_bf16 v[88:91], a[84:87], v[204:207], v[88:91]
    s_waitcnt vmcnt(22)
    s_barrier
    ds_read_b128 a[80:83], v5 offset:34816
    s_waitcnt lgkmcnt(7)
    v_mfma_f32_16x16x32_bf16 v[64:67], a[88:91], v[200:203], v[64:67]
    v_mfma_f32_16x16x32_bf16 v[92:95], a[88:91], v[204:207], v[92:95]
    buffer_load_dwordx4 v[164:167], v0, s[24:27], s12 offen offset:1024
    ds_read_b128 a[84:87], v5 offset:35840
    v_mfma_f32_16x16x32_bf16 v[40:43], a[92:95], v[192:195], v[40:43]
    v_mfma_f32_16x16x32_bf16 v[68:71], a[92:95], v[196:199], v[68:71]
    ds_read_b128 a[88:91], v5 offset:36864
    s_waitcnt lgkmcnt(7)
    v_mfma_f32_16x16x32_bf16 v[44:47], a[96:99], v[192:195], v[44:47]
    v_mfma_f32_16x16x32_bf16 v[72:75], a[96:99], v[196:199], v[72:75]
    s_add_u32 s13, s11, 71680
    s_add_u32 s14, s11, 71680
    s_add_u32 s14, s14, s10
    s_mov_b32 m0, s13
    s_nop 0
    buffer_load_dwordx4 v2, s[24:27], s14 offen offset:0 lds
    ds_read_b128 a[92:95], v5 offset:37888
    v_mfma_f32_16x16x32_bf16 v[48:51], a[100:103], v[192:195], v[48:51]
    v_mfma_f32_16x16x32_bf16 v[76:79], a[100:103], v[196:199], v[76:79]
    buffer_load_dwordx4 v2, s[24:27], s14 offen offset:1024 lds
    ds_read_b128 a[96:99], v5 offset:38912
    s_waitcnt lgkmcnt(7)
    v_mfma_f32_16x16x32_bf16 v[52:55], a[104:107], v[192:195], v[52:55]
    v_mfma_f32_16x16x32_bf16 v[80:83], a[104:107], v[196:199], v[80:83]
    ds_read_b128 a[100:103], v5 offset:39936
    v_mfma_f32_16x16x32_bf16 v[56:59], a[108:111], v[192:195], v[56:59]
    v_mfma_f32_16x16x32_bf16 v[84:87], a[108:111], v[196:199], v[84:87]
    buffer_load_dwordx4 v2, s[24:27], s14 offen offset:2048 lds
    ds_read_b128 a[104:107], v5 offset:40960
    s_waitcnt lgkmcnt(7)
    v_mfma_f32_16x16x32_bf16 v[60:63], a[72:75], v[192:195], v[60:63]
    v_mfma_f32_16x16x32_bf16 v[88:91], a[72:75], v[196:199], v[88:91]
    ds_read_b128 a[108:111], v5 offset:41984
    v_mfma_f32_16x16x32_bf16 v[64:67], a[76:79], v[192:195], v[64:67]
    v_mfma_f32_16x16x32_bf16 v[92:95], a[76:79], v[196:199], v[92:95]
    buffer_load_dwordx4 v2, s[24:27], s14 offen offset:3072 lds
    ds_read_b128 a[72:75], v5 offset:43008
    s_waitcnt vmcnt(25)
    s_waitcnt lgkmcnt(7)
    v_mfma_f32_16x16x32_bf16 v[40:43], a[80:83], v[120:123], v[40:43]
    v_mfma_f32_16x16x32_bf16 v[68:71], a[80:83], v[124:127], v[68:71]
    ds_read_b128 a[76:79], v5 offset:44032
    v_mfma_f32_16x16x32_bf16 v[44:47], a[84:87], v[120:123], v[44:47]
    v_mfma_f32_16x16x32_bf16 v[72:75], a[84:87], v[124:127], v[72:75]
    s_add_u32 s13, s13, 4096
    s_add_u32 s14, s14, 4096
    s_mov_b32 m0, s13
    s_nop 0
    buffer_load_dwordx4 v2, s[24:27], s14 offen offset:0 lds
    ds_read_b128 a[80:83], v5 offset:45056
    s_waitcnt lgkmcnt(7)
    v_mfma_f32_16x16x32_bf16 v[48:51], a[88:91], v[120:123], v[48:51]
    v_mfma_f32_16x16x32_bf16 v[76:79], a[88:91], v[124:127], v[76:79]
    buffer_load_dwordx4 v2, s[24:27], s14 offen offset:1024 lds
    ds_read_b128 a[84:87], v5 offset:46080
    v_mfma_f32_16x16x32_bf16 v[52:55], a[92:95], v[120:123], v[52:55]
    v_mfma_f32_16x16x32_bf16 v[80:83], a[92:95], v[124:127], v[80:83]
    ds_read_b128 a[88:91], v5 offset:47104
    s_waitcnt lgkmcnt(7)
    v_mfma_f32_16x16x32_bf16 v[56:59], a[96:99], v[120:123], v[56:59]
    v_mfma_f32_16x16x32_bf16 v[84:87], a[96:99], v[124:127], v[84:87]
    buffer_load_dwordx4 v2, s[24:27], s14 offen offset:2048 lds
    ds_read_b128 a[92:95], v5 offset:48128
    v_mfma_f32_16x16x32_bf16 v[60:63], a[100:103], v[120:123], v[60:63]
    v_mfma_f32_16x16x32_bf16 v[88:91], a[100:103], v[124:127], v[88:91]
    ds_read_b128 a[96:99], v5 offset:49152
    s_waitcnt lgkmcnt(7)
    v_mfma_f32_16x16x32_bf16 v[64:67], a[104:107], v[120:123], v[64:67]
    v_mfma_f32_16x16x32_bf16 v[92:95], a[104:107], v[124:127], v[92:95]
    s_add_u32 s12, s58, 8192
    buffer_load_dwordx4 v[152:155], v2, s[24:27], s12 offen offset:2048
    ds_read_b128 a[100:103], v5 offset:50176
    s_waitcnt vmcnt(27)
    v_mfma_f32_16x16x32_bf16 v[40:43], a[108:111], v[112:115], v[40:43]
    v_mfma_f32_16x16x32_bf16 v[68:71], a[108:111], v[116:119], v[68:71]
    ds_read_b128 a[104:107], v5 offset:51200
    s_waitcnt lgkmcnt(7)
    v_mfma_f32_16x16x32_bf16 v[44:47], a[72:75], v[112:115], v[44:47]
    v_mfma_f32_16x16x32_bf16 v[72:75], a[72:75], v[116:119], v[72:75]
    buffer_load_dwordx4 v[156:159], v0, s[24:27], s12 offen offset:2048
    ds_read_b128 a[108:111], v5 offset:52224
    v_mfma_f32_16x16x32_bf16 v[48:51], a[76:79], v[112:115], v[48:51]
    v_mfma_f32_16x16x32_bf16 v[76:79], a[76:79], v[116:119], v[76:79]
    ds_read_b128 a[72:75], v5 offset:53248
    s_waitcnt lgkmcnt(7)
    v_mfma_f32_16x16x32_bf16 v[52:55], a[80:83], v[112:115], v[52:55]
    v_mfma_f32_16x16x32_bf16 v[80:83], a[80:83], v[116:119], v[80:83]
    buffer_load_dwordx4 v[144:147], v2, s[24:27], s12 offen offset:3072
    ds_read_b128 a[76:79], v5 offset:54272
    v_mfma_f32_16x16x32_bf16 v[56:59], a[84:87], v[112:115], v[56:59]
    v_mfma_f32_16x16x32_bf16 v[84:87], a[84:87], v[116:119], v[84:87]
    ds_read_b128 a[80:83], v5 offset:55296
    s_waitcnt lgkmcnt(7)
    v_mfma_f32_16x16x32_bf16 v[60:63], a[88:91], v[112:115], v[60:63]
    v_mfma_f32_16x16x32_bf16 v[88:91], a[88:91], v[116:119], v[88:91]
    buffer_load_dwordx4 v[148:151], v0, s[24:27], s12 offen offset:3072
    ds_read_b128 a[84:87], v5 offset:56320
    v_mfma_f32_16x16x32_bf16 v[64:67], a[92:95], v[112:115], v[64:67]
    v_mfma_f32_16x16x32_bf16 v[92:95], a[92:95], v[116:119], v[92:95]
    ds_read_b128 a[88:91], v5 offset:57344
    s_waitcnt vmcnt(28)
    s_waitcnt lgkmcnt(7)
    v_mfma_f32_16x16x32_bf16 v[40:43], a[96:99], v[104:107], v[40:43]
    v_mfma_f32_16x16x32_bf16 v[68:71], a[96:99], v[108:111], v[68:71]
    s_add_u32 s12, s58, 12288
    buffer_load_dwordx4 v[136:139], v2, s[24:27], s12 offen offset:0
    ds_read_b128 a[92:95], v5 offset:58368
    v_mfma_f32_16x16x32_bf16 v[44:47], a[100:103], v[104:107], v[44:47]
    v_mfma_f32_16x16x32_bf16 v[72:75], a[100:103], v[108:111], v[72:75]
    buffer_load_dwordx4 v[140:143], v0, s[24:27], s12 offen offset:0
    ds_read_b128 a[96:99], v5 offset:59392
    s_waitcnt lgkmcnt(7)
    v_mfma_f32_16x16x32_bf16 v[48:51], a[104:107], v[104:107], v[48:51]
    v_mfma_f32_16x16x32_bf16 v[76:79], a[104:107], v[108:111], v[76:79]
    ds_read_b128 a[100:103], v5 offset:60416
    v_mfma_f32_16x16x32_bf16 v[52:55], a[108:111], v[104:107], v[52:55]
    v_mfma_f32_16x16x32_bf16 v[80:83], a[108:111], v[108:111], v[80:83]
    buffer_load_dwordx4 v[128:131], v2, s[24:27], s12 offen offset:1024
    ds_read_b128 a[104:107], v5 offset:61440
    s_waitcnt lgkmcnt(7)
    v_mfma_f32_16x16x32_bf16 v[56:59], a[72:75], v[104:107], v[56:59]
    v_mfma_f32_16x16x32_bf16 v[84:87], a[72:75], v[108:111], v[84:87]
    ds_read_b128 a[108:111], v5 offset:62464
    v_mfma_f32_16x16x32_bf16 v[60:63], a[76:79], v[104:107], v[60:63]
    v_mfma_f32_16x16x32_bf16 v[88:91], a[76:79], v[108:111], v[88:91]
    buffer_load_dwordx4 v[132:135], v0, s[24:27], s12 offen offset:1024
    s_waitcnt vmcnt(23)
    s_barrier
    ds_read_b128 a[72:75], v2 offset:43008
    s_waitcnt lgkmcnt(7)
    v_mfma_f32_16x16x32_bf16 v[64:67], a[80:83], v[104:107], v[64:67]
    v_mfma_f32_16x16x32_bf16 v[92:95], a[80:83], v[108:111], v[92:95]
    ds_read_b128 a[76:79], v2 offset:44032
    v_mfma_f32_16x16x32_bf16 v[40:43], a[84:87], v[96:99], v[40:43]
    v_mfma_f32_16x16x32_bf16 v[68:71], a[84:87], v[100:103], v[68:71]
    ds_read_b128 a[80:83], v2 offset:45056
    s_waitcnt lgkmcnt(7)
    v_mfma_f32_16x16x32_bf16 v[44:47], a[88:91], v[96:99], v[44:47]
    v_mfma_f32_16x16x32_bf16 v[72:75], a[88:91], v[100:103], v[72:75]
    ds_read_b128 a[84:87], v2 offset:46080
    v_mfma_f32_16x16x32_bf16 v[48:51], a[92:95], v[96:99], v[48:51]
    v_mfma_f32_16x16x32_bf16 v[76:79], a[92:95], v[100:103], v[76:79]
    ds_read_b128 a[88:91], v2 offset:47104
    s_waitcnt lgkmcnt(7)
    v_mfma_f32_16x16x32_bf16 v[52:55], a[96:99], v[96:99], v[52:55]
    v_mfma_f32_16x16x32_bf16 v[80:83], a[96:99], v[100:103], v[80:83]
    ds_read_b128 a[92:95], v2 offset:48128
    v_mfma_f32_16x16x32_bf16 v[56:59], a[100:103], v[96:99], v[56:59]
    v_mfma_f32_16x16x32_bf16 v[84:87], a[100:103], v[100:103], v[84:87]
    ds_read_b128 a[96:99], v2 offset:49152
    s_waitcnt lgkmcnt(7)
    v_mfma_f32_16x16x32_bf16 v[60:63], a[104:107], v[96:99], v[60:63]
    v_mfma_f32_16x16x32_bf16 v[88:91], a[104:107], v[100:103], v[88:91]
    ds_read_b128 a[100:103], v2 offset:50176
    v_mfma_f32_16x16x32_bf16 v[64:67], a[108:111], v[96:99], v[64:67]
    v_mfma_f32_16x16x32_bf16 v[92:95], a[108:111], v[100:103], v[92:95]
    ds_read_b128 a[104:107], v2 offset:51200
    s_waitcnt vmcnt(21)
    s_waitcnt lgkmcnt(7)
    v_mfma_f32_16x16x32_bf16 v[40:43], a[72:75], v[184:187], v[40:43]
    v_mfma_f32_16x16x32_bf16 v[68:71], a[72:75], v[188:191], v[68:71]
    ds_read_b128 a[108:111], v2 offset:52224
    v_mfma_f32_16x16x32_bf16 v[44:47], a[76:79], v[184:187], v[44:47]
    v_mfma_f32_16x16x32_bf16 v[72:75], a[76:79], v[188:191], v[72:75]
    ds_read_b128 a[72:75], v2 offset:53248
    s_waitcnt lgkmcnt(7)
    v_mfma_f32_16x16x32_bf16 v[48:51], a[80:83], v[184:187], v[48:51]
    v_mfma_f32_16x16x32_bf16 v[76:79], a[80:83], v[188:191], v[76:79]
    s_barrier
    ds_read_b128 a[76:79], v2 offset:54272
    v_mfma_f32_16x16x32_bf16 v[52:55], a[84:87], v[184:187], v[52:55]
    v_mfma_f32_16x16x32_bf16 v[80:83], a[84:87], v[188:191], v[80:83]
    buffer_load_dwordx4 v[112:115], v2, s[36:39], s67 offen
    ds_read_b128 a[80:83], v2 offset:55296
    s_waitcnt lgkmcnt(7)
    v_mfma_f32_16x16x32_bf16 v[56:59], a[88:91], v[184:187], v[56:59]
    v_mfma_f32_16x16x32_bf16 v[84:87], a[88:91], v[188:191], v[84:87]
    buffer_load_dwordx4 v[116:119], v2, s[36:39], s67 offen offset:1024
    ds_read_b128 a[84:87], v2 offset:56320
    v_mfma_f32_16x16x32_bf16 v[60:63], a[92:95], v[184:187], v[60:63]
    v_mfma_f32_16x16x32_bf16 v[88:91], a[92:95], v[188:191], v[88:91]
    buffer_load_dwordx4 v[120:123], v2, s[36:39], s68 offen
    ds_read_b128 a[88:91], v2 offset:57344
    s_waitcnt lgkmcnt(7)
    v_mfma_f32_16x16x32_bf16 v[64:67], a[96:99], v[184:187], v[64:67]
    v_mfma_f32_16x16x32_bf16 v[92:95], a[96:99], v[188:191], v[92:95]
    v_subrev_u32 v22, 4, v2
    v_add_u32 v23, s67, v22
    s_cmp_eq_u32 s66, 0
    s_cselect_b32 s4, 0, -1
    v_cmp_eq_u32 vcc, s4, v1
    s_nop 1
    v_cndmask_b32 v23, v23, v241, vcc
    buffer_load_dword v124, v23, s[36:39], 0 offen
    ds_read_b128 a[92:95], v2 offset:58368
    s_waitcnt vmcnt(23)
    v_mfma_f32_16x16x32_bf16 v[40:43], a[100:103], v[176:179], v[40:43]
    v_mfma_f32_16x16x32_bf16 v[68:71], a[100:103], v[180:183], v[68:71]
    buffer_load_dword v125, v2, s[36:39], s67 offen offset:1020
    ds_read_b128 a[96:99], v2 offset:59392
    s_waitcnt lgkmcnt(7)
    v_mfma_f32_16x16x32_bf16 v[44:47], a[104:107], v[176:179], v[44:47]
    v_mfma_f32_16x16x32_bf16 v[72:75], a[104:107], v[180:183], v[72:75]
    v_add_u32 v24, s68, v22
    s_cmp_eq_u32 s3, 0
    s_cselect_b32 s4, 0, -1
    v_cmp_eq_u32 vcc, s4, v1
    s_nop 1
    v_cndmask_b32 v24, v24, v241, vcc
    buffer_load_dword v126, v24, s[36:39], 0 offen
    ds_read_b128 a[100:103], v2 offset:60416
    v_mfma_f32_16x16x32_bf16 v[48:51], a[108:111], v[176:179], v[48:51]
    v_mfma_f32_16x16x32_bf16 v[76:79], a[108:111], v[180:183], v[76:79]
    buffer_load_dwordx4 a[0:3], v243, s[28:31], s48 offen
    ds_read_b128 a[104:107], v2 offset:61440
    s_waitcnt lgkmcnt(7)
    v_mfma_f32_16x16x32_bf16 v[52:55], a[72:75], v[176:179], v[52:55]
    v_mfma_f32_16x16x32_bf16 v[80:83], a[72:75], v[180:183], v[80:83]
    buffer_load_dwordx4 a[4:7], v243, s[28:31], s48 offen offset:16
    ds_read_b128 a[108:111], v2 offset:62464
    v_mfma_f32_16x16x32_bf16 v[56:59], a[76:79], v[176:179], v[56:59]
    v_mfma_f32_16x16x32_bf16 v[84:87], a[76:79], v[180:183], v[84:87]
    buffer_load_dword a8, v243, s[28:31], s48 offen offset:32
    ds_read_b128 a[72:75], v2 offset:63488
    s_waitcnt lgkmcnt(7)
    v_mfma_f32_16x16x32_bf16 v[60:63], a[80:83], v[176:179], v[60:63]
    v_mfma_f32_16x16x32_bf16 v[88:91], a[80:83], v[180:183], v[88:91]
    s_lshl_b32 s4, s17, 12
    s_lshl_b32 s5, s7, 7
    s_cmp_eq_u32 s3, 0
    s_cselect_b32 s46, s5, s4
    s_cselect_b32 s4, 11, 7
    s_cselect_b32 s5, 15, 31
    v_and_b32 v33, s5, v1
    v_lshlrev_b32 v33, s4, v33
    v_add_u32 v33, s46, v33
    s_lshl_b32 s5, s47, 12
    s_sub_u32 s5, s5, 4096
    v_lshl_add_u32 v34, v1, 7, s5
    v_cmp_gt_u32 vcc, 32, v1
    s_nop 1
    v_cndmask_b32_e64 v33, v34, v33, vcc
    s_mov_b32 s46, 0x1908000
    buffer_load_dwordx2 v[34:35], v33, s[24:27], s46 offen sc1
    ds_read_b128 a[76:79], v2 offset:64512
    v_mfma_f32_16x16x32_bf16 v[64:67], a[84:87], v[176:179], v[64:67]
    v_mfma_f32_16x16x32_bf16 v[92:95], a[84:87], v[180:183], v[92:95]
    ds_read_b128 a[80:83], v5 offset:0
    s_waitcnt vmcnt(27)
    s_waitcnt lgkmcnt(7)
    v_mfma_f32_16x16x32_bf16 v[40:43], a[88:91], v[168:171], v[40:43]
    v_mfma_f32_16x16x32_bf16 v[68:71], a[88:91], v[172:175], v[68:71]
    ds_read_b128 a[84:87], v5 offset:1024
    v_mfma_f32_16x16x32_bf16 v[44:47], a[92:95], v[168:171], v[44:47]
    v_mfma_f32_16x16x32_bf16 v[72:75], a[92:95], v[172:175], v[72:75]
    ds_read_b128 a[88:91], v5 offset:2048
    s_waitcnt lgkmcnt(7)
    v_mfma_f32_16x16x32_bf16 v[48:51], a[96:99], v[168:171], v[48:51]
    v_mfma_f32_16x16x32_bf16 v[76:79], a[96:99], v[172:175], v[76:79]
    ds_read_b128 a[92:95], v5 offset:3072
    v_mfma_f32_16x16x32_bf16 v[52:55], a[100:103], v[168:171], v[52:55]
    v_mfma_f32_16x16x32_bf16 v[80:83], a[100:103], v[172:175], v[80:83]
    ds_read_b128 a[96:99], v5 offset:4096
    s_waitcnt lgkmcnt(7)
    v_mfma_f32_16x16x32_bf16 v[56:59], a[104:107], v[168:171], v[56:59]
    v_mfma_f32_16x16x32_bf16 v[84:87], a[104:107], v[172:175], v[84:87]
    ds_read_b128 a[100:103], v5 offset:5120
    v_mfma_f32_16x16x32_bf16 v[60:63], a[108:111], v[168:171], v[60:63]
    v_mfma_f32_16x16x32_bf16 v[88:91], a[108:111], v[172:175], v[88:91]
    s_waitcnt vmcnt(18)
    s_barrier
    ds_read_b128 a[104:107], v5 offset:6144
    s_waitcnt lgkmcnt(7)
    v_mfma_f32_16x16x32_bf16 v[64:67], a[72:75], v[168:171], v[64:67]
    v_mfma_f32_16x16x32_bf16 v[92:95], a[72:75], v[172:175], v[92:95]
    ds_read_b128 a[108:111], v5 offset:7168
    v_mfma_f32_16x16x32_bf16 v[40:43], a[76:79], v[160:163], v[40:43]
    v_mfma_f32_16x16x32_bf16 v[68:71], a[76:79], v[164:167], v[68:71]
    ds_read_b128 a[72:75], v5 offset:8192
    s_waitcnt lgkmcnt(7)
    v_mfma_f32_16x16x32_bf16 v[44:47], a[80:83], v[160:163], v[44:47]
    v_mfma_f32_16x16x32_bf16 v[72:75], a[80:83], v[164:167], v[72:75]
    ds_read_b128 a[76:79], v5 offset:9216
    v_mfma_f32_16x16x32_bf16 v[48:51], a[84:87], v[160:163], v[48:51]
    v_mfma_f32_16x16x32_bf16 v[76:79], a[84:87], v[164:167], v[76:79]
    ds_read_b128 a[80:83], v5 offset:10240
    s_waitcnt lgkmcnt(7)
    v_mfma_f32_16x16x32_bf16 v[52:55], a[88:91], v[160:163], v[52:55]
    v_mfma_f32_16x16x32_bf16 v[80:83], a[88:91], v[164:167], v[80:83]
    ds_read_b128 a[84:87], v5 offset:11264
    v_mfma_f32_16x16x32_bf16 v[56:59], a[92:95], v[160:163], v[56:59]
    v_mfma_f32_16x16x32_bf16 v[84:87], a[92:95], v[164:167], v[84:87]
    ds_read_b128 a[88:91], v5 offset:12288
    s_waitcnt lgkmcnt(7)
    v_mfma_f32_16x16x32_bf16 v[60:63], a[96:99], v[160:163], v[60:63]
    v_mfma_f32_16x16x32_bf16 v[88:91], a[96:99], v[164:167], v[88:91]
    ds_read_b128 a[92:95], v5 offset:13312
    v_mfma_f32_16x16x32_bf16 v[64:67], a[100:103], v[160:163], v[64:67]
    v_mfma_f32_16x16x32_bf16 v[92:95], a[100:103], v[164:167], v[92:95]
    ds_read_b128 a[96:99], v5 offset:14336
    s_waitcnt vmcnt(16)
    s_waitcnt lgkmcnt(7)
    v_mfma_f32_16x16x32_bf16 v[40:43], a[104:107], v[152:155], v[40:43]
    v_mfma_f32_16x16x32_bf16 v[68:71], a[104:107], v[156:159], v[68:71]
    ds_read_b128 a[100:103], v5 offset:15360
    v_mfma_f32_16x16x32_bf16 v[44:47], a[108:111], v[152:155], v[44:47]
    v_mfma_f32_16x16x32_bf16 v[72:75], a[108:111], v[156:159], v[72:75]
    ds_read_b128 a[104:107], v5 offset:16384
    s_waitcnt lgkmcnt(7)
    v_mfma_f32_16x16x32_bf16 v[48:51], a[72:75], v[152:155], v[48:51]
    v_mfma_f32_16x16x32_bf16 v[76:79], a[72:75], v[156:159], v[76:79]
    ds_read_b128 a[108:111], v5 offset:17408
    v_mfma_f32_16x16x32_bf16 v[52:55], a[76:79], v[152:155], v[52:55]
    v_mfma_f32_16x16x32_bf16 v[80:83], a[76:79], v[156:159], v[80:83]
    ds_read_b128 a[72:75], v5 offset:18432
    s_waitcnt lgkmcnt(7)
    v_mfma_f32_16x16x32_bf16 v[56:59], a[80:83], v[152:155], v[56:59]
    v_mfma_f32_16x16x32_bf16 v[84:87], a[80:83], v[156:159], v[84:87]
    ds_read_b128 a[76:79], v5 offset:19456
    v_mfma_f32_16x16x32_bf16 v[60:63], a[84:87], v[152:155], v[60:63]
    v_mfma_f32_16x16x32_bf16 v[88:91], a[84:87], v[156:159], v[88:91]
    ds_read_b128 a[80:83], v5 offset:20480
    s_waitcnt lgkmcnt(7)
    v_mfma_f32_16x16x32_bf16 v[64:67], a[88:91], v[152:155], v[64:67]
    v_mfma_f32_16x16x32_bf16 v[92:95], a[88:91], v[156:159], v[92:95]
    ds_read_b128 a[84:87], v5 offset:21504
    s_waitcnt vmcnt(14)
    v_mfma_f32_16x16x32_bf16 v[40:43], a[92:95], v[144:147], v[40:43]
    v_mfma_f32_16x16x32_bf16 v[68:71], a[92:95], v[148:151], v[68:71]
    ds_read_b128 a[88:91], v5 offset:22528
    s_waitcnt lgkmcnt(7)
    v_mfma_f32_16x16x32_bf16 v[44:47], a[96:99], v[144:147], v[44:47]
    v_mfma_f32_16x16x32_bf16 v[72:75], a[96:99], v[148:151], v[72:75]
    ds_read_b128 a[92:95], v5 offset:23552
    v_mfma_f32_16x16x32_bf16 v[48:51], a[100:103], v[144:147], v[48:51]
    v_mfma_f32_16x16x32_bf16 v[76:79], a[100:103], v[148:151], v[76:79]
    ds_read_b128 a[96:99], v5 offset:24576
    s_waitcnt lgkmcnt(7)
    v_mfma_f32_16x16x32_bf16 v[52:55], a[104:107], v[144:147], v[52:55]
    v_mfma_f32_16x16x32_bf16 v[80:83], a[104:107], v[148:151], v[80:83]
    ds_read_b128 a[100:103], v5 offset:25600
    v_mfma_f32_16x16x32_bf16 v[56:59], a[108:111], v[144:147], v[56:59]
    v_mfma_f32_16x16x32_bf16 v[84:87], a[108:111], v[148:151], v[84:87]
    ds_read_b128 a[104:107], v5 offset:26624
    s_waitcnt lgkmcnt(7)
    v_mfma_f32_16x16x32_bf16 v[60:63], a[72:75], v[144:147], v[60:63]
    v_mfma_f32_16x16x32_bf16 v[88:91], a[72:75], v[148:151], v[88:91]
    ds_read_b128 a[108:111], v5 offset:27648
    v_mfma_f32_16x16x32_bf16 v[64:67], a[76:79], v[144:147], v[64:67]
    v_mfma_f32_16x16x32_bf16 v[92:95], a[76:79], v[148:151], v[92:95]
    ds_read_b128 a[72:75], v5 offset:28672
    s_waitcnt vmcnt(12)
    s_waitcnt lgkmcnt(7)
    v_mfma_f32_16x16x32_bf16 v[40:43], a[80:83], v[136:139], v[40:43]
    v_mfma_f32_16x16x32_bf16 v[68:71], a[80:83], v[140:143], v[68:71]
    ds_read_b128 a[76:79], v5 offset:29696
    v_mfma_f32_16x16x32_bf16 v[44:47], a[84:87], v[136:139], v[44:47]
    v_mfma_f32_16x16x32_bf16 v[72:75], a[84:87], v[140:143], v[72:75]
    ds_read_b128 a[80:83], v5 offset:30720
    s_waitcnt lgkmcnt(7)
    v_mfma_f32_16x16x32_bf16 v[48:51], a[88:91], v[136:139], v[48:51]
    v_mfma_f32_16x16x32_bf16 v[76:79], a[88:91], v[140:143], v[76:79]
    ds_read_b128 a[84:87], v5 offset:31744
    v_mfma_f32_16x16x32_bf16 v[52:55], a[92:95], v[136:139], v[52:55]
    v_mfma_f32_16x16x32_bf16 v[80:83], a[92:95], v[140:143], v[80:83]
    ds_read_b128 a[88:91], v5 offset:32768
    s_waitcnt lgkmcnt(7)
    v_mfma_f32_16x16x32_bf16 v[56:59], a[96:99], v[136:139], v[56:59]
    v_mfma_f32_16x16x32_bf16 v[84:87], a[96:99], v[140:143], v[84:87]
    ds_read_b128 a[92:95], v5 offset:33792
    v_mfma_f32_16x16x32_bf16 v[60:63], a[100:103], v[136:139], v[60:63]
    v_mfma_f32_16x16x32_bf16 v[88:91], a[100:103], v[140:143], v[88:91]
    s_waitcnt lgkmcnt(6)
    v_mfma_f32_16x16x32_bf16 v[64:67], a[104:107], v[136:139], v[64:67]
    v_mfma_f32_16x16x32_bf16 v[92:95], a[104:107], v[140:143], v[92:95]
    s_waitcnt vmcnt(10)
    v_mfma_f32_16x16x32_bf16 v[40:43], a[108:111], v[128:131], v[40:43]
    v_mfma_f32_16x16x32_bf16 v[68:71], a[108:111], v[132:135], v[68:71]
    s_waitcnt lgkmcnt(4)
    v_mfma_f32_16x16x32_bf16 v[44:47], a[72:75], v[128:131], v[44:47]
    v_mfma_f32_16x16x32_bf16 v[72:75], a[72:75], v[132:135], v[72:75]
    v_mfma_f32_16x16x32_bf16 v[48:51], a[76:79], v[128:131], v[48:51]
    v_mfma_f32_16x16x32_bf16 v[76:79], a[76:79], v[132:135], v[76:79]
    s_waitcnt lgkmcnt(2)
    v_mfma_f32_16x16x32_bf16 v[52:55], a[80:83], v[128:131], v[52:55]
    v_mfma_f32_16x16x32_bf16 v[80:83], a[80:83], v[132:135], v[80:83]
    v_mfma_f32_16x16x32_bf16 v[56:59], a[84:87], v[128:131], v[56:59]
    v_mfma_f32_16x16x32_bf16 v[84:87], a[84:87], v[132:135], v[84:87]
    s_waitcnt lgkmcnt(0)
    v_mfma_f32_16x16x32_bf16 v[60:63], a[88:91], v[128:131], v[60:63]
    v_mfma_f32_16x16x32_bf16 v[88:91], a[88:91], v[132:135], v[88:91]
    v_mfma_f32_16x16x32_bf16 v[64:67], a[92:95], v[128:131], v[64:67]
    v_mfma_f32_16x16x32_bf16 v[92:95], a[92:95], v[132:135], v[92:95]
    s_branch M_feat
M_gemm1:
    v_lshrrev_b32 v16, 3, v3
    v_mul_u32_u24 v16, 18432, v16
    v_and_b32_e64 v17, 7, v3
    v_lshl_add_u32 v16, v17, 8, v16
    v_add_u32 v16, 252, v16
    v_cmp_gt_u32 vcc, 16, v1
    s_nop 1
    v_cndmask_b32_e64 v16, v241, v16, vcc
    s_add_u32 s15, s58, 16384
M_xpoll:
    buffer_load_dword v17, v16, s[24:27], s15 offen sc1
    s_add_u32 s75, s75, 1
    s_cmp_lt_u32 s75, 20000
    s_waitcnt vmcnt(0)
    v_cmp_eq_u32_e64 vcc, -1, v17
    s_cbranch_scc0 M_xpoll_ok
    s_cbranch_vccnz M_xpoll
M_xpoll_ok:
    s_add_u32 s12, s58, 12288
    buffer_load_dwordx4 v[120:123], v2, s[24:27], s12 offen offset:2048 sc1
    buffer_load_dwordx4 v[124:127], v0, s[24:27], s12 offen offset:2048 sc1
    buffer_load_dwordx4 v[112:115], v2, s[24:27], s12 offen offset:3072 sc1
    buffer_load_dwordx4 v[116:119], v0, s[24:27], s12 offen offset:3072 sc1
    s_add_u32 s12, s58, 16384
    buffer_load_dwordx4 v[104:107], v2, s[24:27], s12 offen offset:0 sc1
    buffer_load_dwordx4 v[108:111], v0, s[24:27], s12 offen offset:0 sc1
    s_waitcnt vmcnt(6)
    s_barrier
    ds_read_b128 a[72:75], v5 offset:34816
    ds_read_b128 a[76:79], v5 offset:35840
    ds_read_b128 a[80:83], v5 offset:36864
    ds_read_b128 a[84:87], v5 offset:37888
    ds_read_b128 a[88:91], v5 offset:38912
    ds_read_b128 a[92:95], v5 offset:39936
    ds_read_b128 a[96:99], v5 offset:40960
    ds_read_b128 a[100:103], v5 offset:41984
    ds_read_b128 a[104:107], v5 offset:43008
    s_waitcnt vmcnt(4)
    v_max_u32 v16, v123, v127
    v_cmp_eq_u32_e64 vcc, -1, v16
    s_cbranch_vccnz M_x0r
M_x0b:
    s_waitcnt lgkmcnt(7)
    v_mfma_f32_16x16x32_bf16 v[40:43], a[72:75], v[120:123], 0
    v_mfma_f32_16x16x32_bf16 v[68:71], a[72:75], v[124:127], 0
    buffer_load_dwordx4 v[96:99], v2, s[24:27], s12 offen offset:1024 sc1
    ds_read_b128 a[108:111], v5 offset:44032
    v_mfma_f32_16x16x32_bf16 v[44:47], a[76:79], v[120:123], 0
    v_mfma_f32_16x16x32_bf16 v[72:75], a[76:79], v[124:127], 0
    ds_read_b128 a[72:75], v5 offset:45056
    s_waitcnt lgkmcnt(7)
    v_mfma_f32_16x16x32_bf16 v[48:51], a[80:83], v[120:123], 0
    v_mfma_f32_16x16x32_bf16 v[76:79], a[80:83], v[124:127], 0
    buffer_load_dwordx4 v[100:103], v0, s[24:27], s12 offen offset:1024 sc1
    ds_read_b128 a[76:79], v5 offset:46080
    v_mfma_f32_16x16x32_bf16 v[52:55], a[84:87], v[120:123], 0
    v_mfma_f32_16x16x32_bf16 v[80:83], a[84:87], v[124:127], 0
    ds_read_b128 a[80:83], v5 offset:47104
    s_waitcnt vmcnt(4)
    v_max_u32 v16, v115, v119
    v_cmp_eq_u32_e64 vcc, -1, v16
    s_waitcnt lgkmcnt(7)
    v_mfma_f32_16x16x32_bf16 v[56:59], a[88:91], v[120:123], 0
    v_mfma_f32_16x16x32_bf16 v[84:87], a[88:91], v[124:127], 0
    ds_read_b128 a[84:87], v5 offset:48128
    v_mfma_f32_16x16x32_bf16 v[60:63], a[92:95], v[120:123], 0
    v_mfma_f32_16x16x32_bf16 v[88:91], a[92:95], v[124:127], 0
    s_add_u32 s12, s58, 0
    buffer_load_dwordx4 v[232:235], v2, s[24:27], s12 offen offset:0 sc1
    ds_read_b128 a[88:91], v5 offset:49152
    s_waitcnt lgkmcnt(7)
    v_mfma_f32_16x16x32_bf16 v[64:67], a[96:99], v[120:123], 0
    v_mfma_f32_16x16x32_bf16 v[92:95], a[96:99], v[124:127], 0
    s_cbranch_vccnz M_x1r
M_x1b:
    ds_read_b128 a[92:95], v5 offset:50176
    v_mfma_f32_16x16x32_bf16 v[40:43], a[100:103], v[112:115], v[40:43]
    v_mfma_f32_16x16x32_bf16 v[68:71], a[100:103], v[116:119], v[68:71]
    buffer_load_dwordx4 v[236:239], v0, s[24:27], s12 offen offset:0 sc1
    ds_read_b128 a[96:99], v5 offset:51200
    s_waitcnt lgkmcnt(7)
    v_mfma_f32_16x16x32_bf16 v[44:47], a[104:107], v[112:115], v[44:47]
    v_mfma_f32_16x16x32_bf16 v[72:75], a[104:107], v[116:119], v[72:75]
    ds_read_b128 a[100:103], v5 offset:52224
    v_mfma_f32_16x16x32_bf16 v[48:51], a[108:111], v[112:115], v[48:51]
    v_mfma_f32_16x16x32_bf16 v[76:79], a[108:111], v[116:119], v[76:79]
    buffer_load_dwordx4 v[224:227], v2, s[24:27], s12 offen offset:1024 sc1
    ds_read_b128 a[104:107], v5 offset:53248
    s_waitcnt lgkmcnt(7)
    v_mfma_f32_16x16x32_bf16 v[52:55], a[72:75], v[112:115], v[52:55]
    v_mfma_f32_16x16x32_bf16 v[80:83], a[72:75], v[116:119], v[80:83]
    ds_read_b128 a[108:111], v5 offset:54272
    s_waitcnt vmcnt(5)
    v_max3_u32 v16, v104, v105, v106
    v_max3_u32 v17, v108, v109, v110
    v_max3_u32 v16, v16, v107, v111
    v_max_u32 v16, v16, v17
    v_cmp_eq_u32 vcc, -1, v16
    v_mfma_f32_16x16x32_bf16 v[56:59], a[76:79], v[112:115], v[56:59]
    v_mfma_f32_16x16x32_bf16 v[84:87], a[76:79], v[116:119], v[84:87]
    ds_read_b128 a[72:75], v5 offset:55296
    s_waitcnt lgkmcnt(7)
    v_mfma_f32_16x16x32_bf16 v[60:63], a[80:83], v[112:115], v[60:63]
    v_mfma_f32_16x16x32_bf16 v[88:91], a[80:83], v[116:119], v[88:91]
    buffer_load_dwordx4 v[228:231], v0, s[24:27], s12 offen offset:1024 sc1
    ds_read_b128 a[76:79], v5 offset:56320
    v_mfma_f32_16x16x32_bf16 v[64:67], a[84:87], v[112:115], v[64:67]
    v_mfma_f32_16x16x32_bf16 v[92:95], a[84:87], v[116:119], v[92:95]
    s_cbranch_vccnz M_x2r
M_x2b:
    ds_read_b128 a[80:83], v5 offset:57344
    s_waitcnt lgkmcnt(7)
    v_mfma_f32_16x16x32_bf16 v[40:43], a[88:91], v[104:107], v[40:43]
    v_mfma_f32_16x16x32_bf16 v[68:71], a[88:91], v[108:111], v[68:71]
    buffer_load_dwordx4 v[216:219], v2, s[24:27], s12 offen offset:2048 sc1
    ds_read_b128 a[84:87], v5 offset:58368
    v_mfma_f32_16x16x32_bf16 v[44:47], a[92:95], v[104:107], v[44:47]
    v_mfma_f32_16x16x32_bf16 v[72:75], a[92:95], v[108:111], v[72:75]
    ds_read_b128 a[88:91], v5 offset:59392
    s_waitcnt lgkmcnt(7)
    v_mfma_f32_16x16x32_bf16 v[48:51], a[96:99], v[104:107], v[48:51]
    v_mfma_f32_16x16x32_bf16 v[76:79], a[96:99], v[108:111], v[76:79]
    buffer_load_dwordx4 v[220:223], v0, s[24:27], s12 offen offset:2048 sc1
    ds_read_b128 a[92:95], v5 offset:60416
    v_mfma_f32_16x16x32_bf16 v[52:55], a[100:103], v[104:107], v[52:55]
    v_mfma_f32_16x16x32_bf16 v[80:83], a[100:103], v[108:111], v[80:83]
    ds_read_b128 a[96:99], v5 offset:61440
    s_waitcnt vmcnt(6)
    v_max3_u32 v16, v96, v97, v98
    v_max3_u32 v17, v100, v101, v102
    v_max3_u32 v16, v16, v99, v103
    v_max_u32 v16, v16, v17
    v_cmp_eq_u32 vcc, -1, v16
    s_waitcnt lgkmcnt(7)
    v_mfma_f32_16x16x32_bf16 v[56:59], a[104:107], v[104:107], v[56:59]
    v_mfma_f32_16x16x32_bf16 v[84:87], a[104:107], v[108:111], v[84:87]
    ds_read_b128 a[100:103], v5 offset:62464
    v_mfma_f32_16x16x32_bf16 v[60:63], a[108:111], v[104:107], v[60:63]
    v_mfma_f32_16x16x32_bf16 v[88:91], a[108:111], v[108:111], v[88:91]
    buffer_load_dwordx4 v[208:211], v2, s[24:27], s12 offen offset:3072 sc1
    ds_read_b128 a[104:107], v2 offset:0
    s_waitcnt lgkmcnt(7)
    v_mfma_f32_16x16x32_bf16 v[64:67], a[72:75], v[104:107], v[64:67]
    v_mfma_f32_16x16x32_bf16 v[92:95], a[72:75], v[108:111], v[92:95]
    s_cbranch_vccnz M_x3r
M_x3b:
    ds_read_b128 a[108:111], v2 offset:1024
    v_mfma_f32_16x16x32_bf16 v[40:43], a[76:79], v[96:99], v[40:43]
    v_mfma_f32_16x16x32_bf16 v[68:71], a[76:79], v[100:103], v[68:71]
    buffer_load_dwordx4 v[212:215], v0, s[24:27], s12 offen offset:3072 sc1
    ds_read_b128 a[72:75], v2 offset:2048
    s_waitcnt lgkmcnt(7)
    v_mfma_f32_16x16x32_bf16 v[44:47], a[80:83], v[96:99], v[44:47]
    v_mfma_f32_16x16x32_bf16 v[72:75], a[80:83], v[100:103], v[72:75]
    ds_read_b128 a[76:79], v2 offset:3072
    v_mfma_f32_16x16x32_bf16 v[48:51], a[84:87], v[96:99], v[48:51]
    v_mfma_f32_16x16x32_bf16 v[76:79], a[84:87], v[100:103], v[76:79]
    s_add_u32 s12, s58, 4096
    buffer_load_dwordx4 v[200:203], v2, s[24:27], s12 offen offset:0 sc1
    ds_read_b128 a[80:83], v2 offset:4096
    s_waitcnt lgkmcnt(7)
    v_mfma_f32_16x16x32_bf16 v[52:55], a[88:91], v[96:99], v[52:55]
    v_mfma_f32_16x16x32_bf16 v[80:83], a[88:91], v[100:103], v[80:83]
    ds_read_b128 a[84:87], v2 offset:5120
    s_waitcnt vmcnt(7)
    v_max_u32 v16, v235, v239
    v_cmp_eq_u32_e64 vcc, -1, v16
    v_mfma_f32_16x16x32_bf16 v[56:59], a[92:95], v[96:99], v[56:59]
    v_mfma_f32_16x16x32_bf16 v[84:87], a[92:95], v[100:103], v[84:87]
    ds_read_b128 a[88:91], v2 offset:6144
    s_waitcnt lgkmcnt(7)
    v_mfma_f32_16x16x32_bf16 v[60:63], a[96:99], v[96:99], v[60:63]
    v_mfma_f32_16x16x32_bf16 v[88:91], a[96:99], v[100:103], v[88:91]
    buffer_load_dwordx4 v[204:207], v0, s[24:27], s12 offen offset:0 sc1
    ds_read_b128 a[92:95], v2 offset:7168
    v_mfma_f32_16x16x32_bf16 v[64:67], a[100:103], v[96:99], v[64:67]
    v_mfma_f32_16x16x32_bf16 v[92:95], a[100:103], v[100:103], v[92:95]
    s_cbranch_vccnz M_x4r
M_x4b:
    ds_read_b128 a[96:99], v2 offset:8192
    s_waitcnt lgkmcnt(7)
    v_mfma_f32_16x16x32_bf16 v[40:43], a[104:107], v[232:235], v[40:43]
    v_mfma_f32_16x16x32_bf16 v[68:71], a[104:107], v[236:239], v[68:71]
    buffer_load_dwordx4 v[192:195], v2, s[24:27], s12 offen offset:1024 sc1
    ds_read_b128 a[100:103], v2 offset:9216
    v_mfma_f32_16x16x32_bf16 v[44:47], a[108:111], v[232:235], v[44:47]
    v_mfma_f32_16x16x32_bf16 v[72:75], a[108:111], v[236:239], v[72:75]
    ds_read_b128 a[104:107], v2 offset:10240
    s_waitcnt lgkmcnt(7)
    v_mfma_f32_16x16x32_bf16 v[48:51], a[72:75], v[232:235], v[48:51]
    v_mfma_f32_16x16x32_bf16 v[76:79], a[72:75], v[236:239], v[76:79]
    buffer_load_dwordx4 v[196:199], v0, s[24:27], s12 offen offset:1024 sc1
    ds_read_b128 a[108:111], v2 offset:11264
    v_mfma_f32_16x16x32_bf16 v[52:55], a[76:79], v[232:235], v[52:55]
    v_mfma_f32_16x16x32_bf16 v[80:83], a[76:79], v[236:239], v[80:83]
    ds_read_b128 a[72:75], v2 offset:12288
    s_waitcnt vmcnt(8)
    v_max_u32 v16, v227, v231
    v_cmp_eq_u32 vcc, -1, v16
    s_waitcnt lgkmcnt(7)
    v_mfma_f32_16x16x32_bf16 v[56:59], a[80:83], v[232:235], v[56:59]
    v_mfma_f32_16x16x32_bf16 v[84:87], a[80:83], v[236:239], v[84:87]
    ds_read_b128 a[76:79], v2 offset:13312
    v_mfma_f32_16x16x32_bf16 v[60:63], a[84:87], v[232:235], v[60:63]
    v_mfma_f32_16x16x32_bf16 v[88:91], a[84:87], v[236:239], v[88:91]
    buffer_load_dwordx4 v[184:187], v2, s[24:27], s12 offen offset:2048 sc1
    ds_read_b128 a[80:83], v2 offset:14336
    s_waitcnt lgkmcnt(7)
    v_mfma_f32_16x16x32_bf16 v[64:67], a[88:91], v[232:235], v[64:67]
    v_mfma_f32_16x16x32_bf16 v[92:95], a[88:91], v[236:239], v[92:95]
    s_cbranch_vccnz M_x5r
M_x5b:
    ds_read_b128 a[84:87], v2 offset:15360
    v_mfma_f32_16x16x32_bf16 v[40:43], a[92:95], v[224:227], v[40:43]
    v_mfma_f32_16x16x32_bf16 v[68:71], a[92:95], v[228:231], v[68:71]
    buffer_load_dwordx4 v[188:191], v0, s[24:27], s12 offen offset:2048 sc1
    ds_read_b128 a[88:91], v2 offset:16384
    s_waitcnt lgkmcnt(7)
    v_mfma_f32_16x16x32_bf16 v[44:47], a[96:99], v[224:227], v[44:47]
    v_mfma_f32_16x16x32_bf16 v[72:75], a[96:99], v[228:231], v[72:75]
    ds_read_b128 a[92:95], v2 offset:17408
    v_mfma_f32_16x16x32_bf16 v[48:51], a[100:103], v[224:227], v[48:51]
    v_mfma_f32_16x16x32_bf16 v[76:79], a[100:103], v[228:231], v[76:79]
    buffer_load_dwordx4 v[176:179], v2, s[24:27], s12 offen offset:3072 sc1
    ds_read_b128 a[96:99], v2 offset:18432
    s_waitcnt lgkmcnt(7)
    v_mfma_f32_16x16x32_bf16 v[52:55], a[104:107], v[224:227], v[52:55]
    v_mfma_f32_16x16x32_bf16 v[80:83], a[104:107], v[228:231], v[80:83]
    ds_read_b128 a[100:103], v2 offset:19456
    s_waitcnt vmcnt(9)
    v_max_u32 v16, v219, v223
    v_cmp_eq_u32_e64 vcc, -1, v16
    v_mfma_f32_16x16x32_bf16 v[56:59], a[108:111], v[224:227], v[56:59]
    v_mfma_f32_16x16x32_bf16 v[84:87], a[108:111], v[228:231], v[84:87]
    ds_read_b128 a[104:107], v2 offset:20480
    s_waitcnt lgkmcnt(7)
    v_mfma_f32_16x16x32_bf16 v[60:63], a[72:75], v[224:227], v[60:63]
    v_mfma_f32_16x16x32_bf16 v[88:91], a[72:75], v[228:231], v[88:91]
    buffer_load_dwordx4 v[180:183], v0, s[24:27], s12 offen offset:3072 sc1
    ds_read_b128 a[108:111], v2 offset:21504
    v_mfma_f32_16x16x32_bf16 v[64:67], a[76:79], v[224:227], v[64:67]
    v_mfma_f32_16x16x32_bf16 v[92:95], a[76:79], v[228:231], v[92:95]
    s_cbranch_vccnz M_x6r
M_x6b:
    ds_read_b128 a[72:75], v2 offset:22528
    s_waitcnt lgkmcnt(7)
    v_mfma_f32_16x16x32_bf16 v[40:43], a[80:83], v[216:219], v[40:43]
    v_mfma_f32_16x16x32_bf16 v[68:71], a[80:83], v[220:223], v[68:71]
    s_add_u32 s12, s58, 8192
    buffer_load_dwordx4 v[168:171], v2, s[24:27], s12 offen offset:0 sc1
    ds_read_b128 a[76:79], v2 offset:23552
    v_mfma_f32_16x16x32_bf16 v[44:47], a[84:87], v[216:219], v[44:47]
    v_mfma_f32_16x16x32_bf16 v[72:75], a[84:87], v[220:223], v[72:75]
    ds_read_b128 a[80:83], v2 offset:24576
    s_waitcnt lgkmcnt(7)
    v_mfma_f32_16x16x32_bf16 v[48:51], a[88:91], v[216:219], v[48:51]
    v_mfma_f32_16x16x32_bf16 v[76:79], a[88:91], v[220:223], v[76:79]
    buffer_load_dwordx4 v[172:175], v0, s[24:27], s12 offen offset:0 sc1
    ds_read_b128 a[84:87], v2 offset:25600
    v_mfma_f32_16x16x32_bf16 v[52:55], a[92:95], v[216:219], v[52:55]
    v_mfma_f32_16x16x32_bf16 v[80:83], a[92:95], v[220:223], v[80:83]
    ds_read_b128 a[88:91], v2 offset:26624
    s_waitcnt vmcnt(10)
    v_max_u32 v16, v211, v215
    v_cmp_eq_u32 vcc, -1, v16
    s_waitcnt lgkmcnt(7)
    v_mfma_f32_16x16x32_bf16 v[56:59], a[96:99], v[216:219], v[56:59]
    v_mfma_f32_16x16x32_bf16 v[84:87], a[96:99], v[220:223], v[84:87]
    ds_read_b128 a[92:95], v2 offset:27648
    v_mfma_f32_16x16x32_bf16 v[60:63], a[100:103], v[216:219], v[60:63]
    v_mfma_f32_16x16x32_bf16 v[88:91], a[100:103], v[220:223], v[88:91]
    buffer_load_dwordx4 v[160:163], v2, s[24:27], s12 offen offset:1024 sc1
    ds_read_b128 a[96:99], v2 offset:28672
    s_waitcnt lgkmcnt(7)
    v_mfma_f32_16x16x32_bf16 v[64:67], a[104:107], v[216:219], v[64:67]
    v_mfma_f32_16x16x32_bf16 v[92:95], a[104:107], v[220:223], v[92:95]
    s_cbranch_vccnz M_x7r
M_x7b:
    ds_read_b128 a[100:103], v2 offset:29696
    v_mfma_f32_16x16x32_bf16 v[40:43], a[108:111], v[208:211], v[40:43]
    v_mfma_f32_16x16x32_bf16 v[68:71], a[108:111], v[212:215], v[68:71]
    buffer_load_dwordx4 v[164:167], v0, s[24:27], s12 offen offset:1024 sc1
    ds_read_b128 a[104:107], v2 offset:30720
    s_waitcnt lgkmcnt(7)
    v_mfma_f32_16x16x32_bf16 v[44:47], a[72:75], v[208:211], v[44:47]
    v_mfma_f32_16x16x32_bf16 v[72:75], a[72:75], v[212:215], v[72:75]
    ds_read_b128 a[108:111], v2 offset:31744
    v_mfma_f32_16x16x32_bf16 v[48:51], a[76:79], v[208:211], v[48:51]
    v_mfma_f32_16x16x32_bf16 v[76:79], a[76:79], v[212:215], v[76:79]
    buffer_load_dwordx4 v[152:155], v2, s[24:27], s12 offen offset:2048 sc1
    ds_read_b128 a[72:75], v2 offset:32768
    s_waitcnt lgkmcnt(7)
    v_mfma_f32_16x16x32_bf16 v[52:55], a[80:83], v[208:211], v[52:55]
    v_mfma_f32_16x16x32_bf16 v[80:83], a[80:83], v[212:215], v[80:83]
    ds_read_b128 a[76:79], v2 offset:33792
    s_waitcnt vmcnt(11)
    v_max_u32 v16, v203, v207
    v_cmp_eq_u32_e64 vcc, -1, v16
    v_mfma_f32_16x16x32_bf16 v[56:59], a[84:87], v[208:211], v[56:59]
    v_mfma_f32_16x16x32_bf16 v[84:87], a[84:87], v[212:215], v[84:87]
    ds_read_b128 a[80:83], v2 offset:34816
    s_waitcnt lgkmcnt(7)
    v_mfma_f32_16x16x32_bf16 v[60:63], a[88:91], v[208:211], v[60:63]
    v_mfma_f32_16x16x32_bf16 v[88:91], a[88:91], v[212:215], v[88:91]
    buffer_load_dwordx4 v[156:159], v0, s[24:27], s12 offen offset:2048 sc1
    ds_read_b128 a[84:87], v2 offset:35840
    v_mfma_f32_16x16x32_bf16 v[64:67], a[92:95], v[208:211], v[64:67]
    v_mfma_f32_16x16x32_bf16 v[92:95], a[92:95], v[212:215], v[92:95]
    s_cbranch_vccnz M_x8r
M_x8b:
    ds_read_b128 a[88:91], v2 offset:36864
    s_waitcnt lgkmcnt(7)
    v_mfma_f32_16x16x32_bf16 v[40:43], a[96:99], v[200:203], v[40:43]
    v_mfma_f32_16x16x32_bf16 v[68:71], a[96:99], v[204:207], v[68:71]
    buffer_load_dwordx4 v[144:147], v2, s[24:27], s12 offen offset:3072 sc1
    ds_read_b128 a[92:95], v2 offset:37888
    v_mfma_f32_16x16x32_bf16 v[44:47], a[100:103], v[200:203], v[44:47]
    v_mfma_f32_16x16x32_bf16 v[72:75], a[100:103], v[204:207], v[72:75]
    ds_read_b128 a[96:99], v2 offset:38912
    s_waitcnt lgkmcnt(7)
    v_mfma_f32_16x16x32_bf16 v[48:51], a[104:107], v[200:203], v[48:51]
    v_mfma_f32_16x16x32_bf16 v[76:79], a[104:107], v[204:207], v[76:79]
    buffer_load_dwordx4 v[148:151], v0, s[24:27], s12 offen offset:3072 sc1
    ds_read_b128 a[100:103], v2 offset:39936
    v_mfma_f32_16x16x32_bf16 v[52:55], a[108:111], v[200:203], v[52:55]
    v_mfma_f32_16x16x32_bf16 v[80:83], a[108:111], v[204:207], v[80:83]
    ds_read_b128 a[104:107], v2 offset:40960
    s_waitcnt vmcnt(12)
    v_max_u32 v16, v195, v199
    v_cmp_eq_u32 vcc, -1, v16
    s_waitcnt lgkmcnt(7)
    v_mfma_f32_16x16x32_bf16 v[56:59], a[72:75], v[200:203], v[56:59]
    v_mfma_f32_16x16x32_bf16 v[84:87], a[72:75], v[204:207], v[84:87]
    ds_read_b128 a[108:111], v2 offset:41984
    v_mfma_f32_16x16x32_bf16 v[60:63], a[76:79], v[200:203], v[60:63]
    v_mfma_f32_16x16x32_bf16 v[88:91], a[76:79], v[204:207], v[88:91]
    s_add_u32 s12, s58, 12288
    buffer_load_dwordx4 v[136:139], v2, s[24:27], s12 offen offset:0 sc1
    ds_read_b128 a[72:75], v2 offset:43008
    s_waitcnt lgkmcnt(7)
    v_mfma_f32_16x16x32_bf16 v[64:67], a[80:83], v[200:203], v[64:67]
    v_mfma_f32_16x16x32_bf16 v[92:95], a[80:83], v[204:207], v[92:95]
    s_cbranch_vccnz M_x9r
M_x9b:
    ds_read_b128 a[76:79], v2 offset:44032
    v_mfma_f32_16x16x32_bf16 v[40:43], a[84:87], v[192:195], v[40:43]
    v_mfma_f32_16x16x32_bf16 v[68:71], a[84:87], v[196:199], v[68:71]
    buffer_load_dwordx4 v[140:143], v0, s[24:27], s12 offen offset:0 sc1
    ds_read_b128 a[80:83], v2 offset:45056
    s_waitcnt lgkmcnt(7)
    v_mfma_f32_16x16x32_bf16 v[44:47], a[88:91], v[192:195], v[44:47]
    v_mfma_f32_16x16x32_bf16 v[72:75], a[88:91], v[196:199], v[72:75]
    ds_read_b128 a[84:87], v2 offset:46080
    v_mfma_f32_16x16x32_bf16 v[48:51], a[92:95], v[192:195], v[48:51]
    v_mfma_f32_16x16x32_bf16 v[76:79], a[92:95], v[196:199], v[76:79]
    buffer_load_dwordx4 v[128:131], v2, s[24:27], s12 offen offset:1024 sc1
    ds_read_b128 a[88:91], v2 offset:47104
    s_waitcnt lgkmcnt(7)
    v_mfma_f32_16x16x32_bf16 v[52:55], a[96:99], v[192:195], v[52:55]
    v_mfma_f32_16x16x32_bf16 v[80:83], a[96:99], v[196:199], v[80:83]
    ds_read_b128 a[92:95], v2 offset:48128
    s_waitcnt vmcnt(13)
    v_max_u32 v16, v187, v191
    v_cmp_eq_u32_e64 vcc, -1, v16
    v_mfma_f32_16x16x32_bf16 v[56:59], a[100:103], v[192:195], v[56:59]
    v_mfma_f32_16x16x32_bf16 v[84:87], a[100:103], v[196:199], v[84:87]
    ds_read_b128 a[96:99], v2 offset:49152
    s_waitcnt lgkmcnt(7)
    v_mfma_f32_16x16x32_bf16 v[60:63], a[104:107], v[192:195], v[60:63]
    v_mfma_f32_16x16x32_bf16 v[88:91], a[104:107], v[196:199], v[88:91]
    buffer_load_dwordx4 v[132:135], v0, s[24:27], s12 offen offset:1024 sc1
    ds_read_b128 a[100:103], v2 offset:50176
    v_mfma_f32_16x16x32_bf16 v[64:67], a[108:111], v[192:195], v[64:67]
    v_mfma_f32_16x16x32_bf16 v[92:95], a[108:111], v[196:199], v[92:95]
    s_cbranch_vccnz M_x10r
M_x10b:
    ds_read_b128 a[104:107], v2 offset:51200
    s_waitcnt lgkmcnt(7)
    v_mfma_f32_16x16x32_bf16 v[40:43], a[72:75], v[184:187], v[40:43]
    v_mfma_f32_16x16x32_bf16 v[68:71], a[72:75], v[188:191], v[68:71]
    ds_read_b128 a[108:111], v2 offset:52224
    v_mfma_f32_16x16x32_bf16 v[44:47], a[76:79], v[184:187], v[44:47]
    v_mfma_f32_16x16x32_bf16 v[72:75], a[76:79], v[188:191], v[72:75]
    ds_read_b128 a[72:75], v2 offset:53248
    s_waitcnt lgkmcnt(7)
    v_mfma_f32_16x16x32_bf16 v[48:51], a[80:83], v[184:187], v[48:51]
    v_mfma_f32_16x16x32_bf16 v[76:79], a[80:83], v[188:191], v[76:79]
    s_barrier
    ds_read_b128 a[76:79], v2 offset:54272
    v_mfma_f32_16x16x32_bf16 v[52:55], a[84:87], v[184:187], v[52:55]
    v_mfma_f32_16x16x32_bf16 v[80:83], a[84:87], v[188:191], v[80:83]
    ds_read_b128 a[80:83], v2 offset:55296
    s_waitcnt vmcnt(12)
    v_max_u32 v16, v179, v183
    v_cmp_eq_u32_e64 vcc, -1, v16
    s_waitcnt lgkmcnt(7)
    v_mfma_f32_16x16x32_bf16 v[56:59], a[88:91], v[184:187], v[56:59]
    v_mfma_f32_16x16x32_bf16 v[84:87], a[88:91], v[188:191], v[84:87]
    ds_read_b128 a[84:87], v2 offset:56320
    v_mfma_f32_16x16x32_bf16 v[60:63], a[92:95], v[184:187], v[60:63]
    v_mfma_f32_16x16x32_bf16 v[88:91], a[92:95], v[188:191], v[88:91]
    s_mul_i32 s13, s3, 7168
    s_min_u32 s13, s13, 21504
    s_add_u32 s14, s13, s61
    s_add_u32 s13, s13, 100352
    s_mov_b32 m0, s13
    s_nop 0
    buffer_load_dwordx4 v2, s[24:27], s14 offen offset:0 lds
    ds_read_b128 a[88:91], v2 offset:57344
    s_waitcnt lgkmcnt(7)
    v_mfma_f32_16x16x32_bf16 v[64:67], a[96:99], v[184:187], v[64:67]
    v_mfma_f32_16x16x32_bf16 v[92:95], a[96:99], v[188:191], v[92:95]
    s_cbranch_vccnz M_x11r
M_x11b:
    ds_read_b128 a[92:95], v2 offset:58368
    v_mfma_f32_16x16x32_bf16 v[40:43], a[100:103], v[176:179], v[40:43]
    v_mfma_f32_16x16x32_bf16 v[68:71], a[100:103], v[180:183], v[68:71]
    buffer_load_dwordx4 v2, s[24:27], s14 offen offset:1024 lds
    ds_read_b128 a[96:99], v2 offset:59392
    s_waitcnt lgkmcnt(7)
    v_mfma_f32_16x16x32_bf16 v[44:47], a[104:107], v[176:179], v[44:47]
    v_mfma_f32_16x16x32_bf16 v[72:75], a[104:107], v[180:183], v[72:75]
    ds_read_b128 a[100:103], v2 offset:60416
    v_mfma_f32_16x16x32_bf16 v[48:51], a[108:111], v[176:179], v[48:51]
    v_mfma_f32_16x16x32_bf16 v[76:79], a[108:111], v[180:183], v[76:79]
    buffer_load_dwordx4 v2, s[24:27], s14 offen offset:2048 lds
    ds_read_b128 a[104:107], v2 offset:61440
    s_waitcnt lgkmcnt(7)
    v_mfma_f32_16x16x32_bf16 v[52:55], a[72:75], v[176:179], v[52:55]
    v_mfma_f32_16x16x32_bf16 v[80:83], a[72:75], v[180:183], v[80:83]
    ds_read_b128 a[108:111], v2 offset:62464
    s_waitcnt vmcnt(13)
    v_max_u32 v16, v171, v175
    v_cmp_eq_u32 vcc, -1, v16
    v_mfma_f32_16x16x32_bf16 v[56:59], a[76:79], v[176:179], v[56:59]
    v_mfma_f32_16x16x32_bf16 v[84:87], a[76:79], v[180:183], v[84:87]
    ds_read_b128 a[72:75], v2 offset:63488
    s_waitcnt lgkmcnt(7)
    v_mfma_f32_16x16x32_bf16 v[60:63], a[80:83], v[176:179], v[60:63]
    v_mfma_f32_16x16x32_bf16 v[88:91], a[80:83], v[180:183], v[88:91]
    buffer_load_dwordx4 v2, s[24:27], s14 offen offset:3072 lds
    ds_read_b128 a[76:79], v2 offset:64512
    v_mfma_f32_16x16x32_bf16 v[64:67], a[84:87], v[176:179], v[64:67]
    v_mfma_f32_16x16x32_bf16 v[92:95], a[84:87], v[180:183], v[92:95]
    s_cbranch_vccnz M_x12r
M_x12b:
    ds_read_b128 a[80:83], v5 offset:0
    s_waitcnt lgkmcnt(7)
    v_mfma_f32_16x16x32_bf16 v[40:43], a[88:91], v[168:171], v[40:43]
    v_mfma_f32_16x16x32_bf16 v[68:71], a[88:91], v[172:175], v[68:71]
    s_add_u32 s13, s13, 4096
    s_add_u32 s14, s14, 4096
    s_mov_b32 m0, s13
    s_nop 0
    buffer_load_dwordx4 v2, s[24:27], s14 offen offset:0 lds
    ds_read_b128 a[84:87], v5 offset:1024
    v_mfma_f32_16x16x32_bf16 v[44:47], a[92:95], v[168:171], v[44:47]
    v_mfma_f32_16x16x32_bf16 v[72:75], a[92:95], v[172:175], v[72:75]
    ds_read_b128 a[88:91], v5 offset:2048
    s_waitcnt lgkmcnt(7)
    v_mfma_f32_16x16x32_bf16 v[48:51], a[96:99], v[168:171], v[48:51]
    v_mfma_f32_16x16x32_bf16 v[76:79], a[96:99], v[172:175], v[76:79]
    buffer_load_dwordx4 v2, s[24:27], s14 offen offset:1024 lds
    ds_read_b128 a[92:95], v5 offset:3072
    v_mfma_f32_16x16x32_bf16 v[52:55], a[100:103], v[168:171], v[52:55]
    v_mfma_f32_16x16x32_bf16 v[80:83], a[100:103], v[172:175], v[80:83]
    ds_read_b128 a[96:99], v5 offset:4096
    s_waitcnt vmcnt(14)
    v_max_u32 v16, v163, v167
    v_cmp_eq_u32 vcc, -1, v16
    s_waitcnt lgkmcnt(7)
    v_mfma_f32_16x16x32_bf16 v[56:59], a[104:107], v[168:171], v[56:59]
    v_mfma_f32_16x16x32_bf16 v[84:87], a[104:107], v[172:175], v[84:87]
    ds_read_b128 a[100:103], v5 offset:5120
    v_mfma_f32_16x16x32_bf16 v[60:63], a[108:111], v[168:171], v[60:63]
    v_mfma_f32_16x16x32_bf16 v[88:91], a[108:111], v[172:175], v[88:91]
    buffer_load_dwordx4 v2, s[24:27], s14 offen offset:2048 lds
    ds_read_b128 a[104:107], v5 offset:6144
    s_waitcnt lgkmcnt(7)
    v_mfma_f32_16x16x32_bf16 v[64:67], a[72:75], v[168:171], v[64:67]
    v_mfma_f32_16x16x32_bf16 v[92:95], a[72:75], v[172:175], v[92:95]
    s_cbranch_vccnz M_x13r
M_x13b:
    ds_read_b128 a[108:111], v5 offset:7168
    v_mfma_f32_16x16x32_bf16 v[40:43], a[76:79], v[160:163], v[40:43]
    v_mfma_f32_16x16x32_bf16 v[68:71], a[76:79], v[164:167], v[68:71]
    s_mul_i32 s13, s3, 4096
    s_min_u32 s13, s13, 9216
    s_add_u32 s14, s13, s61
    s_add_u32 s14, s14, 59392
    s_add_u32 s13, s13, 29696
    s_mov_b32 m0, s13
    s_nop 0
    buffer_load_dwordx4 v2, s[24:27], s14 offen offset:0 lds
    ds_read_b128 a[72:75], v5 offset:8192
    s_waitcnt lgkmcnt(7)
    v_mfma_f32_16x16x32_bf16 v[44:47], a[80:83], v[160:163], v[44:47]
    v_mfma_f32_16x16x32_bf16 v[72:75], a[80:83], v[164:167], v[72:75]
    ds_read_b128 a[76:79], v5 offset:9216
    v_mfma_f32_16x16x32_bf16 v[48:51], a[84:87], v[160:163], v[48:51]
    v_mfma_f32_16x16x32_bf16 v[76:79], a[84:87], v[164:167], v[76:79]
    buffer_load_dwordx4 v2, s[24:27], s14 offen offset:1024 lds
    ds_read_b128 a[80:83], v5 offset:10240
    s_waitcnt lgkmcnt(7)
    v_mfma_f32_16x16x32_bf16 v[52:55], a[88:91], v[160:163], v[52:55]
    v_mfma_f32_16x16x32_bf16 v[80:83], a[88:91], v[164:167], v[80:83]
    ds_read_b128 a[84:87], v5 offset:11264
    s_waitcnt vmcnt(15)
    v_max_u32 v16, v155, v159
    v_cmp_eq_u32 vcc, -1, v16
    v_mfma_f32_16x16x32_bf16 v[56:59], a[92:95], v[160:163], v[56:59]
    v_mfma_f32_16x16x32_bf16 v[84:87], a[92:95], v[164:167], v[84:87]
    ds_read_b128 a[88:91], v5 offset:12288
    s_waitcnt lgkmcnt(7)
    v_mfma_f32_16x16x32_bf16 v[60:63], a[96:99], v[160:163], v[60:63]
    v_mfma_f32_16x16x32_bf16 v[88:91], a[96:99], v[164:167], v[88:91]
    buffer_load_dwordx4 v2, s[24:27], s14 offen offset:2048 lds
    ds_read_b128 a[92:95], v5 offset:13312
    v_mfma_f32_16x16x32_bf16 v[64:67], a[100:103], v[160:163], v[64:67]
    v_mfma_f32_16x16x32_bf16 v[92:95], a[100:103], v[164:167], v[92:95]
    s_cbranch_vccnz M_x14r
M_x14b:
    ds_read_b128 a[96:99], v5 offset:14336
    s_waitcnt lgkmcnt(7)
    v_mfma_f32_16x16x32_bf16 v[40:43], a[104:107], v[152:155], v[40:43]
    v_mfma_f32_16x16x32_bf16 v[68:71], a[104:107], v[156:159], v[68:71]
    buffer_load_dwordx4 v2, s[24:27], s14 offen offset:3072 lds
    ds_read_b128 a[100:103], v5 offset:15360
    v_mfma_f32_16x16x32_bf16 v[44:47], a[108:111], v[152:155], v[44:47]
    v_mfma_f32_16x16x32_bf16 v[72:75], a[108:111], v[156:159], v[72:75]
    ds_read_b128 a[104:107], v5 offset:16384
    s_waitcnt lgkmcnt(7)
    v_mfma_f32_16x16x32_bf16 v[48:51], a[72:75], v[152:155], v[48:51]
    v_mfma_f32_16x16x32_bf16 v[76:79], a[72:75], v[156:159], v[76:79]
    ds_read_b128 a[108:111], v5 offset:17408
    v_mfma_f32_16x16x32_bf16 v[52:55], a[76:79], v[152:155], v[52:55]
    v_mfma_f32_16x16x32_bf16 v[80:83], a[76:79], v[156:159], v[80:83]
    ds_read_b128 a[72:75], v5 offset:18432
    s_waitcnt vmcnt(15)
    v_max_u32 v16, v147, v151
    v_cmp_eq_u32 vcc, -1, v16
    s_waitcnt lgkmcnt(7)
    v_mfma_f32_16x16x32_bf16 v[56:59], a[80:83], v[152:155], v[56:59]
    v_mfma_f32_16x16x32_bf16 v[84:87], a[80:83], v[156:159], v[84:87]
    ds_read_b128 a[76:79], v5 offset:19456
    v_mfma_f32_16x16x32_bf16 v[60:63], a[84:87], v[152:155], v[60:63]
    v_mfma_f32_16x16x32_bf16 v[88:91], a[84:87], v[156:159], v[88:91]
    ds_read_b128 a[80:83], v5 offset:20480
    s_waitcnt lgkmcnt(7)
    v_mfma_f32_16x16x32_bf16 v[64:67], a[88:91], v[152:155], v[64:67]
    v_mfma_f32_16x16x32_bf16 v[92:95], a[88:91], v[156:159], v[92:95]
    s_cbranch_vccnz M_x15r
M_x15b:
    ds_read_b128 a[84:87], v5 offset:21504
    v_mfma_f32_16x16x32_bf16 v[40:43], a[92:95], v[144:147], v[40:43]
    v_mfma_f32_16x16x32_bf16 v[68:71], a[92:95], v[148:151], v[68:71]
    ds_read_b128 a[88:91], v5 offset:22528
    s_waitcnt lgkmcnt(7)
    v_mfma_f32_16x16x32_bf16 v[44:47], a[96:99], v[144:147], v[44:47]
    v_mfma_f32_16x16x32_bf16 v[72:75], a[96:99], v[148:151], v[72:75]
    ds_read_b128 a[92:95], v5 offset:23552
    v_mfma_f32_16x16x32_bf16 v[48:51], a[100:103], v[144:147], v[48:51]
    v_mfma_f32_16x16x32_bf16 v[76:79], a[100:103], v[148:151], v[76:79]
    ds_read_b128 a[96:99], v5 offset:24576
    s_waitcnt lgkmcnt(7)
    v_mfma_f32_16x16x32_bf16 v[52:55], a[104:107], v[144:147], v[52:55]
    v_mfma_f32_16x16x32_bf16 v[80:83], a[104:107], v[148:151], v[80:83]
    ds_read_b128 a[100:103], v5 offset:25600
    s_waitcnt vmcnt(13)
    v_max_u32 v16, v139, v143
    v_cmp_eq_u32_e64 vcc, -1, v16
    v_mfma_f32_16x16x32_bf16 v[56:59], a[108:111], v[144:147], v[56:59]
    v_mfma_f32_16x16x32_bf16 v[84:87], a[108:111], v[148:151], v[84:87]
    ds_read_b128 a[104:107], v5 offset:26624
    s_waitcnt lgkmcnt(7)
    v_mfma_f32_16x16x32_bf16 v[60:63], a[72:75], v[144:147], v[60:63]
    v_mfma_f32_16x16x32_bf16 v[88:91], a[72:75], v[148:151], v[88:91]
    ds_read_b128 a[108:111], v5 offset:27648
    v_mfma_f32_16x16x32_bf16 v[64:67], a[76:79], v[144:147], v[64:67]
    v_mfma_f32_16x16x32_bf16 v[92:95], a[76:79], v[148:151], v[92:95]
    s_cbranch_vccnz M_x16r
M_x16b:
    ds_read_b128 a[72:75], v5 offset:28672
    s_waitcnt lgkmcnt(7)
    v_mfma_f32_16x16x32_bf16 v[40:43], a[80:83], v[136:139], v[40:43]
    v_mfma_f32_16x16x32_bf16 v[68:71], a[80:83], v[140:143], v[68:71]
    ds_read_b128 a[76:79], v5 offset:29696
    v_mfma_f32_16x16x32_bf16 v[44:47], a[84:87], v[136:139], v[44:47]
    v_mfma_f32_16x16x32_bf16 v[72:75], a[84:87], v[140:143], v[72:75]
    ds_read_b128 a[80:83], v5 offset:30720
    s_waitcnt lgkmcnt(7)
    v_mfma_f32_16x16x32_bf16 v[48:51], a[88:91], v[136:139], v[48:51]
    v_mfma_f32_16x16x32_bf16 v[76:79], a[88:91], v[140:143], v[76:79]
    ds_read_b128 a[84:87], v5 offset:31744
    v_mfma_f32_16x16x32_bf16 v[52:55], a[92:95], v[136:139], v[52:55]
    v_mfma_f32_16x16x32_bf16 v[80:83], a[92:95], v[140:143], v[80:83]
    ds_read_b128 a[88:91], v5 offset:32768
    s_waitcnt vmcnt(11)
    v_max_u32 v16, v131, v135
    v_cmp_eq_u32 vcc, -1, v16
    s_waitcnt lgkmcnt(7)
    v_mfma_f32_16x16x32_bf16 v[56:59], a[96:99], v[136:139], v[56:59]
    v_mfma_f32_16x16x32_bf16 v[84:87], a[96:99], v[140:143], v[84:87]
    ds_read_b128 a[92:95], v5 offset:33792
    v_mfma_f32_16x16x32_bf16 v[60:63], a[100:103], v[136:139], v[60:63]
    v_mfma_f32_16x16x32_bf16 v[88:91], a[100:103], v[140:143], v[88:91]
    s_waitcnt lgkmcnt(6)
    v_mfma_f32_16x16x32_bf16 v[64:67], a[104:107], v[136:139], v[64:67]
    v_mfma_f32_16x16x32_bf16 v[92:95], a[104:107], v[140:143], v[92:95]
    s_cbranch_vccnz M_x17r
M_x17b:
    v_mfma_f32_16x16x32_bf16 v[40:43], a[108:111], v[128:131], v[40:43]
    v_mfma_f32_16x16x32_bf16 v[68:71], a[108:111], v[132:135], v[68:71]
    s_waitcnt lgkmcnt(4)
    v_mfma_f32_16x16x32_bf16 v[44:47], a[72:75], v[128:131], v[44:47]
    v_mfma_f32_16x16x32_bf16 v[72:75], a[72:75], v[132:135], v[72:75]
    v_mfma_f32_16x16x32_bf16 v[48:51], a[76:79], v[128:131], v[48:51]
    v_mfma_f32_16x16x32_bf16 v[76:79], a[76:79], v[132:135], v[76:79]
    s_waitcnt lgkmcnt(2)
    v_mfma_f32_16x16x32_bf16 v[52:55], a[80:83], v[128:131], v[52:55]
    v_mfma_f32_16x16x32_bf16 v[80:83], a[80:83], v[132:135], v[80:83]
    v_mfma_f32_16x16x32_bf16 v[56:59], a[84:87], v[128:131], v[56:59]
    v_mfma_f32_16x16x32_bf16 v[84:87], a[84:87], v[132:135], v[84:87]
    s_waitcnt lgkmcnt(0)
    v_mfma_f32_16x16x32_bf16 v[60:63], a[88:91], v[128:131], v[60:63]
    v_mfma_f32_16x16x32_bf16 v[88:91], a[88:91], v[132:135], v[88:91]
    v_mfma_f32_16x16x32_bf16 v[64:67], a[92:95], v[128:131], v[64:67]
    v_mfma_f32_16x16x32_bf16 v[92:95], a[92:95], v[132:135], v[92:95]
    s_mov_b32 s10, 0x40000000
M_feat:
    s_nop 7
    s_nop 0
    v_cvt_pk_bf16_f32 v172, v49, v50
    v_cvt_pk_bf16_f32 v173, v51, v52
    v_cvt_pk_bf16_f32 v174, v53, v54
    v_cvt_pk_bf16_f32 v175, v55, v56
    v_cvt_pk_bf16_f32 v176, v57, v240
    v_cvt_pk_bf16_f32 v178, v77, v78
    v_cvt_pk_bf16_f32 v179, v79, v80
    v_cvt_pk_bf16_f32 v180, v81, v82
    v_cvt_pk_bf16_f32 v181, v83, v84
    v_cvt_pk_bf16_f32 v182, v85, v240
    v_max3_f32 v16, v40, v41, v42
    v_max3_f32 v17, -v40, -v41, -v42
    v_max3_f32 v18, v43, v44, v45
    v_max3_f32 v19, -v43, -v44, -v45
    v_max3_f32 v24, v68, v69, v70
    v_max3_f32 v25, -v68, -v69, -v70
    v_max3_f32 v26, v71, v72, v73
    v_max3_f32 v27, -v71, -v72, -v73
    v_max3_f32 v16, v16, v46, v47
    v_max3_f32 v17, v17, -v46, -v47
    v_max3_f32 v24, v24, v74, v75
    v_max3_f32 v25, v25, -v74, -v75
    v_max3_f32 v16, v16, v18, v48
    v_max3_f32 v17, v17, v19, -v48
    v_max3_f32 v24, v24, v26, v76
    v_max3_f32 v25, v25, v27, -v76
    ds_write_b32 v7, v172 offset:0
    ds_write_b32 v7, v173 offset:4
    ds_write_b32 v7, v174 offset:8
    ds_write_b32 v7, v175 offset:12
    ds_write_b32 v7, v176 offset:16
    ds_write_b32 v7, v178 offset:3712
    ds_write_b32 v7, v179 offset:3716
    ds_write_b32 v7, v180 offset:3720
    ds_write_b32 v7, v181 offset:3724
    ds_write_b32 v7, v182 offset:3728
    v_permlane16_swap_b32 v16, v17
    v_permlane16_swap_b32 v24, v25
    v_max_f32 v16, v16, v17
    v_max_f32 v24, v24, v25
    v_mov_b32 v17, v16
    v_mov_b32_e64 v25, v24
    s_nop 0
    v_permlane16_swap_b32 v16, v17
    v_permlane16_swap_b32 v24, v25
    v_pk_mul_f32 v[16:17], v[16:17], s[44:45] neg_lo:[0,1] neg_hi:[0,1]
    v_pk_mul_f32 v[24:25], v[24:25], s[44:45] neg_lo:[0,1] neg_hi:[0,1]
    v_pk_fma_f32 v[136:137], v[40:41], s[44:45], v[16:17] op_sel_hi:[1,1,0]
    v_pk_fma_f32 v[144:145], v[40:41], s[44:45], v[16:17] op_sel:[0,0,1] op_sel_hi:[1,1,1] neg_lo:[1,0,0] neg_hi:[1,0,0]
    v_pk_fma_f32 v[138:139], v[42:43], s[44:45], v[16:17] op_sel_hi:[1,1,0]
    v_pk_fma_f32 v[146:147], v[42:43], s[44:45], v[16:17] op_sel:[0,0,1] op_sel_hi:[1,1,1] neg_lo:[1,0,0] neg_hi:[1,0,0]
    v_pk_fma_f32 v[140:141], v[44:45], s[44:45], v[16:17] op_sel_hi:[1,1,0]
    v_pk_fma_f32 v[148:149], v[44:45], s[44:45], v[16:17] op_sel:[0,0,1] op_sel_hi:[1,1,1] neg_lo:[1,0,0] neg_hi:[1,0,0]
    v_pk_fma_f32 v[142:143], v[46:47], s[44:45], v[16:17] op_sel_hi:[1,1,0]
    v_pk_fma_f32 v[150:151], v[46:47], s[44:45], v[16:17] op_sel:[0,0,1] op_sel_hi:[1,1,1] neg_lo:[1,0,0] neg_hi:[1,0,0]
    v_pk_fma_f32 v[152:153], v[48:49], s[44:45], v[16:17] op_sel_hi:[0,1,1] neg_hi:[1,0,0]
    v_pk_fma_f32 v[154:155], v[68:69], s[44:45], v[24:25] op_sel_hi:[1,1,0]
    v_pk_fma_f32 v[162:163], v[68:69], s[44:45], v[24:25] op_sel:[0,0,1] op_sel_hi:[1,1,1] neg_lo:[1,0,0] neg_hi:[1,0,0]
    v_pk_fma_f32 v[156:157], v[70:71], s[44:45], v[24:25] op_sel_hi:[1,1,0]
    v_pk_fma_f32 v[164:165], v[70:71], s[44:45], v[24:25] op_sel:[0,0,1] op_sel_hi:[1,1,1] neg_lo:[1,0,0] neg_hi:[1,0,0]
    v_pk_fma_f32 v[158:159], v[72:73], s[44:45], v[24:25] op_sel_hi:[1,1,0]
    v_pk_fma_f32 v[166:167], v[72:73], s[44:45], v[24:25] op_sel:[0,0,1] op_sel_hi:[1,1,1] neg_lo:[1,0,0] neg_hi:[1,0,0]
    v_pk_fma_f32 v[160:161], v[74:75], s[44:45], v[24:25] op_sel_hi:[1,1,0]
    v_pk_fma_f32 v[168:169], v[74:75], s[44:45], v[24:25] op_sel:[0,0,1] op_sel_hi:[1,1,1] neg_lo:[1,0,0] neg_hi:[1,0,0]
    v_pk_fma_f32 v[170:171], v[76:77], s[44:45], v[24:25] op_sel_hi:[0,1,1] neg_hi:[1,0,0]
    v_exp_f32 v136, v136
    v_exp_f32 v137, v137
    v_exp_f32 v138, v138
    v_exp_f32 v139, v139
    v_exp_f32 v140, v140
    v_exp_f32 v141, v141
    v_exp_f32 v142, v142
    v_exp_f32 v143, v143
    v_exp_f32 v144, v144
    v_exp_f32 v145, v145
    v_exp_f32 v146, v146
    v_exp_f32 v147, v147
    v_exp_f32 v148, v148
    v_exp_f32 v149, v149
    v_exp_f32 v150, v150
    v_exp_f32 v151, v151
    v_exp_f32 v152, v152
    v_exp_f32 v153, v153
    v_exp_f32 v154, v154
    v_exp_f32 v155, v155
    v_exp_f32 v156, v156
    v_exp_f32 v157, v157
    v_exp_f32 v158, v158
    v_exp_f32 v159, v159
    v_exp_f32 v160, v160
    v_exp_f32 v161, v161
    v_exp_f32 v162, v162
    v_exp_f32 v163, v163
    v_exp_f32 v164, v164
    v_exp_f32 v165, v165
    v_exp_f32 v166, v166
    v_exp_f32 v167, v167
    v_exp_f32 v168, v168
    v_exp_f32 v169, v169
    v_exp_f32 v170, v170
    v_exp_f32 v171, v171
    v_pk_add_f32 v[16:17], v[136:137], v[138:139]
    v_pk_add_f32 v[18:19], v[140:141], v[142:143]
    v_pk_add_f32 v[20:21], v[144:145], v[146:147]
    v_pk_add_f32 v[22:23], v[148:149], v[150:151]
    v_pk_add_f32 v[24:25], v[154:155], v[156:157]
    v_pk_add_f32 v[26:27], v[158:159], v[160:161]
    v_pk_add_f32 v[28:29], v[162:163], v[164:165]
    v_pk_add_f32 v[30:31], v[166:167], v[168:169]
    v_pk_add_f32 v[16:17], v[16:17], v[18:19]
    v_pk_add_f32 v[20:21], v[20:21], v[22:23]
    v_pk_add_f32 v[24:25], v[24:25], v[26:27]
    v_pk_add_f32 v[28:29], v[28:29], v[30:31]
    v_add_f32 v18, v16, v17
    v_add_f32 v19, v20, v21
    v_add_f32 v26, v24, v25
    v_add_f32 v27, v28, v29
    v_pk_add_f32 v[18:19], v[18:19], v[152:153]
    v_pk_add_f32 v[26:27], v[26:27], v[170:171]
    s_nop 0
    v_permlane16_swap_b32 v18, v19
    v_permlane16_swap_b32 v26, v27
    v_add_f32 v18, v18, v19
    v_add_f32 v26, v26, v27
    v_rcp_f32 v18, v18
    v_rcp_f32 v26, v26
    v_mov_b32 v19, v18
    v_mov_b32 v27, v26
    s_nop 0
    v_permlane16_swap_b32 v18, v19
    v_permlane16_swap_b32 v26, v27
    v_pk_mul_f32 v[136:137], v[136:137], v[18:19] op_sel_hi:[1,0]
    v_pk_mul_f32 v[138:139], v[138:139], v[18:19] op_sel_hi:[1,0]
    v_pk_mul_f32 v[140:141], v[140:141], v[18:19] op_sel_hi:[1,0]
    v_pk_mul_f32 v[142:143], v[142:143], v[18:19] op_sel_hi:[1,0]
    v_pk_mul_f32 v[144:145], v[144:145], v[18:19] op_sel:[0,1] op_sel_hi:[1,1]
    v_pk_mul_f32 v[146:147], v[146:147], v[18:19] op_sel:[0,1] op_sel_hi:[1,1]
    v_pk_mul_f32 v[148:149], v[148:149], v[18:19] op_sel:[0,1] op_sel_hi:[1,1]
    v_pk_mul_f32 v[150:151], v[150:151], v[18:19] op_sel:[0,1] op_sel_hi:[1,1]
    v_pk_mul_f32 v[152:153], v[152:153], v[18:19]
    v_cvt_pk_bf16_f32 v184, v136, v137
    v_cvt_pk_bf16_f32 v185, v138, v139
    v_cvt_pk_bf16_f32 v186, v140, v141
    v_cvt_pk_bf16_f32 v187, v142, v143
    v_cvt_pk_bf16_f32 v188, v144, v145
    v_cvt_pk_bf16_f32 v189, v146, v147
    v_cvt_pk_bf16_f32 v190, v148, v149
    v_cvt_pk_bf16_f32 v191, v150, v151
    v_cvt_pk_bf16_f32 v192, v152, v153
    ds_write_b64 v6, v[184:185] offset:0
    ds_write_b64 v6, v[186:187] offset:8
    ds_write_b64 v6, v[188:189] offset:16
    ds_write_b64 v6, v[190:191] offset:24
    ds_write_b32 v250, v192 offset:64
    v_pk_mul_f32 v[154:155], v[154:155], v[26:27] op_sel_hi:[1,0]
    v_pk_mul_f32 v[156:157], v[156:157], v[26:27] op_sel_hi:[1,0]
    v_pk_mul_f32 v[158:159], v[158:159], v[26:27] op_sel_hi:[1,0]
    v_pk_mul_f32 v[160:161], v[160:161], v[26:27] op_sel_hi:[1,0]
    v_pk_mul_f32 v[162:163], v[162:163], v[26:27] op_sel:[0,1] op_sel_hi:[1,1]
    v_pk_mul_f32 v[164:165], v[164:165], v[26:27] op_sel:[0,1] op_sel_hi:[1,1]
    v_pk_mul_f32 v[166:167], v[166:167], v[26:27] op_sel:[0,1] op_sel_hi:[1,1]
    v_pk_mul_f32 v[168:169], v[168:169], v[26:27] op_sel:[0,1] op_sel_hi:[1,1]
    v_pk_mul_f32 v[170:171], v[170:171], v[26:27]
    v_cvt_pk_bf16_f32 v194, v154, v155
    v_cvt_pk_bf16_f32 v195, v156, v157
    v_cvt_pk_bf16_f32 v196, v158, v159
    v_cvt_pk_bf16_f32 v197, v160, v161
    v_cvt_pk_bf16_f32 v198, v162, v163
    v_cvt_pk_bf16_f32 v199, v164, v165
    v_cvt_pk_bf16_f32 v200, v166, v167
    v_cvt_pk_bf16_f32 v201, v168, v169
    v_cvt_pk_bf16_f32 v202, v170, v171
    ds_write_b64 v6, v[194:195] offset:3712
    ds_write_b64 v6, v[196:197] offset:3720
    ds_write_b64 v6, v[198:199] offset:3728
    ds_write_b64 v6, v[200:201] offset:3736
    ds_write_b32 v250, v202 offset:3776
    s_add_u32 s15, s73, s59
    v_mov_b32 v22, 0
    v_mov_b32 v23, 0
    s_cmp_eq_u32 s60, 0
    s_cbranch_scc0 M_nopb
    s_waitcnt vmcnt(0)
    v_xor_b32 v35, s89, v35
    v_cmp_ne_u32 vcc, s88, v34
    v_cmp_lt_u32 s[62:63], 15, v35
    s_nop 0
    s_or_b64 vcc, vcc, s[62:63]
    s_cbranch_vccnz M_pbr
M_pbb:
    s_nop 0
    buffer_load_dwordx4 v[204:207], v2, s[24:27], s82 offen offset:4 sc1
    buffer_load_dwordx4 v[208:211], v2, s[24:27], s82 offen offset:1028 sc1
    buffer_load_dwordx4 v[212:215], v2, s[24:27], s82 offen offset:0 sc1
    buffer_load_dwordx4 v[216:219], v2, s[24:27], s82 offen offset:1024 sc1
    buffer_load_dwordx4 v[220:223], v2, s[24:27], s83 offen offset:4 sc1
    buffer_load_dwordx4 v[224:227], v2, s[24:27], s83 offen sc1
M_nopb:
    s_waitcnt lgkmcnt(0)
    s_barrier
    ds_read_b64_tr_b16 v[136:137], v8 offset:0
    ds_read_b64_tr_b16 v[140:141], v9 offset:0
    ds_read_b64_tr_b16 v[144:145], v9 offset:32
    ds_read_b64_tr_b16 v[148:149], v9 offset:64
    ds_read_b64_tr_b16 v[138:139], v8 offset:232
    ds_read_b64_tr_b16 v[142:143], v9 offset:232
    ds_read_b64_tr_b16 v[146:147], v9 offset:264
    ds_read_b64_tr_b16 v[150:151], v9 offset:296
    ds_read_b64_tr_b16 v[152:153], v8 offset:7424
    ds_read_b64_tr_b16 v[156:157], v9 offset:7424
    ds_read_b64_tr_b16 v[160:161], v9 offset:7456
    ds_read_b64_tr_b16 v[164:165], v9 offset:7488
    ds_read_b64_tr_b16 v[154:155], v8 offset:7656
    ds_read_b64_tr_b16 v[158:159], v9 offset:7656
    ds_read_b64_tr_b16 v[162:163], v9 offset:7688
    ds_read_b64_tr_b16 v[166:167], v9 offset:7720
    ds_read_b64_tr_b16 v[168:169], v8 offset:14848
    ds_read_b64_tr_b16 v[172:173], v9 offset:14848
    ds_read_b64_tr_b16 v[176:177], v9 offset:14880
    ds_read_b64_tr_b16 v[180:181], v9 offset:14912
    ds_read_b64_tr_b16 v[170:171], v8 offset:15080
    ds_read_b64_tr_b16 v[174:175], v9 offset:15080
    ds_read_b64_tr_b16 v[178:179], v9 offset:15112
    ds_read_b64_tr_b16 v[182:183], v9 offset:15144
    ds_read_b64_tr_b16 v[184:185], v8 offset:22272
    ds_read_b64_tr_b16 v[188:189], v9 offset:22272
    ds_read_b64_tr_b16 v[192:193], v9 offset:22304
    ds_read_b64_tr_b16 v[196:197], v9 offset:22336
    ds_read_b64_tr_b16 v[186:187], v8 offset:22504
    ds_read_b64_tr_b16 v[190:191], v9 offset:22504
    ds_read_b64_tr_b16 v[194:195], v9 offset:22536
    ds_read_b64_tr_b16 v[198:199], v9 offset:22568
    s_waitcnt lgkmcnt(15)
    v_mfma_f32_16x16x32_bf16 v[40:43], v[140:143], v[136:139], 0
    v_mfma_f32_16x16x32_bf16 v[44:47], v[144:147], v[136:139], 0
    v_mfma_f32_16x16x32_bf16 v[48:51], v[148:151], v[136:139], 0
    v_mfma_f32_16x16x32_bf16 v[40:43], v[156:159], v[152:155], v[40:43]
    v_mfma_f32_16x16x32_bf16 v[44:47], v[160:163], v[152:155], v[44:47]
    v_mfma_f32_16x16x32_bf16 v[48:51], v[164:167], v[152:155], v[48:51]
    s_waitcnt lgkmcnt(8)
    v_mfma_f32_16x16x32_bf16 v[40:43], v[172:175], v[168:171], v[40:43]
    v_mfma_f32_16x16x32_bf16 v[44:47], v[176:179], v[168:171], v[44:47]
    v_mfma_f32_16x16x32_bf16 v[48:51], v[180:183], v[168:171], v[48:51]
    s_waitcnt lgkmcnt(0)
    v_mfma_f32_16x16x32_bf16 v[40:43], v[188:191], v[184:187], v[40:43]
    v_mfma_f32_16x16x32_bf16 v[44:47], v[192:195], v[184:187], v[44:47]
    v_mfma_f32_16x16x32_bf16 v[48:51], v[196:199], v[184:187], v[48:51]
    s_nop 5
    v_cvt_pk_bf16_f32 v16, v40, v41
    v_cvt_pk_bf16_f32 v17, v42, v43
    v_cvt_pk_bf16_f32 v18, v44, v45
    v_cvt_pk_bf16_f32 v19, v46, v47
    v_cvt_pk_bf16_f32 v20, v48, v49
    v_cvt_pk_bf16_f32 v21, v50, v51
    v_permlane16_swap_b32 v16, v18
    v_permlane16_swap_b32 v17, v19
    buffer_store_dwordx4 v[20:23], v11, s[24:27], s15 offen offset:64 sc1
    buffer_store_dwordx4 v[16:19], v10, s[24:27], s15 offen sc1
    s_cmp_eq_u32 s60, 0
    s_cbranch_scc0 M_qf
    s_mul_i32 s13, s3, 2048
    s_min_u32 s13, s13, 4096
    s_add_u32 s14, s13, s61
    s_add_u32 s14, s14, 53248
    s_add_u32 s13, s13, 153600
    s_mov_b32 m0, s13
    s_nop 0
    buffer_load_dwordx4 v2, s[24:27], s14 offen offset:0 lds
    buffer_load_dwordx4 v2, s[24:27], s14 offen offset:1024 lds
    s_mul_i32 s13, s3, 4096
    s_min_u32 s13, s13, 9216
    s_add_u32 s14, s13, s61
    s_add_u32 s14, s14, 59392
    s_add_u32 s13, s13, 29696
    s_mov_b32 m0, s13
    s_nop 0
    buffer_load_dwordx4 v2, s[24:27], s14 offen offset:0 lds
    buffer_load_dwordx4 v2, s[24:27], s14 offen offset:1024 lds
    buffer_load_dwordx4 v2, s[24:27], s14 offen offset:2048 lds
    buffer_load_dwordx4 v2, s[24:27], s14 offen offset:3072 lds
    s_lshl_b32 s4, s66, 11
    s_add_u32 s4, s4, s65
    v_add_u32 v38, s4, v2
    s_lshl_b32 s4, s3, 10
    s_add_u32 s4, s4, 135680
    v_add_u32_e64 v39, s4, v2
    ds_write_b128 v38, v[112:115] offset:64
    v_alignbit_b32 v136, v112, v124, 16
    v_alignbit_b32 v137, v113, v112, 16
    v_alignbit_b32 v138, v114, v113, 16
    v_alignbit_b32 v139, v115, v114, 16
    ds_write_b128 v38, v[136:139] offset:4288
    ds_write_b128 v38, v[116:119] offset:1088
    v_alignbit_b32 v140, v116, v125, 16
    v_alignbit_b32 v141, v117, v116, 16
    v_alignbit_b32 v142, v118, v117, 16
    v_alignbit_b32 v143, v119, v118, 16
    ds_write_b128 v38, v[140:143] offset:5312
    ds_write_b128 v39, v[120:123] offset:64
    v_alignbit_b32 v144, v120, v126, 16
    v_alignbit_b32 v145, v121, v120, 16
    v_alignbit_b32 v146, v122, v121, 16
    v_alignbit_b32 v147, v123, v122, 16
    ds_write_b128 v39, v[144:147] offset:4288
    v_mov_b32 v148, 0
    v_mov_b32 v149, 0
    v_mov_b32 v150, 0
    v_mov_b32_e64 v151, 0
    s_min_u32 s4, s3, 2
    s_mul_i32 s4, s4, 17664
    s_add_u32 s4, s4, 100352
    v_add_u32 v152, s4, v2
    s_mov_b64 exec, 0xf
    ds_write_b128 v152, v[148:151] offset:0
    ds_write_b128 v152, v[148:151] offset:4224
    s_mov_b64 exec, 0xfffffff
    ds_write_b128 v152, v[148:151] offset:12544
    ds_write_b128 v152, v[148:151] offset:17120
    s_mov_b64 exec, -1
    s_waitcnt vmcnt(8)
    s_cmp_eq_u32 s66, 1
    s_cselect_b32 s4, 63, -1
    v_cmp_ne_u32 s[62:63], s4, v1
    s_cmp_eq_u32 s3, 3
    s_cselect_b32 s4, 63, -1
    v_cmp_ne_u32_e64 vcc, s4, v1
    v_cndmask_b32 v211, 0, v211, s[62:63]
    s_nop 0
    v_cndmask_b32 v223, 0, v223, vcc
    ds_write_b128 v38, v[212:215] offset:13024
    ds_write_b128 v38, v[216:219] offset:14048
    ds_write_b128 v38, v[204:207] offset:8448
    ds_write_b128 v38, v[208:211] offset:9472
    ds_write_b128 v39, v[224:227] offset:13024
    ds_write_b128 v39, v[220:223] offset:8448
M_qf:
    v_max3_f32 v24, v58, v59, v60
    v_max3_f32 v25, -v58, -v59, -v60
    v_max3_f32 v26, v61, v62, v63
    v_max3_f32 v27, -v61, -v62, -v63
    v_max3_f32 v32, v86, v87, v88
    v_max3_f32 v33, -v86, -v87, -v88
    v_max3_f32 v34, v89, v90, v91
    v_max3_f32 v35, -v89, -v90, -v91
    v_max3_f32 v24, v24, v64, v65
    v_max3_f32 v25, v25, -v64, -v65
    v_max3_f32 v32, v32, v92, v93
    v_max3_f32 v33, v33, -v92, -v93
    v_max3_f32 v24, v24, v26, v66
    v_max3_f32 v25, v25, v27, -v66
    v_max3_f32 v32, v32, v34, v94
    v_max3_f32 v33, v33, v35, -v94
    v_permlane16_swap_b32 v24, v25
    s_nop 0
    v_permlane16_swap_b32 v32, v33
    v_max_f32 v24, v24, v25
    v_max_f32 v32, v32, v33
    v_mov_b32 v25, v24
    v_mov_b32 v33, v32
    s_nop 0
    v_permlane16_swap_b32 v24, v25
    v_permlane16_swap_b32 v32, v33
    v_pk_mul_f32 v[24:25], v[24:25], s[44:45] neg_lo:[0,1] neg_hi:[0,1]
    v_pk_mul_f32 v[32:33], v[32:33], s[44:45] neg_lo:[0,1] neg_hi:[0,1]
    v_pk_fma_f32 v[200:201], v[58:59], s[44:45], v[24:25] op_sel_hi:[1,1,0]
    v_pk_fma_f32 v[208:209], v[58:59], s[44:45], v[24:25] op_sel:[0,0,1] op_sel_hi:[1,1,1] neg_lo:[1,0,0] neg_hi:[1,0,0]
    v_pk_fma_f32 v[202:203], v[60:61], s[44:45], v[24:25] op_sel_hi:[1,1,0]
    v_pk_fma_f32 v[210:211], v[60:61], s[44:45], v[24:25] op_sel:[0,0,1] op_sel_hi:[1,1,1] neg_lo:[1,0,0] neg_hi:[1,0,0]
    v_pk_fma_f32 v[204:205], v[62:63], s[44:45], v[24:25] op_sel_hi:[1,1,0]
    v_pk_fma_f32 v[212:213], v[62:63], s[44:45], v[24:25] op_sel:[0,0,1] op_sel_hi:[1,1,1] neg_lo:[1,0,0] neg_hi:[1,0,0]
    v_pk_fma_f32 v[206:207], v[64:65], s[44:45], v[24:25] op_sel_hi:[1,1,0]
    v_pk_fma_f32 v[214:215], v[64:65], s[44:45], v[24:25] op_sel:[0,0,1] op_sel_hi:[1,1,1] neg_lo:[1,0,0] neg_hi:[1,0,0]
    v_pk_fma_f32 v[216:217], v[66:67], s[44:45], v[24:25] op_sel_hi:[0,1,1] neg_hi:[1,0,0]
    v_pk_fma_f32 v[218:219], v[86:87], s[44:45], v[32:33] op_sel_hi:[1,1,0]
    v_pk_fma_f32 v[226:227], v[86:87], s[44:45], v[32:33] op_sel:[0,0,1] op_sel_hi:[1,1,1] neg_lo:[1,0,0] neg_hi:[1,0,0]
    v_pk_fma_f32 v[220:221], v[88:89], s[44:45], v[32:33] op_sel_hi:[1,1,0]
    v_pk_fma_f32 v[228:229], v[88:89], s[44:45], v[32:33] op_sel:[0,0,1] op_sel_hi:[1,1,1] neg_lo:[1,0,0] neg_hi:[1,0,0]
    v_pk_fma_f32 v[222:223], v[90:91], s[44:45], v[32:33] op_sel_hi:[1,1,0]
    v_pk_fma_f32 v[230:231], v[90:91], s[44:45], v[32:33] op_sel:[0,0,1] op_sel_hi:[1,1,1] neg_lo:[1,0,0] neg_hi:[1,0,0]
    v_pk_fma_f32 v[224:225], v[92:93], s[44:45], v[32:33] op_sel_hi:[1,1,0]
    v_pk_fma_f32 v[232:233], v[92:93], s[44:45], v[32:33] op_sel:[0,0,1] op_sel_hi:[1,1,1] neg_lo:[1,0,0] neg_hi:[1,0,0]
    v_pk_fma_f32 v[234:235], v[94:95], s[44:45], v[32:33] op_sel_hi:[0,1,1] neg_hi:[1,0,0]
    v_exp_f32 v200, v200
    v_exp_f32 v201, v201
    v_exp_f32 v202, v202
    v_exp_f32 v203, v203
    v_exp_f32 v204, v204
    v_exp_f32 v205, v205
    v_exp_f32 v206, v206
    v_exp_f32 v207, v207
    v_exp_f32 v208, v208
    v_exp_f32 v209, v209
    v_exp_f32 v210, v210
    v_exp_f32 v211, v211
    v_exp_f32 v212, v212
    v_exp_f32 v213, v213
    v_exp_f32 v214, v214
    v_exp_f32 v215, v215
    v_exp_f32 v216, v216
    v_exp_f32 v217, v217
    v_exp_f32 v218, v218
    v_exp_f32 v219, v219
    v_exp_f32 v220, v220
    v_exp_f32 v221, v221
    v_exp_f32 v222, v222
    v_exp_f32 v223, v223
    v_exp_f32 v224, v224
    v_exp_f32 v225, v225
    v_exp_f32 v226, v226
    v_exp_f32 v227, v227
    v_exp_f32 v228, v228
    v_exp_f32 v229, v229
    v_exp_f32 v230, v230
    v_exp_f32 v231, v231
    v_exp_f32 v232, v232
    v_exp_f32 v233, v233
    v_exp_f32 v234, v234
    v_exp_f32 v235, v235
    v_pk_add_f32 v[24:25], v[200:201], v[202:203]
    v_pk_add_f32 v[26:27], v[204:205], v[206:207]
    v_pk_add_f32 v[28:29], v[208:209], v[210:211]
    v_pk_add_f32 v[30:31], v[212:213], v[214:215]
    v_pk_add_f32 v[32:33], v[218:219], v[220:221]
    v_pk_add_f32 v[34:35], v[222:223], v[224:225]
    v_pk_add_f32 v[36:37], v[226:227], v[228:229]
    v_pk_add_f32 v[38:39], v[230:231], v[232:233]
    v_pk_add_f32 v[24:25], v[24:25], v[26:27]
    v_pk_add_f32 v[28:29], v[28:29], v[30:31]
    v_pk_add_f32 v[32:33], v[32:33], v[34:35]
    v_pk_add_f32 v[36:37], v[36:37], v[38:39]
    v_add_f32 v26, v24, v25
    v_add_f32 v27, v28, v29
    v_add_f32 v34, v32, v33
    v_add_f32 v35, v36, v37
    v_pk_add_f32 v[26:27], v[26:27], v[216:217]
    v_pk_add_f32 v[34:35], v[34:35], v[234:235]
    s_nop 0
    v_permlane16_swap_b32 v26, v27
    v_permlane16_swap_b32 v34, v35
    v_add_f32 v26, v26, v27
    v_add_f32 v34, v34, v35
    v_rcp_f32 v26, v26
    v_rcp_f32 v34, v34
    v_mov_b32 v27, v26
    v_mov_b32 v35, v34
    s_nop 0
    v_permlane16_swap_b32 v26, v27
    v_permlane16_swap_b32 v34, v35
    v_pk_mul_f32 v[200:201], v[200:201], v[26:27] op_sel_hi:[1,0]
    v_pk_mul_f32 v[202:203], v[202:203], v[26:27] op_sel_hi:[1,0]
    v_pk_mul_f32 v[204:205], v[204:205], v[26:27] op_sel_hi:[1,0]
    v_pk_mul_f32 v[206:207], v[206:207], v[26:27] op_sel_hi:[1,0]
    v_pk_mul_f32 v[208:209], v[208:209], v[26:27] op_sel:[0,1] op_sel_hi:[1,1]
    v_pk_mul_f32 v[210:211], v[210:211], v[26:27] op_sel:[0,1] op_sel_hi:[1,1]
    v_pk_mul_f32 v[212:213], v[212:213], v[26:27] op_sel:[0,1] op_sel_hi:[1,1]
    v_pk_mul_f32 v[214:215], v[214:215], v[26:27] op_sel:[0,1] op_sel_hi:[1,1]
    v_pk_mul_f32 v[216:217], v[216:217], v[26:27]
    v_cvt_pk_bf16_f32 v96, v200, v201
    v_cvt_pk_bf16_f32 v97, v202, v203
    v_cvt_pk_bf16_f32 v98, v204, v205
    v_cvt_pk_bf16_f32 v99, v206, v207
    v_cvt_pk_bf16_f32 v100, v208, v209
    v_cvt_pk_bf16_f32 v101, v210, v211
    v_cvt_pk_bf16_f32 v102, v212, v213
    v_cvt_pk_bf16_f32 v103, v214, v215
    v_cvt_pk_bf16_f32 v104, v216, v217
    v_cndmask_b32 v105, v104, 0, s[90:91]
    v_cndmask_b32 v104, 0, v104, s[90:91]
    v_mov_b32 v106, 0
    v_mov_b32 v107, 0
    v_pk_mul_f32 v[218:219], v[218:219], v[34:35] op_sel_hi:[1,0]
    v_pk_mul_f32 v[220:221], v[220:221], v[34:35] op_sel_hi:[1,0]
    v_pk_mul_f32 v[222:223], v[222:223], v[34:35] op_sel_hi:[1,0]
    v_pk_mul_f32 v[224:225], v[224:225], v[34:35] op_sel_hi:[1,0]
    v_pk_mul_f32 v[226:227], v[226:227], v[34:35] op_sel:[0,1] op_sel_hi:[1,1]
    v_pk_mul_f32 v[228:229], v[228:229], v[34:35] op_sel:[0,1] op_sel_hi:[1,1]
    v_pk_mul_f32 v[230:231], v[230:231], v[34:35] op_sel:[0,1] op_sel_hi:[1,1]
    v_pk_mul_f32 v[232:233], v[232:233], v[34:35] op_sel:[0,1] op_sel_hi:[1,1]
    v_pk_mul_f32 v[234:235], v[234:235], v[34:35]
    v_cvt_pk_bf16_f32 v108, v218, v219
    v_cvt_pk_bf16_f32 v109, v220, v221
    v_cvt_pk_bf16_f32 v110, v222, v223
    v_cvt_pk_bf16_f32 v111, v224, v225
    v_cvt_pk_bf16_f32 v112, v226, v227
    v_cvt_pk_bf16_f32 v113, v228, v229
    v_cvt_pk_bf16_f32 v114, v230, v231
    v_cvt_pk_bf16_f32 v115, v232, v233
    v_cvt_pk_bf16_f32 v116, v234, v235
    v_cndmask_b32 v117, v116, 0, s[90:91]
    v_cndmask_b32 v116, 0, v116, s[90:91]
    v_mov_b32 v118, 0
    v_mov_b32 v119, 0
    s_mov_b32 s75, 0
    s_cmp_eq_u32 s60, 0
    s_cbranch_scc1 M_conv
    s_add_u32 s15, s74, s59
    buffer_load_dwordx4 v[136:139], v252, s[24:27], s15 offen offset:0 sc1
    buffer_load_dwordx4 v[140:143], v252, s[24:27], s15 offen offset:256 sc1
    buffer_load_dwordx4 v[144:147], v253, s[24:27], s15 offen offset:512 sc1
    s_add_u32 s15, s15, 12288
    buffer_load_dwordx4 v[148:151], v252, s[24:27], s15 offen offset:0 sc1
    buffer_load_dwordx4 v[152:155], v252, s[24:27], s15 offen offset:256 sc1
    buffer_load_dwordx4 v[156:159], v253, s[24:27], s15 offen offset:512 sc1
    s_add_u32 s15, s15, 12288
    buffer_load_dwordx4 v[160:163], v252, s[24:27], s15 offen offset:0 sc1
    buffer_load_dwordx4 v[164:167], v252, s[24:27], s15 offen offset:256 sc1
    buffer_load_dwordx4 v[168:171], v253, s[24:27], s15 offen offset:512 sc1
    s_add_u32 s15, s15, 12288
    buffer_load_dwordx4 v[172:175], v252, s[24:27], s15 offen offset:0 sc1
    buffer_load_dwordx4 v[176:179], v252, s[24:27], s15 offen offset:256 sc1
    buffer_load_dwordx4 v[180:183], v253, s[24:27], s15 offen offset:512 sc1
    s_branch M_gather
M_conv:
    s_waitcnt lgkmcnt(0)
    s_barrier
    v_accvgpr_read_b32 v36, a38
    v_accvgpr_read_b32 v37, a39
    v_add_u32 v38, s81, v36
    v_add_u32 v39, s81, v37
    v_mov_b32 v60, -1
    v_mov_b32 v61, -1
    v_mov_b32 v62, -1
    v_mov_b32 v63, -1
    v_and_b32 v64, 31, v1
    v_lshlrev_b32 v64, 4, v64
    v_lshrrev_b32 v65, 5, v1
    v_lshl_add_u32 v64, v65, 19, v64
    ds_read_b64 a[116:117], v36 offset:8
    ds_read_b64 a[118:119], v36 offset:0
    ds_read_b64 a[148:149], v37 offset:3592
    ds_read_b64 a[150:151], v37 offset:3584
    ds_read_b64 a[120:121], v36 offset:520
    ds_read_b64 a[122:123], v36 offset:512
    ds_read_b64 a[152:153], v37 offset:3080
    ds_read_b64 a[154:155], v37 offset:3072
    ds_read_b64 a[124:125], v36 offset:1032
    ds_read_b64 a[126:127], v36 offset:1024
    ds_read_b64 a[156:157], v37 offset:2568
    ds_read_b64 a[158:159], v37 offset:2560
    ds_read_b64 a[128:129], v36 offset:1544
    ds_read_b64 a[130:131], v36 offset:1536
    ds_read_b64 a[160:161], v37 offset:2056
    ds_read_b64 a[162:163], v37 offset:2048
    ds_read_b64 a[132:133], v36 offset:2056
    ds_read_b64 a[134:135], v36 offset:2048
    ds_read_b64 a[164:165], v37 offset:1544
    ds_read_b64 a[166:167], v37 offset:1536
    ds_read_b64 a[136:137], v36 offset:2568
    ds_read_b64 a[138:139], v36 offset:2560
    ds_read_b64 a[168:169], v37 offset:1032
    ds_read_b64 a[170:171], v37 offset:1024
    ds_read_b64 a[140:141], v36 offset:3080
    ds_read_b64 a[142:143], v36 offset:3072
    ds_read_b64 a[172:173], v37 offset:520
    ds_read_b64 a[174:175], v37 offset:512
    ds_read_b64 a[144:145], v36 offset:3592
    ds_read_b64 a[146:147], v36 offset:3584
    ds_read_b64 a[176:177], v37 offset:8
    ds_read_b64 a[178:179], v37 offset:0
    s_waitcnt lgkmcnt(15)
    v_mfma_f32_16x16x32_bf16 a[40:43], a[116:119], a[148:151], 0
    ds_read_b64 a[180:181], v36 offset:72
    v_mfma_f32_16x16x32_bf16 a[44:47], a[116:119], a[152:155], 0
    ds_read_b64 a[182:183], v36 offset:64
    v_mfma_f32_16x16x32_bf16 a[44:47], a[120:123], a[148:151], a[44:47]
    ds_read_b64 a[212:213], v37 offset:3656
    v_mfma_f32_16x16x32_bf16 a[48:51], a[120:123], a[152:155], 0
    ds_read_b64 a[214:215], v37 offset:3648
    v_mfma_f32_16x16x32_bf16 a[48:51], a[116:119], a[156:159], a[48:51]
    ds_read_b64 a[184:185], v36 offset:584
    s_lshl_b32 s4, s7, 10
    s_add_u32 s4, s4, s9
    s_add_u32 s4, s4, 0xec0000
    buffer_store_dwordx4 v[60:63], v2, s[24:27], s4 offen
    v_mfma_f32_16x16x32_bf16 a[52:55], a[120:123], a[156:159], 0
    ds_read_b64 a[186:187], v36 offset:576
    v_mfma_f32_16x16x32_bf16 a[48:51], a[124:127], a[148:151], a[48:51]
    ds_read_b64 a[216:217], v37 offset:3144
    v_mfma_f32_16x16x32_bf16 a[52:55], a[124:127], a[152:155], a[52:55]
    ds_read_b64 a[218:219], v37 offset:3136
    v_mfma_f32_16x16x32_bf16 a[56:59], a[124:127], a[156:159], 0
    ds_read_b64 a[188:189], v36 offset:1096
    v_mfma_f32_16x16x32_bf16 a[52:55], a[116:119], a[160:163], a[52:55]
    ds_read_b64 a[190:191], v36 offset:1088
    v_mfma_f32_16x16x32_bf16 a[56:59], a[120:123], a[160:163], a[56:59]
    ds_read_b64 a[220:221], v37 offset:2632
    buffer_store_dwordx4 v[60:63], v0, s[24:27], s4 offen
    v_mfma_f32_16x16x32_bf16 a[60:63], a[124:127], a[160:163], 0
    ds_read_b64 a[222:223], v37 offset:2624
    v_mfma_f32_16x16x32_bf16 a[52:55], a[128:131], a[148:151], a[52:55]
    ds_read_b64 a[192:193], v36 offset:1608
    v_mfma_f32_16x16x32_bf16 a[56:59], a[128:131], a[152:155], a[56:59]
    ds_read_b64 a[194:195], v36 offset:1600
    v_mfma_f32_16x16x32_bf16 a[60:63], a[128:131], a[156:159], a[60:63]
    ds_read_b64 a[224:225], v37 offset:2120
    v_mfma_f32_16x16x32_bf16 a[64:67], a[128:131], a[160:163], 0
    ds_read_b64 a[226:227], v37 offset:2112
    s_waitcnt lgkmcnt(15)
    v_mfma_f32_16x16x32_bf16 a[56:59], a[116:119], a[164:167], a[56:59]
    ds_read_b64 a[196:197], v36 offset:2120
    s_add_u32 s4, s70, 0xec0000
    buffer_store_dwordx2 v[60:61], v242, s[24:27], s4 offen
    v_mfma_f32_16x16x32_bf16 a[60:63], a[120:123], a[164:167], a[60:63]
    ds_read_b64 a[198:199], v36 offset:2112
    v_mfma_f32_16x16x32_bf16 a[64:67], a[124:127], a[164:167], a[64:67]
    ds_read_b64 a[228:229], v37 offset:1608
    v_mfma_f32_16x16x32_bf16 a[68:71], a[128:131], a[164:167], 0
    ds_read_b64 a[230:231], v37 offset:1600
    v_mfma_f32_16x16x32_bf16 a[56:59], a[132:135], a[148:151], a[56:59]
    ds_read_b64 a[200:201], v36 offset:2632
    v_mfma_f32_16x16x32_bf16 a[60:63], a[132:135], a[152:155], a[60:63]
    ds_read_b64 a[202:203], v36 offset:2624
    v_mfma_f32_16x16x32_bf16 a[64:67], a[132:135], a[156:159], a[64:67]
    ds_read_b64 a[232:233], v37 offset:1096
    s_add_u32 s4, s4, 18432
    buffer_store_dwordx2 v[60:61], v242, s[24:27], s4 offen
    v_mfma_f32_16x16x32_bf16 a[68:71], a[132:135], a[160:163], a[68:71]
    ds_read_b64 a[234:235], v37 offset:1088
    v_mfma_f32_16x16x32_bf16 a[60:63], a[116:119], a[168:171], a[60:63]
    ds_read_b64 a[204:205], v36 offset:3144
    v_mfma_f32_16x16x32_bf16 a[64:67], a[120:123], a[168:171], a[64:67]
    ds_read_b64 a[206:207], v36 offset:3136
    v_mfma_f32_16x16x32_bf16 a[68:71], a[124:127], a[168:171], a[68:71]
    ds_read_b64 a[236:237], v37 offset:584
    v_mfma_f32_16x16x32_bf16 a[60:63], a[136:139], a[148:151], a[60:63]
    ds_read_b64 a[238:239], v37 offset:576
    v_mfma_f32_16x16x32_bf16 a[64:67], a[136:139], a[152:155], a[64:67]
    ds_read_b64 a[208:209], v36 offset:3656
    s_lshl_b32 s4, s17, 11
    s_add_u32 s4, s4, s50
    s_lshl_b32 s5, s3, 9
    s_add_u32 s4, s4, s5
    buffer_store_dwordx4 v[60:63], v64, s[24:27], s4 offen
    v_mfma_f32_16x16x32_bf16 a[68:71], a[136:139], a[156:159], a[68:71]
    ds_read_b64 a[210:211], v36 offset:3648
    v_mfma_f32_16x16x32_bf16 a[64:67], a[116:119], a[172:175], a[64:67]
    ds_read_b64 a[240:241], v37 offset:72
    v_mfma_f32_16x16x32_bf16 a[68:71], a[120:123], a[172:175], a[68:71]
    ds_read_b64 a[242:243], v37 offset:64
    v_mfma_f32_16x16x32_bf16 a[64:67], a[140:143], a[148:151], a[64:67]
    v_mfma_f32_16x16x32_bf16 a[68:71], a[140:143], a[152:155], a[68:71]
    v_mfma_f32_16x16x32_bf16 a[68:71], a[116:119], a[176:179], a[68:71]
    buffer_store_dwordx4 v[60:63], v244, s[24:27], s71 offen
    v_mfma_f32_16x16x32_bf16 a[68:71], a[144:147], a[148:151], a[68:71]
    s_waitcnt lgkmcnt(15)
    v_mfma_f32_16x16x32_bf16 a[40:43], a[180:183], a[212:215], a[40:43]
    ds_read_b64 a[116:117], v36 offset:136
    v_mfma_f32_16x16x32_bf16 a[44:47], a[180:183], a[216:219], a[44:47]
    ds_read_b64 a[118:119], v36 offset:128
    v_mfma_f32_16x16x32_bf16 a[44:47], a[184:187], a[212:215], a[44:47]
    ds_read_b64 a[148:149], v37 offset:3720
    v_mfma_f32_16x16x32_bf16 a[48:51], a[184:187], a[216:219], a[48:51]
    ds_read_b64 a[150:151], v37 offset:3712
    v_mfma_f32_16x16x32_bf16 a[48:51], a[180:183], a[220:223], a[48:51]
    ds_read_b64 a[120:121], v36 offset:648
    buffer_store_dwordx4 v[60:63], v244, s[24:27], s71 offen offset:256
    v_mfma_f32_16x16x32_bf16 a[52:55], a[184:187], a[220:223], a[52:55]
    ds_read_b64 a[122:123], v36 offset:640
    v_mfma_f32_16x16x32_bf16 a[48:51], a[188:191], a[212:215], a[48:51]
    ds_read_b64 a[152:153], v37 offset:3208
    v_mfma_f32_16x16x32_bf16 a[52:55], a[188:191], a[216:219], a[52:55]
    ds_read_b64 a[154:155], v37 offset:3200
    v_mfma_f32_16x16x32_bf16 a[56:59], a[188:191], a[220:223], a[56:59]
    ds_read_b64 a[124:125], v36 offset:1160
    v_mfma_f32_16x16x32_bf16 a[52:55], a[180:183], a[224:227], a[52:55]
    ds_read_b64 a[126:127], v36 offset:1152
    v_mfma_f32_16x16x32_bf16 a[56:59], a[184:187], a[224:227], a[56:59]
    ds_read_b64 a[156:157], v37 offset:2696
    buffer_store_dword v60, v245, s[24:27], s72 offen
    s_cmp_lg_u32 s8, 0
    s_cbranch_scc1 M_plg
M_plb:
    v_mfma_f32_16x16x32_bf16 a[60:63], a[188:191], a[224:227], a[60:63]
    ds_read_b64 a[158:159], v37 offset:2688
    v_mfma_f32_16x16x32_bf16 a[52:55], a[192:195], a[212:215], a[52:55]
    ds_read_b64 a[128:129], v36 offset:1672
    v_mfma_f32_16x16x32_bf16 a[56:59], a[192:195], a[216:219], a[56:59]
    ds_read_b64 a[130:131], v36 offset:1664
    v_mfma_f32_16x16x32_bf16 a[60:63], a[192:195], a[220:223], a[60:63]
    ds_read_b64 a[160:161], v37 offset:2184
    v_mfma_f32_16x16x32_bf16 a[64:67], a[192:195], a[224:227], a[64:67]
    ds_read_b64 a[162:163], v37 offset:2176
    s_waitcnt lgkmcnt(15)
    v_mfma_f32_16x16x32_bf16 a[56:59], a[180:183], a[228:231], a[56:59]
    ds_read_b64 a[132:133], v36 offset:2184
    v_mfma_f32_16x16x32_bf16 a[60:63], a[184:187], a[228:231], a[60:63]
    ds_read_b64 a[134:135], v36 offset:2176
    v_mfma_f32_16x16x32_bf16 a[64:67], a[188:191], a[228:231], a[64:67]
    ds_read_b64 a[164:165], v37 offset:1672
    v_mfma_f32_16x16x32_bf16 a[68:71], a[192:195], a[228:231], a[68:71]
    ds_read_b64 a[166:167], v37 offset:1664
    v_mfma_f32_16x16x32_bf16 a[56:59], a[196:199], a[212:215], a[56:59]
    ds_read_b64 a[136:137], v36 offset:2696
    v_mfma_f32_16x16x32_bf16 a[60:63], a[196:199], a[216:219], a[60:63]
    ds_read_b64 a[138:139], v36 offset:2688
    v_mfma_f32_16x16x32_bf16 a[64:67], a[196:199], a[220:223], a[64:67]
    ds_read_b64 a[168:169], v37 offset:1160
    v_mfma_f32_16x16x32_bf16 a[68:71], a[196:199], a[224:227], a[68:71]
    ds_read_b64 a[170:171], v37 offset:1152
    v_mfma_f32_16x16x32_bf16 a[60:63], a[180:183], a[232:235], a[60:63]
    ds_read_b64 a[140:141], v36 offset:3208
    v_mfma_f32_16x16x32_bf16 a[64:67], a[184:187], a[232:235], a[64:67]
    ds_read_b64 a[142:143], v36 offset:3200
    v_mfma_f32_16x16x32_bf16 a[68:71], a[188:191], a[232:235], a[68:71]
    ds_read_b64 a[172:173], v37 offset:648
    v_mfma_f32_16x16x32_bf16 a[60:63], a[200:203], a[212:215], a[60:63]
    ds_read_b64 a[174:175], v37 offset:640
    v_mfma_f32_16x16x32_bf16 a[64:67], a[200:203], a[216:219], a[64:67]
    ds_read_b64 a[144:145], v36 offset:3720
    v_mfma_f32_16x16x32_bf16 a[68:71], a[200:203], a[220:223], a[68:71]
    ds_read_b64 a[146:147], v36 offset:3712
    v_mfma_f32_16x16x32_bf16 a[64:67], a[180:183], a[236:239], a[64:67]
    ds_read_b64 a[176:177], v37 offset:136
    v_mfma_f32_16x16x32_bf16 a[68:71], a[184:187], a[236:239], a[68:71]
    ds_read_b64 a[178:179], v37 offset:128
    v_mfma_f32_16x16x32_bf16 a[64:67], a[204:207], a[212:215], a[64:67]
    s_add_u32 s15, s74, s59
    buffer_load_dwordx4 v[136:139], v252, s[24:27], s15 offen offset:0 sc1
    v_mfma_f32_16x16x32_bf16 a[68:71], a[204:207], a[216:219], a[68:71]
    v_mfma_f32_16x16x32_bf16 a[68:71], a[180:183], a[240:243], a[68:71]
    v_mfma_f32_16x16x32_bf16 a[68:71], a[208:211], a[212:215], a[68:71]
    buffer_load_dwordx4 v[140:143], v252, s[24:27], s15 offen offset:256 sc1
    s_waitcnt lgkmcnt(15)
    v_mfma_f32_16x16x32_bf16 a[40:43], a[116:119], a[148:151], a[40:43]
    ds_read_b64 a[180:181], v36 offset:200
    v_mfma_f32_16x16x32_bf16 a[44:47], a[116:119], a[152:155], a[44:47]
    ds_read_b64 a[182:183], v36 offset:192
    v_mfma_f32_16x16x32_bf16 a[44:47], a[120:123], a[148:151], a[44:47]
    ds_read_b64 a[212:213], v37 offset:3784
    buffer_load_dwordx4 v[144:147], v253, s[24:27], s15 offen offset:512 sc1
    v_mfma_f32_16x16x32_bf16 a[48:51], a[120:123], a[152:155], a[48:51]
    ds_read_b64 a[214:215], v37 offset:3776
    v_mfma_f32_16x16x32_bf16 a[48:51], a[116:119], a[156:159], a[48:51]
    ds_read_b64 a[184:185], v36 offset:712
    v_mfma_f32_16x16x32_bf16 a[52:55], a[120:123], a[156:159], a[52:55]
    ds_read_b64 a[186:187], v36 offset:704
    s_add_u32 s15, s15, 12288
    buffer_load_dwordx4 v[148:151], v252, s[24:27], s15 offen offset:0 sc1
    v_mfma_f32_16x16x32_bf16 a[48:51], a[124:127], a[148:151], a[48:51]
    ds_read_b64 a[216:217], v37 offset:3272
    v_mfma_f32_16x16x32_bf16 a[52:55], a[124:127], a[152:155], a[52:55]
    ds_read_b64 a[218:219], v37 offset:3264
    v_mfma_f32_16x16x32_bf16 a[56:59], a[124:127], a[156:159], a[56:59]
    ds_read_b64 a[188:189], v36 offset:1224
    buffer_load_dwordx4 v[152:155], v252, s[24:27], s15 offen offset:256 sc1
    v_mfma_f32_16x16x32_bf16 a[52:55], a[116:119], a[160:163], a[52:55]
    ds_read_b64 a[190:191], v36 offset:1216
    v_mfma_f32_16x16x32_bf16 a[56:59], a[120:123], a[160:163], a[56:59]
    ds_read_b64 a[220:221], v37 offset:2760
    v_mfma_f32_16x16x32_bf16 a[60:63], a[124:127], a[160:163], a[60:63]
    ds_read_b64 a[222:223], v37 offset:2752
    buffer_load_dwordx4 v[156:159], v253, s[24:27], s15 offen offset:512 sc1
    v_mfma_f32_16x16x32_bf16 a[52:55], a[128:131], a[148:151], a[52:55]
    ds_read_b64 a[192:193], v36 offset:1736
    v_mfma_f32_16x16x32_bf16 a[56:59], a[128:131], a[152:155], a[56:59]
    ds_read_b64 a[194:195], v36 offset:1728
    v_mfma_f32_16x16x32_bf16 a[60:63], a[128:131], a[156:159], a[60:63]
    ds_read_b64 a[224:225], v37 offset:2248
    s_add_u32 s15, s15, 12288
    buffer_load_dwordx4 v[160:163], v252, s[24:27], s15 offen offset:0 sc1
    v_mfma_f32_16x16x32_bf16 a[64:67], a[128:131], a[160:163], a[64:67]
    ds_read_b64 a[226:227], v37 offset:2240
    s_waitcnt lgkmcnt(15)
    v_mfma_f32_16x16x32_bf16 a[56:59], a[116:119], a[164:167], a[56:59]
    ds_read_b64 a[196:197], v36 offset:2248
    v_mfma_f32_16x16x32_bf16 a[60:63], a[120:123], a[164:167], a[60:63]
    ds_read_b64 a[198:199], v36 offset:2240
    buffer_load_dwordx4 v[164:167], v252, s[24:27], s15 offen offset:256 sc1
    v_mfma_f32_16x16x32_bf16 a[64:67], a[124:127], a[164:167], a[64:67]
    ds_read_b64 a[228:229], v37 offset:1736
    v_mfma_f32_16x16x32_bf16 a[68:71], a[128:131], a[164:167], a[68:71]
    ds_read_b64 a[230:231], v37 offset:1728
    v_mfma_f32_16x16x32_bf16 a[56:59], a[132:135], a[148:151], a[56:59]
    ds_read_b64 a[200:201], v36 offset:2760
    buffer_load_dwordx4 v[168:171], v253, s[24:27], s15 offen offset:512 sc1
    v_mfma_f32_16x16x32_bf16 a[60:63], a[132:135], a[152:155], a[60:63]
    ds_read_b64 a[202:203], v36 offset:2752
    v_mfma_f32_16x16x32_bf16 a[64:67], a[132:135], a[156:159], a[64:67]
    ds_read_b64 a[232:233], v37 offset:1224
    v_mfma_f32_16x16x32_bf16 a[68:71], a[132:135], a[160:163], a[68:71]
    ds_read_b64 a[234:235], v37 offset:1216
    s_add_u32 s15, s15, 12288
    buffer_load_dwordx4 v[172:175], v252, s[24:27], s15 offen offset:0 sc1
    v_mfma_f32_16x16x32_bf16 a[60:63], a[116:119], a[168:171], a[60:63]
    ds_read_b64 a[204:205], v36 offset:3272
    v_mfma_f32_16x16x32_bf16 a[64:67], a[120:123], a[168:171], a[64:67]
    ds_read_b64 a[206:207], v36 offset:3264
    v_mfma_f32_16x16x32_bf16 a[68:71], a[124:127], a[168:171], a[68:71]
    ds_read_b64 a[236:237], v37 offset:712
    buffer_load_dwordx4 v[176:179], v252, s[24:27], s15 offen offset:256 sc1
    v_mfma_f32_16x16x32_bf16 a[60:63], a[136:139], a[148:151], a[60:63]
    ds_read_b64 a[238:239], v37 offset:704
    v_mfma_f32_16x16x32_bf16 a[64:67], a[136:139], a[152:155], a[64:67]
    ds_read_b64 a[208:209], v36 offset:3784
    v_mfma_f32_16x16x32_bf16 a[68:71], a[136:139], a[156:159], a[68:71]
    ds_read_b64 a[210:211], v36 offset:3776
    buffer_load_dwordx4 v[180:183], v253, s[24:27], s15 offen offset:512 sc1
    v_mfma_f32_16x16x32_bf16 a[64:67], a[116:119], a[172:175], a[64:67]
    ds_read_b64 a[240:241], v37 offset:200
    v_mfma_f32_16x16x32_bf16 a[68:71], a[120:123], a[172:175], a[68:71]
    ds_read_b64 a[242:243], v37 offset:192
    v_mfma_f32_16x16x32_bf16 a[64:67], a[140:143], a[148:151], a[64:67]
    v_mfma_f32_16x16x32_bf16 a[68:71], a[140:143], a[152:155], a[68:71]
    v_mfma_f32_16x16x32_bf16 a[68:71], a[116:119], a[176:179], a[68:71]
    v_mfma_f32_16x16x32_bf16 a[68:71], a[144:147], a[148:151], a[68:71]
    s_waitcnt lgkmcnt(15)
    v_mfma_f32_16x16x32_bf16 a[40:43], a[180:183], a[212:215], a[40:43]
    ds_read_b64 a[116:117], v38 offset:8
    v_mfma_f32_16x16x32_bf16 a[44:47], a[180:183], a[216:219], a[44:47]
    ds_read_b64 a[118:119], v38 offset:0
    v_mfma_f32_16x16x32_bf16 a[44:47], a[184:187], a[212:215], a[44:47]
    ds_read_b64 a[148:149], v39 offset:3592
    v_mfma_f32_16x16x32_bf16 a[48:51], a[184:187], a[216:219], a[48:51]
    ds_read_b64 a[150:151], v39 offset:3584
    v_mfma_f32_16x16x32_bf16 a[48:51], a[180:183], a[220:223], a[48:51]
    ds_read_b64 a[120:121], v38 offset:520
    v_mfma_f32_16x16x32_bf16 a[52:55], a[184:187], a[220:223], a[52:55]
    ds_read_b64 a[122:123], v38 offset:512
    v_mfma_f32_16x16x32_bf16 a[48:51], a[188:191], a[212:215], a[48:51]
    ds_read_b64 a[152:153], v39 offset:3080
    v_mfma_f32_16x16x32_bf16 a[52:55], a[188:191], a[216:219], a[52:55]
    ds_read_b64 a[154:155], v39 offset:3072
    v_mfma_f32_16x16x32_bf16 a[56:59], a[188:191], a[220:223], a[56:59]
    ds_read_b64 a[124:125], v38 offset:1032
    v_mfma_f32_16x16x32_bf16 a[52:55], a[180:183], a[224:227], a[52:55]
    ds_read_b64 a[126:127], v38 offset:1024
    v_mfma_f32_16x16x32_bf16 a[56:59], a[184:187], a[224:227], a[56:59]
    ds_read_b64 a[156:157], v39 offset:2568
    v_mfma_f32_16x16x32_bf16 a[60:63], a[188:191], a[224:227], a[60:63]
    ds_read_b64 a[158:159], v39 offset:2560
    v_mfma_f32_16x16x32_bf16 a[52:55], a[192:195], a[212:215], a[52:55]
    ds_read_b64 a[128:129], v38 offset:1544
    v_mfma_f32_16x16x32_bf16 a[56:59], a[192:195], a[216:219], a[56:59]
    ds_read_b64 a[130:131], v38 offset:1536
    v_mfma_f32_16x16x32_bf16 a[60:63], a[192:195], a[220:223], a[60:63]
    ds_read_b64 a[160:161], v39 offset:2056
    v_mfma_f32_16x16x32_bf16 a[64:67], a[192:195], a[224:227], a[64:67]
    ds_read_b64 a[162:163], v39 offset:2048
    s_waitcnt lgkmcnt(15)
    v_mfma_f32_16x16x32_bf16 a[56:59], a[180:183], a[228:231], a[56:59]
    ds_read_b64 a[132:133], v38 offset:2056
    v_mfma_f32_16x16x32_bf16 a[60:63], a[184:187], a[228:231], a[60:63]
    ds_read_b64 a[134:135], v38 offset:2048
    v_mfma_f32_16x16x32_bf16 a[64:67], a[188:191], a[228:231], a[64:67]
    ds_read_b64 a[164:165], v39 offset:1544
    v_mfma_f32_16x16x32_bf16 a[68:71], a[192:195], a[228:231], a[68:71]
    ds_read_b64 a[166:167], v39 offset:1536
    v_mfma_f32_16x16x32_bf16 a[56:59], a[196:199], a[212:215], a[56:59]
    ds_read_b64 a[136:137], v38 offset:2568
    v_mfma_f32_16x16x32_bf16 a[60:63], a[196:199], a[216:219], a[60:63]
    ds_read_b64 a[138:139], v38 offset:2560
    v_mfma_f32_16x16x32_bf16 a[64:67], a[196:199], a[220:223], a[64:67]
    ds_read_b64 a[168:169], v39 offset:1032
    v_mfma_f32_16x16x32_bf16 a[68:71], a[196:199], a[224:227], a[68:71]
    ds_read_b64 a[170:171], v39 offset:1024
    v_mfma_f32_16x16x32_bf16 a[60:63], a[180:183], a[232:235], a[60:63]
    ds_read_b64 a[140:141], v38 offset:3080
    v_mfma_f32_16x16x32_bf16 a[64:67], a[184:187], a[232:235], a[64:67]
    ds_read_b64 a[142:143], v38 offset:3072
    v_mfma_f32_16x16x32_bf16 a[68:71], a[188:191], a[232:235], a[68:71]
    ds_read_b64 a[172:173], v39 offset:520
    v_mfma_f32_16x16x32_bf16 a[60:63], a[200:203], a[212:215], a[60:63]
    ds_read_b64 a[174:175], v39 offset:512
    v_mfma_f32_16x16x32_bf16 a[64:67], a[200:203], a[216:219], a[64:67]
    ds_read_b64 a[144:145], v38 offset:3592
    v_mfma_f32_16x16x32_bf16 a[68:71], a[200:203], a[220:223], a[68:71]
    ds_read_b64 a[146:147], v38 offset:3584
    v_mfma_f32_16x16x32_bf16 a[64:67], a[180:183], a[236:239], a[64:67]
    ds_read_b64 a[176:177], v39 offset:8
    v_mfma_f32_16x16x32_bf16 a[68:71], a[184:187], a[236:239], a[68:71]
    ds_read_b64 a[178:179], v39 offset:0
    v_mfma_f32_16x16x32_bf16 a[64:67], a[204:207], a[212:215], a[64:67]
    v_mfma_f32_16x16x32_bf16 a[68:71], a[204:207], a[216:219], a[68:71]
    v_mfma_f32_16x16x32_bf16 a[68:71], a[180:183], a[240:243], a[68:71]
    v_mfma_f32_16x16x32_bf16 a[68:71], a[208:211], a[212:215], a[68:71]
    s_nop 4
    ds_read_b64 a[180:181], v38 offset:72
    ds_read_b64 a[182:183], v38 offset:64
    ds_read_b64 a[212:213], v39 offset:3656
    ds_read_b64 a[214:215], v39 offset:3648
    ds_read_b64 a[184:185], v38 offset:584
    ds_read_b64 a[186:187], v38 offset:576
    ds_read_b64 a[216:217], v39 offset:3144
    ds_read_b64 a[218:219], v39 offset:3136
    ds_read_b64 a[188:189], v38 offset:1096
    ds_read_b64 a[190:191], v38 offset:1088
    ds_read_b64 a[220:221], v39 offset:2632
    ds_read_b64 a[222:223], v39 offset:2624
    ds_read_b64 a[192:193], v38 offset:1608
    ds_read_b64 a[194:195], v38 offset:1600
    ds_read_b64 a[224:225], v39 offset:2120
    ds_read_b64 a[226:227], v39 offset:2112
    ds_read_b64 a[196:197], v38 offset:2120
    ds_read_b64 a[198:199], v38 offset:2112
    ds_read_b64 a[228:229], v39 offset:1608
    ds_read_b64 a[230:231], v39 offset:1600
    ds_read_b64 a[200:201], v38 offset:2632
    ds_read_b64 a[202:203], v38 offset:2624
    ds_read_b64 a[232:233], v39 offset:1096
    ds_read_b64 a[234:235], v39 offset:1088
    ds_read_b64 a[204:205], v38 offset:3144
    ds_read_b64 a[206:207], v38 offset:3136
    ds_read_b64 a[236:237], v39 offset:584
    ds_read_b64 a[238:239], v39 offset:576
    ds_read_b64 a[208:209], v38 offset:3656
    ds_read_b64 a[210:211], v38 offset:3648
    ds_read_b64 a[240:241], v39 offset:72
    ds_read_b64 a[242:243], v39 offset:64
    s_cmp_eq_u32 s69, 1
    s_cbranch_scc1 M_t3_1
    s_cmp_eq_u32 s69, 2
    s_cbranch_scc1 M_t3_2
    s_cmp_eq_u32 s69, 3
    s_cbranch_scc1 M_t3_3
    s_waitcnt lgkmcnt(15)
    v_mfma_f32_16x16x32_bf16 a[244:247], a[116:119], a[148:151], 0
    v_mfma_f32_16x16x32_bf16 a[248:251], a[128:131], a[164:167], 0
    v_mfma_f32_16x16x32_bf16 a[248:251], a[132:135], a[160:163], a[248:251]
    v_mfma_f32_16x16x32_bf16 a[248:251], a[124:127], a[168:171], a[248:251]
    v_mfma_f32_16x16x32_bf16 a[248:251], a[136:139], a[156:159], a[248:251]
    v_mfma_f32_16x16x32_bf16 a[248:251], a[120:123], a[172:175], a[248:251]
    v_mfma_f32_16x16x32_bf16 a[248:251], a[140:143], a[152:155], a[248:251]
    v_mfma_f32_16x16x32_bf16 a[248:251], a[116:119], a[176:179], a[248:251]
    v_mfma_f32_16x16x32_bf16 a[248:251], a[144:147], a[148:151], a[248:251]
    v_mfma_f32_16x16x32_bf16 a[244:247], a[180:183], a[212:215], a[244:247]
    s_waitcnt lgkmcnt(12)
    v_mfma_f32_16x16x32_bf16 a[248:251], a[192:195], a[228:231], a[248:251]
    v_mfma_f32_16x16x32_bf16 a[248:251], a[196:199], a[224:227], a[248:251]
    s_waitcnt lgkmcnt(8)
    v_mfma_f32_16x16x32_bf16 a[248:251], a[188:191], a[232:235], a[248:251]
    v_mfma_f32_16x16x32_bf16 a[248:251], a[200:203], a[220:223], a[248:251]
    s_waitcnt lgkmcnt(4)
    v_mfma_f32_16x16x32_bf16 a[248:251], a[184:187], a[236:239], a[248:251]
    v_mfma_f32_16x16x32_bf16 a[248:251], a[204:207], a[216:219], a[248:251]
    s_waitcnt lgkmcnt(0)
    v_mfma_f32_16x16x32_bf16 a[248:251], a[180:183], a[240:243], a[248:251]
    v_mfma_f32_16x16x32_bf16 a[248:251], a[208:211], a[212:215], a[248:251]
    s_branch M_t3_end
M_t3_1:
    s_waitcnt lgkmcnt(15)
    v_mfma_f32_16x16x32_bf16 a[244:247], a[116:119], a[152:155], 0
    v_mfma_f32_16x16x32_bf16 a[244:247], a[120:123], a[148:151], a[244:247]
    v_mfma_f32_16x16x32_bf16 a[248:251], a[128:131], a[160:163], 0
    v_mfma_f32_16x16x32_bf16 a[248:251], a[124:127], a[164:167], a[248:251]
    v_mfma_f32_16x16x32_bf16 a[248:251], a[132:135], a[156:159], a[248:251]
    v_mfma_f32_16x16x32_bf16 a[248:251], a[120:123], a[168:171], a[248:251]
    v_mfma_f32_16x16x32_bf16 a[248:251], a[136:139], a[152:155], a[248:251]
    v_mfma_f32_16x16x32_bf16 a[248:251], a[116:119], a[172:175], a[248:251]
    v_mfma_f32_16x16x32_bf16 a[248:251], a[140:143], a[148:151], a[248:251]
    v_mfma_f32_16x16x32_bf16 a[244:247], a[180:183], a[216:219], a[244:247]
    v_mfma_f32_16x16x32_bf16 a[244:247], a[184:187], a[212:215], a[244:247]
    v_mfma_f32_16x16x32_bf16 a[248:251], a[192:195], a[224:227], a[248:251]
    s_waitcnt lgkmcnt(12)
    v_mfma_f32_16x16x32_bf16 a[248:251], a[188:191], a[228:231], a[248:251]
    v_mfma_f32_16x16x32_bf16 a[248:251], a[196:199], a[220:223], a[248:251]
    s_waitcnt lgkmcnt(8)
    v_mfma_f32_16x16x32_bf16 a[248:251], a[184:187], a[232:235], a[248:251]
    v_mfma_f32_16x16x32_bf16 a[248:251], a[200:203], a[216:219], a[248:251]
    s_waitcnt lgkmcnt(4)
    v_mfma_f32_16x16x32_bf16 a[248:251], a[180:183], a[236:239], a[248:251]
    v_mfma_f32_16x16x32_bf16 a[248:251], a[204:207], a[212:215], a[248:251]
    s_branch M_t3_end
M_t3_2:
    s_waitcnt lgkmcnt(15)
    v_mfma_f32_16x16x32_bf16 a[244:247], a[120:123], a[152:155], 0
    v_mfma_f32_16x16x32_bf16 a[244:247], a[116:119], a[156:159], a[244:247]
    v_mfma_f32_16x16x32_bf16 a[244:247], a[124:127], a[148:151], a[244:247]
    v_mfma_f32_16x16x32_bf16 a[248:251], a[124:127], a[160:163], 0
    v_mfma_f32_16x16x32_bf16 a[248:251], a[128:131], a[156:159], a[248:251]
    v_mfma_f32_16x16x32_bf16 a[248:251], a[120:123], a[164:167], a[248:251]
    v_mfma_f32_16x16x32_bf16 a[248:251], a[132:135], a[152:155], a[248:251]
    v_mfma_f32_16x16x32_bf16 a[248:251], a[116:119], a[168:171], a[248:251]
    v_mfma_f32_16x16x32_bf16 a[248:251], a[136:139], a[148:151], a[248:251]
    v_mfma_f32_16x16x32_bf16 a[244:247], a[184:187], a[216:219], a[244:247]
    v_mfma_f32_16x16x32_bf16 a[244:247], a[180:183], a[220:223], a[244:247]
    v_mfma_f32_16x16x32_bf16 a[244:247], a[188:191], a[212:215], a[244:247]
    v_mfma_f32_16x16x32_bf16 a[248:251], a[188:191], a[224:227], a[248:251]
    v_mfma_f32_16x16x32_bf16 a[248:251], a[192:195], a[220:223], a[248:251]
    s_waitcnt lgkmcnt(12)
    v_mfma_f32_16x16x32_bf16 a[248:251], a[184:187], a[228:231], a[248:251]
    v_mfma_f32_16x16x32_bf16 a[248:251], a[196:199], a[216:219], a[248:251]
    s_waitcnt lgkmcnt(8)
    v_mfma_f32_16x16x32_bf16 a[248:251], a[180:183], a[232:235], a[248:251]
    v_mfma_f32_16x16x32_bf16 a[248:251], a[200:203], a[212:215], a[248:251]
    s_branch M_t3_end
M_t3_3:
    s_waitcnt lgkmcnt(15)
    v_mfma_f32_16x16x32_bf16 a[244:247], a[120:123], a[156:159], 0
    v_mfma_f32_16x16x32_bf16 a[244:247], a[124:127], a[152:155], a[244:247]
    v_mfma_f32_16x16x32_bf16 a[248:251], a[124:127], a[156:159], 0
    v_mfma_f32_16x16x32_bf16 a[244:247], a[116:119], a[160:163], a[244:247]
    v_mfma_f32_16x16x32_bf16 a[244:247], a[128:131], a[148:151], a[244:247]
    v_mfma_f32_16x16x32_bf16 a[248:251], a[120:123], a[160:163], a[248:251]
    v_mfma_f32_16x16x32_bf16 a[248:251], a[128:131], a[152:155], a[248:251]
    v_mfma_f32_16x16x32_bf16 a[248:251], a[116:119], a[164:167], a[248:251]
    v_mfma_f32_16x16x32_bf16 a[248:251], a[132:135], a[148:151], a[248:251]
    v_mfma_f32_16x16x32_bf16 a[244:247], a[184:187], a[220:223], a[244:247]
    v_mfma_f32_16x16x32_bf16 a[244:247], a[188:191], a[216:219], a[244:247]
    v_mfma_f32_16x16x32_bf16 a[248:251], a[188:191], a[220:223], a[248:251]
    v_mfma_f32_16x16x32_bf16 a[244:247], a[180:183], a[224:227], a[244:247]
    v_mfma_f32_16x16x32_bf16 a[244:247], a[192:195], a[212:215], a[244:247]
    v_mfma_f32_16x16x32_bf16 a[248:251], a[184:187], a[224:227], a[248:251]
    v_mfma_f32_16x16x32_bf16 a[248:251], a[192:195], a[216:219], a[248:251]
    s_waitcnt lgkmcnt(12)
    v_mfma_f32_16x16x32_bf16 a[248:251], a[180:183], a[228:231], a[248:251]
    v_mfma_f32_16x16x32_bf16 a[248:251], a[196:199], a[212:215], a[248:251]
M_t3_end:
    v_and_b32 v227, 1, v3
    v_lshrrev_b32 v228, 1, v3
    v_lshlrev_b32 v229, 4, v4
    v_lshl_add_u32 v229, v228, 6, v229
    v_lshl_add_u32 v230, v227, 2, v229
    v_lshl_add_u32 v231, v227, 9, v229
    v_sub_u32 v232, 15572, v230
    s_lshl_b32 s4, s66, 11
    s_sub_u32 s4, s65, s4
    v_add_u32_e64 v232, s4, v232
    ds_read_b32 v36, v232 offset:1536
    ds_read_b32 v37, v232 offset:1544
    ds_read_b32 v38, v232 offset:1024
    ds_read_b32 v39, v232 offset:1032
    ds_read_b32 v40, v232 offset:512
    ds_read_b32 v41, v232 offset:520
    ds_read_b32 v42, v232 offset:0
    ds_read_b32 v43, v232 offset:8
    s_lshl_b32 s4, s69, 9
    s_sub_u32 s5, 152788, s4
    v_sub_u32 v232, s5, v230
    s_add_u32 s5, s4, 149204
    v_sub_u32_e64 v233, s5, v230
    ds_read_b32 v44, v232
    ds_read_b32 v45, v232 offset:8
    ds_read_b32 v46, v233
    ds_read_b32 v47, v233 offset:8
    s_lshl_b32 s4, s4, 1
    s_sub_u32 s4, 3584, s4
    v_mad_u32_u24 v226, v227, s4, v229
    s_lshl_b32 s4, s3, 12
    v_add_u32 v234, s4, v2
    s_lshl_b32 s4, s3, 11
    v_add_u32_e64 v233, s4, v2
    s_waitcnt lgkmcnt(0)
    s_barrier
    ds_write_b128 v233, a[244:247] offset:16384
    ds_write_b128 v233, a[248:251] offset:17408
    s_cmp_eq_u32 s66, 0
    s_cbranch_scc0 M_conv_x1
    ds_write_b128 v234, a[56:59] offset:0
    ds_write_b128 v234, a[60:63] offset:1024
    ds_write_b128 v234, a[64:67] offset:2048
    ds_write_b128 v234, a[68:71] offset:3072
    v_accvgpr_read_b32 v48, a40
    v_accvgpr_read_b32 v49, a41
    v_accvgpr_read_b32 v50, a42
    v_accvgpr_read_b32 v51, a43
    v_accvgpr_read_b32 v52, a44
    v_accvgpr_read_b32 v53, a45
    v_accvgpr_read_b32 v54, a46
    v_accvgpr_read_b32 v55, a47
    v_accvgpr_read_b32 v56, a48
    v_accvgpr_read_b32 v57, a49
    v_accvgpr_read_b32 v58, a50
    v_accvgpr_read_b32 v59, a51
    v_accvgpr_read_b32 v60, a52
    v_accvgpr_read_b32 v61, a53
    v_accvgpr_read_b32 v62, a54
    v_accvgpr_read_b32 v63, a55
    s_branch M_conv_x2
M_conv_x1:
    s_nop 0
    ds_write_b128 v234, a[40:43] offset:0
    ds_write_b128 v234, a[44:47] offset:1024
    ds_write_b128 v234, a[48:51] offset:2048
    ds_write_b128 v234, a[52:55] offset:3072
    v_accvgpr_read_b32 v48, a56
    v_accvgpr_read_b32 v49, a57
    v_accvgpr_read_b32 v50, a58
    v_accvgpr_read_b32 v51, a59
    v_accvgpr_read_b32 v52, a60
    v_accvgpr_read_b32 v53, a61
    v_accvgpr_read_b32 v54, a62
    v_accvgpr_read_b32 v55, a63
    v_accvgpr_read_b32 v56, a64
    v_accvgpr_read_b32 v57, a65
    v_accvgpr_read_b32 v58, a66
    v_accvgpr_read_b32 v59, a67
    v_accvgpr_read_b32 v60, a68
    v_accvgpr_read_b32 v61, a69
    v_accvgpr_read_b32 v62, a70
    v_accvgpr_read_b32 v63, a71
M_conv_x2:
    s_mul_i32 s13, s3, 7168
    s_min_u32 s13, s13, 21504
    s_add_u32 s14, s13, s61
    s_add_u32 s13, s13, 100352
    s_mov_b32 m0, s13
    s_nop 0
    s_nop 0
    buffer_load_dwordx4 v2, s[24:27], s14 offen offset:0 lds
    buffer_load_dwordx4 v2, s[24:27], s14 offen offset:1024 lds
    buffer_load_dwordx4 v2, s[24:27], s14 offen offset:2048 lds
    buffer_load_dwordx4 v2, s[24:27], s14 offen offset:3072 lds
    v_xor_b32 v234, 0x1000, v234
    s_add_u32 s76, s67, 0x1500000
    s_waitcnt lgkmcnt(0)
    s_barrier
    ds_read_b128 v[64:67], v234 offset:0
    ds_read_b128 v[68:71], v234 offset:1024
    ds_read_b128 v[72:75], v234 offset:2048
    ds_read_b128 v[76:79], v234 offset:3072
    s_add_u32 s13, s13, 4096
    s_add_u32 s14, s14, 4096
    s_mov_b32 m0, s13
    s_nop 0
    buffer_load_dwordx4 v2, s[24:27], s14 offen offset:0 lds
    buffer_load_dwordx4 v2, s[24:27], s14 offen offset:1024 lds
    buffer_load_dwordx4 v2, s[24:27], s14 offen offset:2048 lds
    s_waitcnt lgkmcnt(0)
    s_nop 0
    v_pk_add_f32 v[48:49], v[48:49], v[64:65]
    v_pk_add_f32 v[50:51], v[50:51], v[66:67]
    v_pk_add_f32 v[52:53], v[52:53], v[68:69]
    v_pk_add_f32 v[54:55], v[54:55], v[70:71]
    v_pk_add_f32 v[56:57], v[56:57], v[72:73]
    v_pk_add_f32 v[58:59], v[58:59], v[74:75]
    v_pk_add_f32 v[60:61], v[60:61], v[76:77]
    v_pk_add_f32 v[62:63], v[62:63], v[78:79]
    v_accvgpr_read_b32 v235, a18
    v_lshlrev_b32_e64 v65, 16, v37
    v_and_b32 v64, 0xffff0000, v37
    v_lshlrev_b32_e64 v67, 16, v36
    v_and_b32 v66, 0xffff0000, v36
    v_fmac_f32 v48, v235, v64
    v_fmac_f32 v49, v235, v65
    v_fmac_f32 v50, v235, v66
    v_fmac_f32 v51, v235, v67
    v_lshlrev_b32_e64 v65, 16, v39
    v_and_b32 v64, 0xffff0000, v39
    v_lshlrev_b32_e64 v67, 16, v38
    v_and_b32 v66, 0xffff0000, v38
    v_fmac_f32 v52, v235, v64
    v_fmac_f32 v53, v235, v65
    v_fmac_f32 v54, v235, v66
    v_fmac_f32 v55, v235, v67
    v_lshlrev_b32_e64 v65, 16, v41
    v_and_b32 v64, 0xffff0000, v41
    v_lshlrev_b32_e64 v67, 16, v40
    v_and_b32 v66, 0xffff0000, v40
    v_fmac_f32 v56, v235, v64
    v_fmac_f32 v57, v235, v65
    v_fmac_f32 v58, v235, v66
    v_fmac_f32 v59, v235, v67
    v_lshlrev_b32_e64 v65, 16, v43
    v_and_b32 v64, 0xffff0000, v43
    v_lshlrev_b32_e64 v67, 16, v42
    v_and_b32 v66, 0xffff0000, v42
    v_fmac_f32 v60, v235, v64
    v_fmac_f32 v61, v235, v65
    v_fmac_f32 v62, v235, v66
    v_fmac_f32 v63, v235, v67
    v_cvt_pk_bf16_f32 v80, v48, v49
    v_cvt_pk_bf16_f32 v81, v50, v51
    v_cvt_pk_bf16_f32 v82, v52, v53
    v_cvt_pk_bf16_f32 v83, v54, v55
    v_cvt_pk_bf16_f32 v84, v56, v57
    v_cvt_pk_bf16_f32 v85, v58, v59
    v_cvt_pk_bf16_f32 v86, v60, v61
    v_cvt_pk_bf16_f32 v87, v62, v63
    v_cmp_eq_u32 vcc, 1, v227
    s_nop 1
    v_cndmask_b32 v64, v82, v80, vcc
    v_cndmask_b32 v65, v83, v81, vcc
    v_cndmask_b32 v66, v80, v82, vcc
    v_cndmask_b32 v67, v81, v83, vcc
    v_cndmask_b32 v70, v86, v84, vcc
    v_cndmask_b32 v71, v87, v85, vcc
    v_cndmask_b32 v72, v84, v86, vcc
    v_cndmask_b32 v73, v85, v87, vcc
    v_mov_b32_dpp v68, v64 quad_perm:[1,0,3,2] row_mask:0xf bank_mask:0xf
    v_mov_b32_dpp v69, v65 quad_perm:[1,0,3,2] row_mask:0xf bank_mask:0xf
    v_mov_b32_dpp v74, v70 quad_perm:[1,0,3,2] row_mask:0xf bank_mask:0xf
    v_mov_b32_dpp v75, v71 quad_perm:[1,0,3,2] row_mask:0xf bank_mask:0xf
    v_cndmask_b32 v88, v66, v68, vcc
    v_cndmask_b32 v89, v68, v66, vcc
    v_cndmask_b32 v90, v67, v69, vcc
    v_cndmask_b32 v91, v69, v67, vcc
    v_cndmask_b32 v92, v72, v74, vcc
    v_cndmask_b32 v93, v74, v72, vcc
    v_cndmask_b32 v94, v73, v75, vcc
    v_cndmask_b32 v95, v75, v73, vcc
    buffer_store_dwordx4 v[88:91], v231, s[24:27], s76 offen offset:0 sc1
    buffer_store_dwordx4 v[92:95], v231, s[24:27], s76 offen offset:1024 sc1
    s_cmp_eq_u32 s3, 0
    s_cbranch_scc0 M_epi_end
    ds_read_b128 v[48:51], v2 offset:16384
    ds_read_b128 v[52:55], v2 offset:17408
    ds_read_b128 v[56:59], v2 offset:18432
    ds_read_b128 v[60:63], v2 offset:19456
    ds_read_b128 v[64:67], v2 offset:20480
    ds_read_b128 v[68:71], v2 offset:21504
    ds_read_b128 v[72:75], v2 offset:22528
    ds_read_b128 v[76:79], v2 offset:23552
    s_waitcnt lgkmcnt(0)
    s_nop 0
    v_pk_add_f32 v[48:49], v[48:49], v[56:57]
    v_pk_add_f32 v[64:65], v[64:65], v[72:73]
    v_pk_add_f32 v[50:51], v[50:51], v[58:59]
    v_pk_add_f32 v[66:67], v[66:67], v[74:75]
    v_pk_add_f32 v[52:53], v[52:53], v[60:61]
    v_pk_add_f32 v[68:69], v[68:69], v[76:77]
    v_pk_add_f32 v[54:55], v[54:55], v[62:63]
    v_pk_add_f32 v[70:71], v[70:71], v[78:79]
    v_pk_add_f32 v[48:49], v[48:49], v[64:65]
    v_pk_add_f32 v[50:51], v[50:51], v[66:67]
    v_pk_add_f32 v[52:53], v[52:53], v[68:69]
    v_pk_add_f32 v[54:55], v[54:55], v[70:71]
    v_accvgpr_read_b32 v235, a19
    v_lshlrev_b32_e64 v65, 16, v45
    v_and_b32 v64, 0xffff0000, v45
    v_lshlrev_b32_e64 v67, 16, v44
    v_and_b32 v66, 0xffff0000, v44
    v_fmac_f32 v48, v235, v64
    v_fmac_f32 v49, v235, v65
    v_fmac_f32 v50, v235, v66
    v_fmac_f32 v51, v235, v67
    v_lshlrev_b32_e64 v65, 16, v47
    v_and_b32 v64, 0xffff0000, v47
    v_lshlrev_b32_e64 v67, 16, v46
    v_and_b32 v66, 0xffff0000, v46
    v_fmac_f32 v52, v235, v64
    v_fmac_f32 v53, v235, v65
    v_fmac_f32 v54, v235, v66
    v_fmac_f32 v55, v235, v67
    v_cvt_pk_bf16_f32 v80, v48, v49
    v_cvt_pk_bf16_f32 v81, v50, v51
    v_cvt_pk_bf16_f32 v82, v52, v53
    v_cvt_pk_bf16_f32 v83, v54, v55
    v_cmp_eq_u32 vcc, 1, v227
    s_nop 1
    v_cndmask_b32 v64, v82, v80, vcc
    v_cndmask_b32 v65, v83, v81, vcc
    v_cndmask_b32 v66, v80, v82, vcc
    v_cndmask_b32 v67, v81, v83, vcc
    v_mov_b32_dpp v68, v64 quad_perm:[1,0,3,2] row_mask:0xf bank_mask:0xf
    v_mov_b32_dpp v69, v65 quad_perm:[1,0,3,2] row_mask:0xf bank_mask:0xf
    v_cndmask_b32 v84, v66, v68, vcc
    v_cndmask_b32 v85, v68, v66, vcc
    v_cndmask_b32 v86, v67, v69, vcc
    v_cndmask_b32 v87, v69, v67, vcc
    buffer_store_dwordx4 v[84:87], v226, s[24:27], s78 offen sc1
M_epi_end:
    s_waitcnt vmcnt(9)
    s_mul_i32 s13, s3, 6144
    s_min_u32 s13, s13, 18432
    s_add_u32 s14, s13, s61
    s_add_u32 s14, s14, 28672
    s_add_u32 s13, s13, 129024
    s_mov_b32 m0, s13
    s_nop 0
    buffer_load_dwordx4 v2, s[24:27], s14 offen offset:0 lds
    buffer_load_dwordx4 v2, s[24:27], s14 offen offset:1024 lds
    buffer_load_dwordx4 v2, s[24:27], s14 offen offset:2048 lds
    buffer_load_dwordx4 v2, s[24:27], s14 offen offset:3072 lds
    s_add_u32 s13, s13, 4096
    s_add_u32 s14, s14, 4096
    s_mov_b32 m0, s13
    s_nop 0
    buffer_load_dwordx4 v2, s[24:27], s14 offen offset:0 lds
    buffer_load_dwordx4 v2, s[24:27], s14 offen offset:1024 lds
    s_branch M_gather0
M_gather:
    s_waitcnt vmcnt(0)
M_gather0:
    v_max3_u32 v24, v139, v143, v147
    v_max3_u32 v25, v151, v155, v159
    v_max3_u32 v26, v163, v167, v171
    v_max3_u32 v27, v175, v179, v183
    v_max3_u32 v28, v24, v25, v26
    v_max_u32 v28, v28, v27
    v_cmp_eq_u32 vcc, -1, v28
    v_and_b32 v31, 1, v4
    v_lshlrev_b32 v31, 5, v31
    v_sub_u32 v31, 64, v31
    v_add_u32 v32, v13, v31
    v_add_u32 v33, v14, v31
    v_add_u32_e64 v34, v15, v31
    s_cbranch_vccnz M_gr
M_gb:
    v_mfma_f32_16x16x32_bf16 v[40:43], a[112:115], v[136:139], 0
    v_mfma_f32_16x16x32_bf16 v[44:47], a[112:115], v[140:143], 0
    v_mfma_f32_16x16x32_bf16 v[48:51], a[112:115], v[144:147], 0
    v_mfma_f32_16x16x32_bf16 v[40:43], a[112:115], v[148:151], v[40:43]
    v_mfma_f32_16x16x32_bf16 v[44:47], a[112:115], v[152:155], v[44:47]
    v_mfma_f32_16x16x32_bf16 v[48:51], a[112:115], v[156:159], v[48:51]
    v_mfma_f32_16x16x32_bf16 v[40:43], a[112:115], v[160:163], v[40:43]
    v_mfma_f32_16x16x32_bf16 v[44:47], a[112:115], v[164:167], v[44:47]
    v_mfma_f32_16x16x32_bf16 v[48:51], a[112:115], v[168:171], v[48:51]
    v_mfma_f32_16x16x32_bf16 v[40:43], a[112:115], v[172:175], v[40:43]
    v_mfma_f32_16x16x32_bf16 v[44:47], a[112:115], v[176:179], v[44:47]
    v_mfma_f32_16x16x32_bf16 v[48:51], a[112:115], v[180:183], v[48:51]
    s_lshl_b32 s76, s7, 10
    s_add_u32 s76, s76, s9
    s_add_u32 s76, s76, s59
    s_add_u32 s76, s76, 0xac0000
    s_add_u32 s77, s70, s59
    s_add_u32 s77, s77, 0xac0000
    v_cvt_pk_bf16_f32 v20, v40, v41
    v_cvt_pk_bf16_f32 v21, v42, v43
    ds_write_b64 v249, v[20:21] offset:0
    v_cvt_pk_bf16_f32 v22, v44, v45
    v_cvt_pk_bf16_f32 v23, v46, v47
    ds_write_b64 v249, v[22:23] offset:256
    v_cvt_pk_bf16_f32 v24, v48, v49
    v_cvt_pk_bf16_f32 v25, v50, v51
    ds_write_b64 v249, v[24:25] offset:512
    s_waitcnt lgkmcnt(0)
    s_barrier
    ds_read_b128 v[144:147], v15 offset:0
    ds_read_b128 v[136:139], v13 offset:0
    ds_read_b128 v[140:143], v14 offset:0
    ds_read_b128 v[156:159], v15 offset:16
    ds_read_b128 v[148:151], v13 offset:16
    ds_read_b128 v[152:155], v14 offset:16
    ds_read_b128 v[168:171], v34 offset:0
    ds_read_b128 v[160:163], v32 offset:0
    ds_read_b128 v[164:167], v33 offset:0
    s_waitcnt lgkmcnt(6)
    v_mfma_f32_16x16x32_bf16 v[48:51], v[144:147], v[96:99], 0
    v_mfma_f32_16x16x32_bf16 v[60:63], v[144:147], v[108:111], 0
    v_mfma_f32_16x16x32_bf16 v[40:43], v[136:139], v[96:99], 0
    v_mfma_f32_16x16x32_bf16 v[52:55], v[136:139], v[108:111], 0
    v_mfma_f32_16x16x32_bf16 v[44:47], v[140:143], v[96:99], 0
    v_mfma_f32_16x16x32_bf16 v[56:59], v[140:143], v[108:111], 0
    s_waitcnt lgkmcnt(3)
    v_mfma_f32_16x16x32_bf16 v[48:51], v[156:159], v[100:103], v[48:51]
    v_mfma_f32_16x16x32_bf16 v[60:63], v[156:159], v[112:115], v[60:63]
    v_mfma_f32_16x16x32_bf16 v[40:43], v[148:151], v[100:103], v[40:43]
    v_mfma_f32_16x16x32_bf16 v[52:55], v[148:151], v[112:115], v[52:55]
    v_mfma_f32_16x16x32_bf16 v[44:47], v[152:155], v[100:103], v[44:47]
    v_mfma_f32_16x16x32_bf16 v[56:59], v[152:155], v[112:115], v[56:59]
    s_waitcnt lgkmcnt(0)
    v_mfma_f32_16x16x32_bf16 v[48:51], v[168:171], v[104:107], v[48:51]
    v_mfma_f32_16x16x32_bf16 v[60:63], v[168:171], v[116:119], v[60:63]
    v_mfma_f32_16x16x32_bf16 v[40:43], v[160:163], v[104:107], v[40:43]
    v_mfma_f32_16x16x32_bf16 v[52:55], v[160:163], v[116:119], v[52:55]
    v_mfma_f32_16x16x32_bf16 v[44:47], v[164:167], v[104:107], v[44:47]
    v_mfma_f32_16x16x32_bf16 v[56:59], v[164:167], v[116:119], v[56:59]
    s_add_u32 s5, s77, 18432
    s_nop 1
    v_add_f32 v50, 0x358637bd, v50
    v_add_f32 v62, 0x358637bd, v62
    v_rcp_f32 v50, v50
    v_rcp_f32 v62, v62
    v_pk_mul_f32 v[40:41], v[40:41], v[50:51] op_sel_hi:[1,0]
    v_pk_mul_f32 v[42:43], v[42:43], v[50:51] op_sel_hi:[1,0]
    v_pk_mul_f32 v[44:45], v[44:45], v[50:51] op_sel_hi:[1,0]
    v_pk_mul_f32 v[46:47], v[46:47], v[50:51] op_sel_hi:[1,0]
    v_pk_mul_f32 v[48:49], v[48:49], v[50:51] op_sel_hi:[1,0]
    v_cvt_pk_bf16_f32 v24, v48, v49
    v_mov_b32_e64 v25, v24
    v_cvt_pk_bf16_f32 v20, v40, v41
    v_cvt_pk_bf16_f32 v21, v42, v43
    v_cvt_pk_bf16_f32 v22, v44, v45
    v_cvt_pk_bf16_f32 v23, v46, v47
    buffer_store_dwordx4 v[20:23], v2, s[24:27], s76 offen
    v_permlane32_swap_b32 v24, v25
    s_nop 0
    buffer_store_dwordx2 v[24:25], v242, s[24:27], s77 offen
    v_pk_mul_f32 v[52:53], v[52:53], v[62:63] op_sel_hi:[1,0]
    v_pk_mul_f32 v[54:55], v[54:55], v[62:63] op_sel_hi:[1,0]
    v_pk_mul_f32 v[56:57], v[56:57], v[62:63] op_sel_hi:[1,0]
    v_pk_mul_f32 v[58:59], v[58:59], v[62:63] op_sel_hi:[1,0]
    v_pk_mul_f32 v[60:61], v[60:61], v[62:63] op_sel_hi:[1,0]
    v_cvt_pk_bf16_f32 v32, v60, v61
    v_mov_b32_e64 v33, v32
    v_cvt_pk_bf16_f32 v28, v52, v53
    v_cvt_pk_bf16_f32 v29, v54, v55
    v_cvt_pk_bf16_f32 v30, v56, v57
    v_cvt_pk_bf16_f32 v31, v58, v59
    buffer_store_dwordx4 v[28:31], v0, s[24:27], s76 offen
    v_permlane32_swap_b32 v32, v33
    buffer_store_dwordx2 v[32:33], v242, s[24:27], s5 offen
    s_cmp_lg_u32 s8, 0
    s_cbranch_scc1 M_pog
M_pob:
    s_add_u32 s77, s19, s59
    s_add_u32 s77, s77, 0xac0000
    s_add_u32 s15, s77, 16384
    s_mul_i32 s13, s3, 5120
    s_min_u32 s13, s13, 14336
    s_add_u32 s14, s13, s61
    s_add_u32 s14, s14, 72704
    s_mov_b32 m0, s13
    s_nop 0
    s_nop 0
    buffer_load_dwordx4 v2, s[24:27], s14 offen offset:0 lds
    buffer_load_dwordx4 v2, s[24:27], s14 offen offset:1024 lds
    buffer_load_dwordx4 v2, s[24:27], s14 offen offset:2048 lds
    buffer_load_dwordx4 v2, s[24:27], s14 offen offset:3072 lds
    s_add_u32 s13, s13, 4096
    s_add_u32 s14, s14, 4096
    s_mov_b32 m0, s13
    s_nop 0
    buffer_load_dwordx4 v2, s[24:27], s14 offen offset:0 lds
    ds_read_b128 a[176:179], v12 offset:22528
    ds_read_b128 a[180:183], v12 offset:23552
    ds_read_b128 a[184:187], v12 offset:24576
    ds_read_b128 a[188:191], v12 offset:25600
    ds_read_b128 a[192:195], v12 offset:26624
    ds_read_b128 a[196:199], v12 offset:27648
    ds_read_b128 a[200:203], v2 offset:29696
    ds_read_b128 a[204:207], v2 offset:30720
    ds_read_b128 a[208:211], v2 offset:31744
    ds_read_b128 a[212:215], v2 offset:32768
    ds_read_b128 a[216:219], v2 offset:33792
    ds_read_b128 a[220:223], v2 offset:34816
    ds_read_b128 a[224:227], v2 offset:35840
    ds_read_b128 a[228:231], v2 offset:36864
    ds_read_b128 a[232:235], v2 offset:37888
    ds_read_b128 a[236:239], v2 offset:38912
    ds_read_b128 a[240:243], v2 offset:39936
    ds_read_b128 a[244:247], v2 offset:40960
    ds_read_b128 a[248:251], v2 offset:41984
    v_lshlrev_b32_e64 v16, 7, v3
    v_add_u32 v16, 124, v16
    v_cmp_gt_u32 vcc, 16, v1
    s_nop 1
    v_cndmask_b32_e64 v16, v241, v16, vcc
M_opoll:
    buffer_load_dword v17, v16, s[24:27], s15 offen sc1
    s_add_u32 s75, s75, 1
    s_cmp_lt_u32 s75, 20000
    s_waitcnt vmcnt(0)
    v_cmp_eq_u32 vcc, -1, v17
    s_cbranch_scc0 M_opoll_ok
    s_cbranch_vccnz M_opoll
M_opoll_ok:
    s_add_u32 s12, s77, 0
    buffer_load_dwordx4 v[96:99], v2, s[24:27], s12 offen offset:0 sc1
    buffer_load_dwordx4 v[100:103], v2, s[24:27], s12 offen offset:1024 sc1
    buffer_load_dwordx4 v[104:107], v2, s[24:27], s12 offen offset:2048 sc1
    buffer_load_dwordx4 v[108:111], v2, s[24:27], s12 offen offset:3072 sc1
    s_add_u32 s12, s77, 4096
    buffer_load_dwordx4 v[112:115], v2, s[24:27], s12 offen offset:0 sc1
    buffer_load_dwordx4 v[116:119], v2, s[24:27], s12 offen offset:1024 sc1
    buffer_load_dwordx4 v[120:123], v2, s[24:27], s12 offen offset:2048 sc1
    buffer_load_dwordx4 v[124:127], v2, s[24:27], s12 offen offset:3072 sc1
    s_add_u32 s12, s77, 8192
    buffer_load_dwordx4 v[128:131], v2, s[24:27], s12 offen offset:0 sc1
    buffer_load_dwordx4 v[132:135], v2, s[24:27], s12 offen offset:1024 sc1
    buffer_load_dwordx4 v[136:139], v2, s[24:27], s12 offen offset:2048 sc1
    buffer_load_dwordx4 v[140:143], v2, s[24:27], s12 offen offset:3072 sc1
    s_waitcnt lgkmcnt(0)
    s_barrier
    ds_read_b128 a[72:75], v5 offset:34816
    ds_read_b128 a[76:79], v5 offset:35840
    ds_read_b128 a[80:83], v5 offset:36864
    ds_read_b128 a[84:87], v5 offset:37888
    ds_read_b128 a[88:91], v5 offset:38912
    ds_read_b128 a[92:95], v5 offset:39936
    ds_read_b128 a[96:99], v5 offset:40960
    ds_read_b128 a[100:103], v5 offset:41984
    ds_read_b128 a[104:107], v5 offset:43008
    ds_read_b128 a[108:111], v5 offset:44032
    ds_read_b128 a[116:119], v5 offset:45056
    ds_read_b128 a[120:123], v5 offset:46080
    ds_read_b128 a[124:127], v5 offset:47104
    ds_read_b128 a[128:131], v5 offset:48128
    ds_read_b128 a[132:135], v5 offset:49152
    ds_read_b128 a[136:139], v5 offset:50176
    ds_read_b128 a[140:143], v5 offset:51200
    ds_read_b128 a[144:147], v5 offset:52224
    ds_read_b128 a[148:151], v5 offset:53248
    ds_read_b128 a[152:155], v5 offset:54272
    ds_read_b128 a[156:159], v5 offset:55296
    ds_read_b128 a[160:163], v5 offset:56320
    ds_read_b128 a[164:167], v5 offset:57344
    ds_read_b128 a[168:171], v5 offset:58368
    s_waitcnt vmcnt(11)
    v_cmp_eq_u32 vcc, -1, v99
    s_cbranch_vccnz M_o0r
M_o0b:
    s_waitcnt lgkmcnt(15)
    v_mfma_f32_16x16x32_bf16 v[40:43], a[72:75], v[96:99], 0
    s_add_u32 s12, s77, 12288
    buffer_load_dwordx4 v[144:147], v2, s[24:27], s12 offen offset:0 sc1
    ds_read_b128 a[172:175], v5 offset:59392
    v_mfma_f32_16x16x32_bf16 v[44:47], a[76:79], v[96:99], 0
    buffer_load_dwordx4 v[148:151], v2, s[24:27], s12 offen offset:1024 sc1
    ds_read_b128 a[72:75], v5 offset:60416
    s_waitcnt vmcnt(12)
    v_cmp_eq_u32 vcc, -1, v103
    v_mfma_f32_16x16x32_bf16 v[48:51], a[80:83], v[96:99], 0
    ds_read_b128 a[76:79], v5 offset:61440
    v_mfma_f32_16x16x32_bf16 v[52:55], a[84:87], v[96:99], 0
    buffer_load_dwordx4 v[152:155], v2, s[24:27], s12 offen offset:2048 sc1
    ds_read_b128 a[80:83], v5 offset:62464
    v_mfma_f32_16x16x32_bf16 v[56:59], a[88:91], v[96:99], 0
    s_cbranch_vccnz M_o1r
M_o1b:
    ds_read_b128 a[84:87], v5 offset:63488
    v_mfma_f32_16x16x32_bf16 v[40:43], a[92:95], v[100:103], v[40:43]
    buffer_load_dwordx4 v[156:159], v2, s[24:27], s12 offen offset:3072 sc1
    ds_read_b128 a[88:91], v5 offset:64512
    v_mfma_f32_16x16x32_bf16 v[44:47], a[96:99], v[100:103], v[44:47]
    buffer_load_dwordx2 v[160:161], v251, s[24:27], s15 offen offset:0 sc1
    ds_read_b128 a[92:95], v12 offset:0
    s_waitcnt vmcnt(14)
    v_cmp_eq_u32_e64 vcc, -1, v107
    v_mfma_f32_16x16x32_bf16 v[48:51], a[100:103], v[100:103], v[48:51]
    ds_read_b128 a[96:99], v12 offset:1024
    s_waitcnt lgkmcnt(15)
    v_mfma_f32_16x16x32_bf16 v[52:55], a[104:107], v[100:103], v[52:55]
    buffer_load_dwordx2 v[162:163], v251, s[24:27], s15 offen offset:128 sc1
    ds_read_b128 a[100:103], v12 offset:2048
    v_mfma_f32_16x16x32_bf16 v[56:59], a[108:111], v[100:103], v[56:59]
    s_cbranch_vccnz M_o2r
M_o2b:
    ds_read_b128 a[104:107], v12 offset:3072
    v_mfma_f32_16x16x32_bf16 v[40:43], a[116:119], v[104:107], v[40:43]
    buffer_load_dwordx2 v[164:165], v251, s[24:27], s15 offen offset:1024 sc1
    ds_read_b128 a[108:111], v12 offset:4096
    v_mfma_f32_16x16x32_bf16 v[44:47], a[120:123], v[104:107], v[44:47]
    buffer_load_dwordx2 v[166:167], v251, s[24:27], s15 offen offset:1152 sc1
    ds_read_b128 a[116:119], v12 offset:5120
    s_waitcnt vmcnt(16)
    v_cmp_eq_u32 vcc, -1, v111
    v_mfma_f32_16x16x32_bf16 v[48:51], a[124:127], v[104:107], v[48:51]
    ds_read_b128 a[120:123], v12 offset:6144
    v_mfma_f32_16x16x32_bf16 v[52:55], a[128:131], v[104:107], v[52:55]
    buffer_load_dwordx4 v[168:171], v246, s[24:27], s49 offen sc1
    ds_read_b128 a[124:127], v12 offset:7168
    v_mfma_f32_16x16x32_bf16 v[56:59], a[132:135], v[104:107], v[56:59]
    s_cbranch_vccnz M_o3r
M_o3b:
    ds_read_b128 a[128:131], v12 offset:8192
    v_mfma_f32_16x16x32_bf16 v[40:43], a[136:139], v[108:111], v[40:43]
    s_add_u32 s4, s49, 0x8000
    buffer_load_dwordx4 v[172:175], v246, s[24:27], s4 offen sc1
    ds_read_b128 a[132:135], v12 offset:9216
    s_waitcnt lgkmcnt(15)
    v_mfma_f32_16x16x32_bf16 v[44:47], a[140:143], v[108:111], v[44:47]
    s_add_u32 s4, s49, 0x10000
    buffer_load_dwordx4 v[176:179], v247, s[24:27], s4 offen sc1
    ds_read_b128 a[136:139], v12 offset:10240
    s_waitcnt vmcnt(18)
    v_cmp_eq_u32 vcc, -1, v115
    v_mfma_f32_16x16x32_bf16 v[48:51], a[144:147], v[108:111], v[48:51]
    ds_read_b128 a[140:143], v12 offset:11264
    v_mfma_f32_16x16x32_bf16 v[52:55], a[148:151], v[108:111], v[52:55]
    ds_read_b128 a[144:147], v12 offset:12288
    v_mfma_f32_16x16x32_bf16 v[56:59], a[152:155], v[108:111], v[56:59]
    s_cbranch_vccnz M_o4r
M_o4b:
    ds_read_b128 a[148:151], v12 offset:13312
    v_mfma_f32_16x16x32_bf16 v[40:43], a[156:159], v[112:115], v[40:43]
    ds_read_b128 a[152:155], v12 offset:14336
    v_mfma_f32_16x16x32_bf16 v[44:47], a[160:163], v[112:115], v[44:47]
    ds_read_b128 a[156:159], v12 offset:15360
    s_waitcnt vmcnt(17)
    v_cmp_eq_u32_e64 vcc, -1, v119
    v_mfma_f32_16x16x32_bf16 v[48:51], a[164:167], v[112:115], v[48:51]
    ds_read_b128 a[160:163], v12 offset:16384
    v_mfma_f32_16x16x32_bf16 v[52:55], a[168:171], v[112:115], v[52:55]
    ds_read_b128 a[164:167], v12 offset:17408
    s_waitcnt lgkmcnt(15)
    v_mfma_f32_16x16x32_bf16 v[56:59], a[172:175], v[112:115], v[56:59]
    s_cbranch_vccnz M_o5r
M_o5b:
    ds_read_b128 a[168:171], v12 offset:18432
    v_mfma_f32_16x16x32_bf16 v[40:43], a[72:75], v[116:119], v[40:43]
    ds_read_b128 a[172:175], v12 offset:19456
    v_mfma_f32_16x16x32_bf16 v[44:47], a[76:79], v[116:119], v[44:47]
    ds_read_b128 a[72:75], v12 offset:20480
    s_waitcnt vmcnt(16)
    v_cmp_eq_u32 vcc, -1, v123
    v_mfma_f32_16x16x32_bf16 v[48:51], a[80:83], v[116:119], v[48:51]
    ds_read_b128 a[76:79], v12 offset:21504
    v_mfma_f32_16x16x32_bf16 v[52:55], a[84:87], v[116:119], v[52:55]
    ds_read_b128 a[80:83], v2 offset:0
    v_mfma_f32_16x16x32_bf16 v[56:59], a[88:91], v[116:119], v[56:59]
    s_cbranch_vccnz M_o6r
M_o6b:
    ds_read_b128 a[84:87], v2 offset:1024
    v_mfma_f32_16x16x32_bf16 v[40:43], a[92:95], v[120:123], v[40:43]
    ds_read_b128 a[88:91], v2 offset:2048
    v_mfma_f32_16x16x32_bf16 v[44:47], a[96:99], v[120:123], v[44:47]
    ds_read_b128 a[92:95], v2 offset:3072
    s_waitcnt vmcnt(15)
    v_cmp_eq_u32 vcc, -1, v127
    s_waitcnt lgkmcnt(15)
    v_mfma_f32_16x16x32_bf16 v[48:51], a[100:103], v[120:123], v[48:51]
    ds_read_b128 a[96:99], v2 offset:4096
    v_mfma_f32_16x16x32_bf16 v[52:55], a[104:107], v[120:123], v[52:55]
    ds_read_b128 a[100:103], v2 offset:5120
    v_mfma_f32_16x16x32_bf16 v[56:59], a[108:111], v[120:123], v[56:59]
    s_cbranch_vccnz M_o7r
M_o7b:
    ds_read_b128 a[104:107], v2 offset:6144
    v_mfma_f32_16x16x32_bf16 v[40:43], a[116:119], v[124:127], v[40:43]
    ds_read_b128 a[108:111], v2 offset:7168
    v_mfma_f32_16x16x32_bf16 v[44:47], a[120:123], v[124:127], v[44:47]
    ds_read_b128 a[116:119], v2 offset:8192
    s_waitcnt vmcnt(14)
    v_cmp_eq_u32_e64 vcc, -1, v131
    v_mfma_f32_16x16x32_bf16 v[48:51], a[124:127], v[124:127], v[48:51]
    ds_read_b128 a[120:123], v2 offset:9216
    v_mfma_f32_16x16x32_bf16 v[52:55], a[128:131], v[124:127], v[52:55]
    ds_read_b128 a[124:127], v2 offset:10240
    v_mfma_f32_16x16x32_bf16 v[56:59], a[132:135], v[124:127], v[56:59]
    s_cbranch_vccnz M_o8r
M_o8b:
    ds_read_b128 a[128:131], v2 offset:11264
    s_waitcnt lgkmcnt(15)
    v_mfma_f32_16x16x32_bf16 v[40:43], a[136:139], v[128:131], v[40:43]
    ds_read_b128 a[132:135], v2 offset:12288
    v_mfma_f32_16x16x32_bf16 v[44:47], a[140:143], v[128:131], v[44:47]
    ds_read_b128 a[136:139], v2 offset:13312
    s_waitcnt vmcnt(13)
    v_cmp_eq_u32 vcc, -1, v135
    v_mfma_f32_16x16x32_bf16 v[48:51], a[144:147], v[128:131], v[48:51]
    ds_read_b128 a[140:143], v2 offset:14336
    v_mfma_f32_16x16x32_bf16 v[52:55], a[148:151], v[128:131], v[52:55]
    ds_read_b128 a[144:147], v2 offset:15360
    v_mfma_f32_16x16x32_bf16 v[56:59], a[152:155], v[128:131], v[56:59]
    s_cbranch_vccnz M_o9r
M_o9b:
    ds_read_b128 a[148:151], v2 offset:16384
    v_mfma_f32_16x16x32_bf16 v[40:43], a[156:159], v[132:135], v[40:43]
    ds_read_b128 a[152:155], v2 offset:17408
    v_mfma_f32_16x16x32_bf16 v[44:47], a[160:163], v[132:135], v[44:47]
    ds_read_b128 a[156:159], v2 offset:18432
    s_waitcnt vmcnt(12)
    v_cmp_eq_u32_e64 vcc, -1, v139
    v_mfma_f32_16x16x32_bf16 v[48:51], a[164:167], v[132:135], v[48:51]
    s_waitcnt lgkmcnt(15)
    v_mfma_f32_16x16x32_bf16 v[52:55], a[168:171], v[132:135], v[52:55]
    v_mfma_f32_16x16x32_bf16 v[56:59], a[172:175], v[132:135], v[56:59]
    s_cbranch_vccnz M_o10r
M_o10b:
    v_mfma_f32_16x16x32_bf16 v[40:43], a[72:75], v[136:139], v[40:43]
    v_mfma_f32_16x16x32_bf16 v[44:47], a[76:79], v[136:139], v[44:47]
    s_waitcnt vmcnt(11)
    v_cmp_eq_u32 vcc, -1, v143
    v_mfma_f32_16x16x32_bf16 v[48:51], a[176:179], v[136:139], v[48:51]
    v_mfma_f32_16x16x32_bf16 v[52:55], a[180:183], v[136:139], v[52:55]
    v_mfma_f32_16x16x32_bf16 v[56:59], a[184:187], v[136:139], v[56:59]
    s_cbranch_vccnz M_o11r
M_o11b:
    v_mfma_f32_16x16x32_bf16 v[40:43], a[188:191], v[140:143], v[40:43]
    v_mfma_f32_16x16x32_bf16 v[44:47], a[192:195], v[140:143], v[44:47]
    s_waitcnt vmcnt(10)
    v_cmp_eq_u32_e64 vcc, -1, v147
    v_mfma_f32_16x16x32_bf16 v[48:51], a[196:199], v[140:143], v[48:51]
    v_mfma_f32_16x16x32_bf16 v[52:55], a[200:203], v[140:143], v[52:55]
    s_barrier
    v_mfma_f32_16x16x32_bf16 v[56:59], a[204:207], v[140:143], v[56:59]
    s_cbranch_vccnz M_o12r
M_o12b:
    v_mfma_f32_16x16x32_bf16 v[40:43], a[208:211], v[144:147], v[40:43]
    s_add_u32 s13, s11, 100352
    s_add_u32 s14, s11, 100352
    s_add_u32 s14, s14, s10
    s_mov_b32 m0, s13
    s_nop 0
    buffer_load_dwordx4 v2, s[24:27], s14 offen offset:0 lds
    v_mfma_f32_16x16x32_bf16 v[44:47], a[212:215], v[144:147], v[44:47]
    s_waitcnt vmcnt(10)
    v_cmp_eq_u32_e64 vcc, -1, v151
    v_mfma_f32_16x16x32_bf16 v[48:51], a[216:219], v[144:147], v[48:51]
    v_mfma_f32_16x16x32_bf16 v[52:55], a[220:223], v[144:147], v[52:55]
    buffer_load_dwordx4 v2, s[24:27], s14 offen offset:1024 lds
    v_mfma_f32_16x16x32_bf16 v[56:59], a[224:227], v[144:147], v[56:59]
    s_cbranch_vccnz M_o13r
M_o13b:
    v_mfma_f32_16x16x32_bf16 v[40:43], a[228:231], v[148:151], v[40:43]
    buffer_load_dwordx4 v2, s[24:27], s14 offen offset:2048 lds
    v_mfma_f32_16x16x32_bf16 v[44:47], a[232:235], v[148:151], v[44:47]
    s_waitcnt vmcnt(11)
    v_cmp_eq_u32_e64 vcc, -1, v155
    v_mfma_f32_16x16x32_bf16 v[48:51], a[236:239], v[148:151], v[48:51]
    v_mfma_f32_16x16x32_bf16 v[52:55], a[240:243], v[148:151], v[52:55]
    buffer_load_dwordx4 v2, s[24:27], s14 offen offset:3072 lds
    v_mfma_f32_16x16x32_bf16 v[56:59], a[244:247], v[148:151], v[56:59]
    s_cbranch_vccnz M_o14r
M_o14b:
    v_mfma_f32_16x16x32_bf16 v[40:43], a[248:251], v[152:155], v[40:43]
    s_add_u32 s13, s13, 4096
    s_add_u32 s14, s14, 4096
    s_mov_b32 m0, s13
    s_nop 0
    buffer_load_dwordx4 v2, s[24:27], s14 offen offset:0 lds
    v_mfma_f32_16x16x32_bf16 v[44:47], a[80:83], v[152:155], v[44:47]
    s_waitcnt vmcnt(12)
    v_cmp_eq_u32_e64 vcc, -1, v159
    v_mfma_f32_16x16x32_bf16 v[48:51], a[84:87], v[152:155], v[48:51]
    v_mfma_f32_16x16x32_bf16 v[52:55], a[88:91], v[152:155], v[52:55]
    buffer_load_dwordx4 v2, s[24:27], s14 offen offset:1024 lds
    s_waitcnt lgkmcnt(14)
    v_mfma_f32_16x16x32_bf16 v[56:59], a[92:95], v[152:155], v[56:59]
    s_cbranch_vccnz M_o15r
M_o15b:
    v_mfma_f32_16x16x32_bf16 v[40:43], a[96:99], v[156:159], v[40:43]
    buffer_load_dwordx4 v2, s[24:27], s14 offen offset:2048 lds
    s_waitcnt lgkmcnt(13)
    s_waitcnt lgkmcnt(12)
    v_mfma_f32_16x16x32_bf16 v[44:47], a[100:103], v[156:159], v[44:47]
    s_waitcnt vmcnt(12)
    v_max_u32 v16, v161, v163
    v_cmp_eq_u32_e64 vcc, -1, v16
    v_mfma_f32_16x16x32_bf16 v[48:51], a[104:107], v[156:159], v[48:51]
    s_waitcnt lgkmcnt(11)
    s_waitcnt lgkmcnt(10)
    v_mfma_f32_16x16x32_bf16 v[52:55], a[108:111], v[156:159], v[52:55]
    v_mfma_f32_16x16x32_bf16 v[56:59], a[116:119], v[156:159], v[56:59]
    s_cbranch_vccnz M_o16r
M_o16b:
    s_waitcnt lgkmcnt(9)
    s_waitcnt lgkmcnt(8)
    v_mfma_f32_16x16x32_bf16 v[40:43], a[120:123], v[160:163], v[40:43]
    v_mfma_f32_16x16x32_bf16 v[44:47], a[124:127], v[160:163], v[44:47]
    s_waitcnt vmcnt(10)
    v_max_u32 v16, v165, v167
    v_cmp_eq_u32 vcc, -1, v16
    s_waitcnt lgkmcnt(7)
    s_waitcnt lgkmcnt(6)
    v_mfma_f32_16x16x32_bf16 v[48:51], a[128:131], v[160:163], v[48:51]
    v_mfma_f32_16x16x32_bf16 v[52:55], a[132:135], v[160:163], v[52:55]
    s_waitcnt lgkmcnt(5)
    s_waitcnt lgkmcnt(4)
    v_mfma_f32_16x16x32_bf16 v[56:59], a[136:139], v[160:163], v[56:59]
    s_cbranch_vccnz M_o17r
M_o17b:
    v_mfma_f32_16x16x32_bf16 v[40:43], a[140:143], v[164:167], v[40:43]
    s_waitcnt lgkmcnt(3)
    s_waitcnt lgkmcnt(2)
    v_mfma_f32_16x16x32_bf16 v[44:47], a[144:147], v[164:167], v[44:47]
    v_mfma_f32_16x16x32_bf16 v[48:51], a[148:151], v[164:167], v[48:51]
    s_waitcnt lgkmcnt(1)
    s_waitcnt lgkmcnt(0)
    v_mfma_f32_16x16x32_bf16 v[52:55], a[152:155], v[164:167], v[52:55]
    v_mfma_f32_16x16x32_bf16 v[56:59], a[156:159], v[164:167], v[56:59]
    s_lshl_b32 s15, s17, 11
    s_add_u32 s15, s15, s50
    s_cmp_eq_u32 s60, 0
    s_cbranch_scc0 M_b_l1
    s_barrier
    v_accvgpr_read_b32 v16, a0
    v_accvgpr_read_b32 v17, a1
    v_accvgpr_read_b32 v18, a2
    v_accvgpr_read_b32 v19, a3
    v_accvgpr_read_b32 v20, a4
    v_accvgpr_read_b32 v21, a5
    v_accvgpr_read_b32 v22, a6
    v_accvgpr_read_b32 v23, a7
    v_accvgpr_read_b32 v24, a8
    v_lshlrev_b32_e64 v60, 16, v16
    v_and_b32 v61, 0xffff0000, v16
    v_lshlrev_b32_e64 v62, 16, v17
    v_and_b32 v63, 0xffff0000, v17
    v_lshlrev_b32_e64 v64, 16, v18
    v_and_b32 v65, 0xffff0000, v18
    v_lshlrev_b32_e64 v66, 16, v19
    v_and_b32 v67, 0xffff0000, v19
    v_lshlrev_b32_e64 v68, 16, v20
    v_and_b32 v69, 0xffff0000, v20
    v_lshlrev_b32_e64 v70, 16, v21
    v_and_b32 v71, 0xffff0000, v21
    v_lshlrev_b32_e64 v72, 16, v22
    v_and_b32 v73, 0xffff0000, v22
    v_lshlrev_b32_e64 v74, 16, v23
    v_and_b32 v75, 0xffff0000, v23
    v_lshlrev_b32_e64 v76, 16, v24
    v_and_b32 v77, 0xffff0000, v24
    s_mov_b32 s76, 0
    s_waitcnt vmcnt(7)
    v_mfma_f32_16x16x32_bf16 v[96:99], v[168:171], a[20:23], 0
    v_mfma_f32_16x16x32_bf16 v[100:103], v[168:171], a[24:27], 0
    v_mfma_f32_16x16x32_bf16 v[104:107], v[172:175], a[20:23], 0
    v_mfma_f32_16x16x32_bf16 v[108:111], v[172:175], a[24:27], 0
    v_mfma_f32_16x16x32_bf16 v[112:115], v[176:179], a[20:23], 0
    v_max3_u32 v16, v168, v172, v176
    v_cmp_eq_u32 vcc, -1, v16
    v_add_f32 v40, v40, v60
    v_add_f32 v41, v41, v61
    v_add_f32 v42, v42, v62
    v_add_f32 v43, v43, v63
    v_add_f32 v44, v44, v64
    v_add_f32 v45, v45, v65
    v_add_f32 v46, v46, v66
    v_add_f32 v47, v47, v67
    v_add_f32 v48, v48, v68
    v_add_f32 v49, v49, v69
    v_add_f32 v50, v50, v70
    v_add_f32 v51, v51, v71
    v_add_f32 v52, v52, v72
    v_add_f32 v53, v53, v73
    v_add_f32 v54, v54, v74
    v_add_f32 v55, v55, v75
    v_add_f32 v56, v56, v76
    v_add_f32 v57, v57, v77
    s_cbranch_vccnz M_yretry
M_yok:
    v_pk_mul_f32 v[116:117], v[40:41], v[96:97]
    v_pk_mul_f32 v[118:119], v[42:43], v[98:99]
    v_pk_mul_f32 v[120:121], v[44:45], v[100:101]
    v_pk_mul_f32 v[122:123], v[46:47], v[102:103]
    v_pk_mul_f32 v[124:125], v[48:49], v[104:105]
    v_pk_mul_f32 v[126:127], v[50:51], v[106:107]
    v_pk_mul_f32 v[128:129], v[52:53], v[108:109]
    v_pk_mul_f32 v[130:131], v[54:55], v[110:111]
    v_pk_mul_f32 v[132:133], v[56:57], v[112:113]
    v_pk_mul_f32 v[138:139], v[40:41], v[40:41]
    v_pk_mul_f32 v[142:143], v[40:41], v[116:117]
    v_pk_mul_f32 v[144:145], v[116:117], v[116:117]
    v_pk_mul_f32 v[146:147], v[116:117], v[96:97]
    v_pk_mul_f32 v[150:151], v[96:97], v[96:97]
    v_pk_add_f32 v[136:137], v[40:41], v[42:43]
    v_pk_fma_f32 v[138:139], v[42:43], v[42:43], v[138:139]
    v_pk_add_f32 v[140:141], v[116:117], v[118:119]
    v_pk_fma_f32 v[142:143], v[42:43], v[118:119], v[142:143]
    v_pk_fma_f32 v[144:145], v[118:119], v[118:119], v[144:145]
    v_pk_fma_f32 v[146:147], v[118:119], v[98:99], v[146:147]
    v_pk_add_f32 v[148:149], v[96:97], v[98:99]
    v_pk_fma_f32 v[150:151], v[98:99], v[98:99], v[150:151]
    v_pk_add_f32 v[136:137], v[136:137], v[44:45]
    v_pk_fma_f32 v[138:139], v[44:45], v[44:45], v[138:139]
    v_pk_add_f32 v[140:141], v[140:141], v[120:121]
    v_pk_fma_f32 v[142:143], v[44:45], v[120:121], v[142:143]
    v_pk_fma_f32 v[144:145], v[120:121], v[120:121], v[144:145]
    v_pk_fma_f32 v[146:147], v[120:121], v[100:101], v[146:147]
    v_pk_add_f32 v[148:149], v[148:149], v[100:101]
    v_pk_fma_f32 v[150:151], v[100:101], v[100:101], v[150:151]
    v_pk_add_f32 v[136:137], v[136:137], v[46:47]
    v_pk_fma_f32 v[138:139], v[46:47], v[46:47], v[138:139]
    v_pk_add_f32 v[140:141], v[140:141], v[122:123]
    v_pk_fma_f32 v[142:143], v[46:47], v[122:123], v[142:143]
    v_pk_fma_f32 v[144:145], v[122:123], v[122:123], v[144:145]
    v_pk_fma_f32 v[146:147], v[122:123], v[102:103], v[146:147]
    v_pk_add_f32 v[148:149], v[148:149], v[102:103]
    v_pk_fma_f32 v[150:151], v[102:103], v[102:103], v[150:151]
    v_pk_add_f32 v[136:137], v[136:137], v[48:49]
    v_pk_fma_f32 v[138:139], v[48:49], v[48:49], v[138:139]
    v_pk_add_f32 v[140:141], v[140:141], v[124:125]
    v_pk_fma_f32 v[142:143], v[48:49], v[124:125], v[142:143]
    v_pk_fma_f32 v[144:145], v[124:125], v[124:125], v[144:145]
    v_pk_fma_f32 v[146:147], v[124:125], v[104:105], v[146:147]
    v_pk_add_f32 v[148:149], v[148:149], v[104:105]
    v_pk_fma_f32 v[150:151], v[104:105], v[104:105], v[150:151]
    v_pk_add_f32 v[136:137], v[136:137], v[50:51]
    v_pk_fma_f32 v[138:139], v[50:51], v[50:51], v[138:139]
    v_pk_add_f32 v[140:141], v[140:141], v[126:127]
    v_pk_fma_f32 v[142:143], v[50:51], v[126:127], v[142:143]
    v_pk_fma_f32 v[144:145], v[126:127], v[126:127], v[144:145]
    v_pk_fma_f32 v[146:147], v[126:127], v[106:107], v[146:147]
    v_pk_add_f32 v[148:149], v[148:149], v[106:107]
    v_pk_fma_f32 v[150:151], v[106:107], v[106:107], v[150:151]
    v_pk_add_f32 v[136:137], v[136:137], v[52:53]
    v_pk_fma_f32 v[138:139], v[52:53], v[52:53], v[138:139]
    v_pk_add_f32 v[140:141], v[140:141], v[128:129]
    v_pk_fma_f32 v[142:143], v[52:53], v[128:129], v[142:143]
    v_pk_fma_f32 v[144:145], v[128:129], v[128:129], v[144:145]
    v_pk_fma_f32 v[146:147], v[128:129], v[108:109], v[146:147]
    v_pk_add_f32 v[148:149], v[148:149], v[108:109]
    v_pk_fma_f32 v[150:151], v[108:109], v[108:109], v[150:151]
    v_pk_add_f32 v[136:137], v[136:137], v[54:55]
    v_pk_fma_f32 v[138:139], v[54:55], v[54:55], v[138:139]
    v_pk_add_f32 v[140:141], v[140:141], v[130:131]
    v_pk_fma_f32 v[142:143], v[54:55], v[130:131], v[142:143]
    v_pk_fma_f32 v[144:145], v[130:131], v[130:131], v[144:145]
    v_pk_fma_f32 v[146:147], v[130:131], v[110:111], v[146:147]
    v_pk_add_f32 v[148:149], v[148:149], v[110:111]
    v_pk_fma_f32 v[150:151], v[110:111], v[110:111], v[150:151]
    v_pk_add_f32 v[136:137], v[136:137], v[56:57]
    v_pk_fma_f32 v[138:139], v[56:57], v[56:57], v[138:139]
    v_pk_add_f32 v[140:141], v[140:141], v[132:133]
    v_pk_fma_f32 v[142:143], v[56:57], v[132:133], v[142:143]
    v_pk_fma_f32 v[144:145], v[132:133], v[132:133], v[144:145]
    v_pk_fma_f32 v[146:147], v[132:133], v[112:113], v[146:147]
    v_pk_add_f32 v[148:149], v[148:149], v[112:113]
    v_pk_fma_f32 v[150:151], v[112:113], v[112:113], v[150:151]
    v_add_f32 v136, v136, v137
    v_add_f32 v138, v138, v139
    v_add_f32 v140, v140, v141
    v_add_f32 v142, v142, v143
    v_add_f32 v144, v144, v145
    v_add_f32 v146, v146, v147
    v_add_f32 v148, v148, v149
    v_add_f32 v150, v150, v151
    v_permlane32_swap_b32 v136, v144
    v_permlane32_swap_b32 v138, v146
    v_permlane32_swap_b32 v140, v148
    v_permlane32_swap_b32 v142, v150
    v_add_f32 v137, v136, v144
    v_add_f32 v139, v138, v146
    v_add_f32 v141, v140, v148
    v_add_f32 v143, v142, v150
    s_nop 0
    v_permlane16_swap_b32 v137, v141
    v_permlane16_swap_b32 v139, v143
    v_add_f32 v18, v137, v141
    v_add_f32_e64 v19, v139, v143
    buffer_store_dwordx2 v[18:19], v248, s[24:27], s15 offen
    s_cmp_lg_u32 s8, 0
    s_cbranch_scc1 M_ps0g
M_ps0b:
    s_mov_b32 s4, s50
    s_nop 0
    buffer_load_dwordx2 v[152:153], v248, s[24:27], s4 offen offset:0 sc1
    buffer_load_dwordx2 v[154:155], v248, s[24:27], s4 offen offset:2048 sc1
    s_add_u32 s4, s4, 4096
    buffer_load_dwordx2 v[156:157], v248, s[24:27], s4 offen offset:0 sc1
    buffer_load_dwordx2 v[158:159], v248, s[24:27], s4 offen offset:2048 sc1
    s_add_u32 s4, s4, 4096
    buffer_load_dwordx2 v[160:161], v248, s[24:27], s4 offen offset:0 sc1
    buffer_load_dwordx2 v[162:163], v248, s[24:27], s4 offen offset:2048 sc1
    s_add_u32 s4, s4, 4096
    buffer_load_dwordx2 v[164:165], v248, s[24:27], s4 offen offset:0 sc1
    buffer_load_dwordx2 v[166:167], v248, s[24:27], s4 offen offset:2048 sc1
    s_lshl_b32 s14, s3, 12
    s_min_u32 s14, s14, 10240
    s_add_u32 s13, s14, 0
    s_add_u32 s14, s14, s10
    s_mov_b32 m0, s13
    s_nop 0
    s_nop 0
    buffer_load_dwordx4 v2, s[24:27], s14 offen offset:0 lds
    buffer_load_dwordx4 v2, s[24:27], s14 offen offset:1024 lds
    buffer_load_dwordx4 v2, s[24:27], s14 offen offset:2048 lds
    buffer_load_dwordx4 v2, s[24:27], s14 offen offset:3072 lds
    v_accvgpr_write_b32 a20, v96
    v_accvgpr_write_b32 a21, v97
    v_accvgpr_write_b32 a22, v98
    v_accvgpr_write_b32 a23, v99
    v_accvgpr_write_b32 a24, v100
    v_accvgpr_write_b32 a25, v101
    v_accvgpr_write_b32 a26, v102
    v_accvgpr_write_b32 a27, v103
    v_accvgpr_write_b32 a28, v104
    v_accvgpr_write_b32 a29, v105
    v_accvgpr_write_b32 a30, v106
    v_accvgpr_write_b32 a31, v107
    v_accvgpr_write_b32 a32, v108
    v_accvgpr_write_b32 a33, v109
    v_accvgpr_write_b32 a34, v110
    v_accvgpr_write_b32 a35, v111
    v_accvgpr_write_b32 a36, v112
    v_accvgpr_write_b32 a37, v113
    s_mov_b32 s75, 0
    s_waitcnt vmcnt(4)
    v_pk_add_f32 v[152:153], v[152:153], v[160:161]
    v_pk_add_f32 v[154:155], v[154:155], v[162:163]
    v_pk_add_f32 v[156:157], v[156:157], v[164:165]
    v_pk_add_f32 v[158:159], v[158:159], v[166:167]
    v_pk_add_f32 v[152:153], v[152:153], v[154:155]
    v_pk_add_f32 v[156:157], v[156:157], v[158:159]
    v_pk_add_f32 v[152:153], v[152:153], v[156:157]
    v_cmp_u_f32 vcc, v152, v153
    v_mov_b32 v136, v152
    v_mov_b32 v138, v152
    v_mov_b32 v137, v153
    v_mov_b32 v139, v153
    s_cbranch_vccnz M_sr0
M_sb0:
    v_permlane16_swap_b32 v136, v138
    v_permlane16_swap_b32 v137, v139
    v_mov_b32 v140, v136
    v_mov_b32 v142, v138
    v_mov_b32 v141, v137
    v_mov_b32 v143, v139
    v_permlane32_swap_b32 v136, v140
    v_permlane32_swap_b32 v137, v141
    v_permlane32_swap_b32 v138, v142
    v_permlane32_swap_b32 v139, v143
    v_mul_f32 v16, 0x3ae38e39, v136
    v_mul_f32 v17, 0x3ae38e39, v137
    v_fma_f32 v17, -v16, v16, v17
    v_max_f32_e64 v17, 0, v17
    v_add_f32 v17, 0x3727c5ac, v17
    v_rsq_f32 v18, v17
    s_nop 0
    v_mul_f32 v19, -v18, v16
    v_fma_f32 v22, v18, v138, v136
    v_mul_f32 v24, v18, v140
    v_mul_f32 v25, v19, v141
    v_mul_f32_e64 v26, v19, v143
    v_fma_f32 v22, v19, v142, v22
    v_fma_f32 v24, 2.0, v139, v24
    v_fma_f32 v26, 2.0, v138, v26
    v_fma_f32 v24, 2.0, v25, v24
    v_fma_f32 v23, v18, v24, v137
    v_fma_f32 v23, v19, v26, v23
    v_pk_fma_f32 v[40:41], v[116:117], v[18:19], v[40:41] op_sel_hi:[1,0,1]
    v_pk_fma_f32 v[42:43], v[118:119], v[18:19], v[42:43] op_sel_hi:[1,0,1]
    v_pk_fma_f32 v[44:45], v[120:121], v[18:19], v[44:45] op_sel_hi:[1,0,1]
    v_pk_fma_f32 v[46:47], v[122:123], v[18:19], v[46:47] op_sel_hi:[1,0,1]
    v_pk_fma_f32 v[48:49], v[124:125], v[18:19], v[48:49] op_sel_hi:[1,0,1]
    v_pk_fma_f32 v[50:51], v[126:127], v[18:19], v[50:51] op_sel_hi:[1,0,1]
    v_pk_fma_f32 v[52:53], v[128:129], v[18:19], v[52:53] op_sel_hi:[1,0,1]
    v_pk_fma_f32 v[54:55], v[130:131], v[18:19], v[54:55] op_sel_hi:[1,0,1]
    v_pk_fma_f32 v[56:57], v[132:133], v[18:19], v[56:57] op_sel_hi:[1,0,1]
    v_mul_f32 v16, 0x3ae38e39, v22
    v_mul_f32 v17, 0x3ae38e39, v23
    v_fma_f32 v17, -v16, v16, v17
    v_max_f32_e64 v17, 0, v17
    v_add_f32 v17, 0x3727c5ac, v17
    v_rsq_f32 v24, v17
    s_nop 0
    v_mul_f32 v25, -v24, v16
    v_pk_fma_f32 v[40:41], v[96:97], v[18:19], v[40:41] op_sel:[0,1,0] op_sel_hi:[1,1,1]
    v_pk_fma_f32 v[42:43], v[98:99], v[18:19], v[42:43] op_sel:[0,1,0] op_sel_hi:[1,1,1]
    v_pk_fma_f32 v[44:45], v[100:101], v[18:19], v[44:45] op_sel:[0,1,0] op_sel_hi:[1,1,1]
    v_pk_fma_f32 v[46:47], v[102:103], v[18:19], v[46:47] op_sel:[0,1,0] op_sel_hi:[1,1,1]
    v_pk_fma_f32 v[48:49], v[104:105], v[18:19], v[48:49] op_sel:[0,1,0] op_sel_hi:[1,1,1]
    v_pk_fma_f32 v[50:51], v[106:107], v[18:19], v[50:51] op_sel:[0,1,0] op_sel_hi:[1,1,1]
    v_pk_fma_f32 v[52:53], v[108:109], v[18:19], v[52:53] op_sel:[0,1,0] op_sel_hi:[1,1,1]
    v_pk_fma_f32 v[54:55], v[110:111], v[18:19], v[54:55] op_sel:[0,1,0] op_sel_hi:[1,1,1]
    v_pk_fma_f32 v[56:57], v[112:113], v[18:19], v[56:57] op_sel:[0,1,0] op_sel_hi:[1,1,1]
    v_pk_fma_f32 v[116:117], v[40:41], v[24:25], v[24:25] op_sel:[0,0,1] op_sel_hi:[1,0,1]
    v_pk_fma_f32 v[118:119], v[42:43], v[24:25], v[24:25] op_sel:[0,0,1] op_sel_hi:[1,0,1]
    v_pk_fma_f32 v[120:121], v[44:45], v[24:25], v[24:25] op_sel:[0,0,1] op_sel_hi:[1,0,1]
    v_pk_fma_f32 v[122:123], v[46:47], v[24:25], v[24:25] op_sel:[0,0,1] op_sel_hi:[1,0,1]
    v_pk_fma_f32 v[124:125], v[48:49], v[24:25], v[24:25] op_sel:[0,0,1] op_sel_hi:[1,0,1]
    v_pk_fma_f32 v[126:127], v[50:51], v[24:25], v[24:25] op_sel:[0,0,1] op_sel_hi:[1,0,1]
    v_pk_fma_f32 v[128:129], v[52:53], v[24:25], v[24:25] op_sel:[0,0,1] op_sel_hi:[1,0,1]
    v_pk_fma_f32 v[130:131], v[54:55], v[24:25], v[24:25] op_sel:[0,0,1] op_sel_hi:[1,0,1]
    v_pk_fma_f32 v[132:133], v[56:57], v[24:25], v[24:25] op_sel:[0,0,1] op_sel_hi:[1,0,1]
    v_cvt_pk_bf16_f32 v28, v116, v117
    v_cvt_pk_bf16_f32 v29, v118, v119
    v_cvt_pk_bf16_f32 v30, v120, v121
    v_cvt_pk_bf16_f32 v31, v122, v123
    buffer_store_dwordx4 v[28:31], v244, s[24:27], s71 offen
    v_cvt_pk_bf16_f32 v32, v124, v125
    v_cvt_pk_bf16_f32 v33, v126, v127
    v_cvt_pk_bf16_f32 v34, v128, v129
    v_cvt_pk_bf16_f32 v35, v130, v131
    buffer_store_dwordx4 v[32:35], v244, s[24:27], s71 offen offset:256
    v_cvt_pk_bf16_f32 v36, v132, v133
    buffer_store_dword v36, v245, s[24:27], s72 offen
    s_cmp_lg_u32 s8, 0
    s_cbranch_scc1 M_pxg
M_pxb:
    s_add_u32 s13, s11, 14336
    s_add_u32 s14, s11, 14336
    s_add_u32 s14, s14, s10
    s_mov_b32 m0, s13
    s_nop 0
    s_nop 0
    buffer_load_dwordx4 v2, s[24:27], s14 offen offset:0 lds
    buffer_load_dwordx4 v2, s[24:27], s14 offen offset:1024 lds
    buffer_load_dwordx4 v2, s[24:27], s14 offen offset:2048 lds
    buffer_load_dwordx4 v2, s[24:27], s14 offen offset:3072 lds
    s_add_u32 s13, s13, 4096
    s_add_u32 s14, s14, 4096
    s_mov_b32 m0, s13
    s_nop 0
    buffer_load_dwordx4 v2, s[24:27], s14 offen offset:0 lds
    buffer_load_dwordx4 v2, s[24:27], s14 offen offset:1024 lds
    buffer_load_dwordx4 v2, s[24:27], s14 offen offset:2048 lds
    v_accvgpr_write_b32 a0, v40
    v_accvgpr_write_b32 a1, v41
    v_accvgpr_write_b32 a2, v42
    v_accvgpr_write_b32 a3, v43
    v_accvgpr_write_b32 a4, v44
    v_accvgpr_write_b32 a5, v45
    v_accvgpr_write_b32 a6, v46
    v_accvgpr_write_b32 a7, v47
    v_accvgpr_write_b32 a8, v48
    v_accvgpr_write_b32 a9, v49
    v_accvgpr_write_b32 a10, v50
    v_accvgpr_write_b32 a11, v51
    v_accvgpr_write_b32 a12, v52
    v_accvgpr_write_b32 a13, v53
    v_accvgpr_write_b32 a14, v54
    v_accvgpr_write_b32 a15, v55
    v_accvgpr_write_b32 a16, v56
    v_accvgpr_write_b32 a17, v57
    s_mov_b32 s60, 1
    s_mov_b32 s49, 0x40000000
    s_mov_b32 s59, 0x400000
    s_add_u32 s58, s9, 0x1200000
    s_add_u32 s50, s50, 0x80000
    s_mov_b32 s75, 0
    s_branch M_gemm1
M_b_l1:
    s_mov_b32 s32, s100
    s_mov_b32 s33, s101
    s_mov_b32 s34, 0x240000
    s_mov_b32 s35, 0x20000
    v_accvgpr_read_b32 v60, a0
    v_accvgpr_read_b32 v61, a1
    v_accvgpr_read_b32 v62, a2
    v_accvgpr_read_b32 v63, a3
    v_accvgpr_read_b32 v64, a4
    v_accvgpr_read_b32 v65, a5
    v_accvgpr_read_b32 v66, a6
    v_accvgpr_read_b32 v67, a7
    v_accvgpr_read_b32 v68, a8
    v_accvgpr_read_b32 v69, a9
    v_accvgpr_read_b32 v70, a10
    v_accvgpr_read_b32 v71, a11
    v_accvgpr_read_b32 v72, a12
    v_accvgpr_read_b32 v73, a13
    v_accvgpr_read_b32 v74, a14
    v_accvgpr_read_b32 v75, a15
    v_accvgpr_read_b32 v76, a16
    v_accvgpr_read_b32 v77, a17
    v_and_b32 v21, -32, v248
    v_cmp_eq_u32 vcc, 0, v4
    s_nop 1
    v_cndmask_b32_e64 v20, v241, v248, vcc
    v_pk_add_f32 v[40:41], v[40:41], v[60:61]
    v_pk_add_f32 v[42:43], v[42:43], v[62:63]
    v_pk_add_f32 v[44:45], v[44:45], v[64:65]
    v_pk_add_f32 v[46:47], v[46:47], v[66:67]
    v_pk_add_f32 v[48:49], v[48:49], v[68:69]
    v_pk_add_f32 v[50:51], v[50:51], v[70:71]
    v_pk_add_f32 v[52:53], v[52:53], v[72:73]
    v_pk_add_f32 v[54:55], v[54:55], v[74:75]
    v_pk_add_f32 v[56:57], v[56:57], v[76:77]
    v_pk_add_f32 v[136:137], v[40:41], v[44:45]
    v_pk_mul_f32 v[138:139], v[40:41], v[40:41]
    v_pk_add_f32 v[140:141], v[42:43], v[46:47]
    v_pk_mul_f32 v[142:143], v[42:43], v[42:43]
    v_pk_fma_f32 v[138:139], v[44:45], v[44:45], v[138:139]
    v_pk_fma_f32 v[142:143], v[46:47], v[46:47], v[142:143]
    v_pk_add_f32 v[136:137], v[136:137], v[48:49]
    v_pk_fma_f32 v[138:139], v[48:49], v[48:49], v[138:139]
    v_pk_add_f32 v[140:141], v[140:141], v[50:51]
    v_pk_fma_f32 v[142:143], v[50:51], v[50:51], v[142:143]
    v_pk_add_f32 v[136:137], v[136:137], v[52:53]
    v_pk_fma_f32 v[138:139], v[52:53], v[52:53], v[138:139]
    v_pk_add_f32 v[140:141], v[140:141], v[54:55]
    v_pk_fma_f32 v[142:143], v[54:55], v[54:55], v[142:143]
    v_pk_add_f32 v[136:137], v[136:137], v[56:57]
    v_pk_fma_f32 v[138:139], v[56:57], v[56:57], v[138:139]
    v_pk_add_f32 v[136:137], v[136:137], v[140:141]
    v_pk_add_f32 v[138:139], v[138:139], v[142:143]
    v_add_f32 v136, v136, v137
    v_add_f32 v137, v138, v139
    s_nop 1
    v_permlane32_swap_b32 v136, v137
    v_add_f32 v136, v136, v137
    v_mov_b32 v137, v136
    s_nop 1
    v_permlane16_swap_b32 v136, v137
    v_add_f32 v18, v136, v137
    v_mov_b32 v19, v18
    s_nop 1
    v_permlane32_swap_b32 v18, v19
    buffer_store_dwordx2 v[18:19], v20, s[24:27], s15 offen
    s_cmp_lg_u32 s8, 0
    s_cbranch_scc1 M_ps1g
M_ps1b:
    s_mov_b32 s4, s50
    s_nop 0
    buffer_load_dwordx2 v[152:153], v21, s[24:27], s4 offen offset:0 sc1
    buffer_load_dwordx2 v[154:155], v21, s[24:27], s4 offen offset:2048 sc1
    s_add_u32 s4, s4, 4096
    buffer_load_dwordx2 v[156:157], v21, s[24:27], s4 offen offset:0 sc1
    buffer_load_dwordx2 v[158:159], v21, s[24:27], s4 offen offset:2048 sc1
    s_add_u32 s4, s4, 4096
    buffer_load_dwordx2 v[160:161], v21, s[24:27], s4 offen offset:0 sc1
    buffer_load_dwordx2 v[162:163], v21, s[24:27], s4 offen offset:2048 sc1
    s_add_u32 s4, s4, 4096
    buffer_load_dwordx2 v[164:165], v21, s[24:27], s4 offen offset:0 sc1
    buffer_load_dwordx2 v[166:167], v21, s[24:27], s4 offen offset:2048 sc1
    v_accvgpr_read_b32 v96, a20
    v_accvgpr_read_b32 v97, a21
    v_accvgpr_read_b32 v98, a22
    v_accvgpr_read_b32 v99, a23
    v_accvgpr_read_b32 v100, a24
    v_accvgpr_read_b32 v101, a25
    v_accvgpr_read_b32 v102, a26
    v_accvgpr_read_b32 v103, a27
    v_accvgpr_read_b32 v104, a28
    v_accvgpr_read_b32 v105, a29
    v_accvgpr_read_b32 v106, a30
    v_accvgpr_read_b32 v107, a31
    v_accvgpr_read_b32 v108, a32
    v_accvgpr_read_b32 v109, a33
    v_accvgpr_read_b32 v110, a34
    v_accvgpr_read_b32 v111, a35
    v_accvgpr_read_b32 v112, a36
    v_accvgpr_read_b32 v113, a37
    v_pk_mul_f32 v[116:117], v[40:41], v[96:97]
    v_pk_mul_f32 v[118:119], v[42:43], v[98:99]
    v_pk_mul_f32 v[120:121], v[44:45], v[100:101]
    v_pk_mul_f32 v[122:123], v[46:47], v[102:103]
    v_pk_mul_f32 v[124:125], v[48:49], v[104:105]
    v_pk_mul_f32 v[126:127], v[50:51], v[106:107]
    v_pk_mul_f32 v[128:129], v[52:53], v[108:109]
    v_pk_mul_f32 v[130:131], v[54:55], v[110:111]
    v_pk_mul_f32 v[132:133], v[56:57], v[112:113]
    s_mov_b32 s75, 0
    s_waitcnt vmcnt(0)
    v_pk_add_f32 v[152:153], v[152:153], v[160:161]
    v_pk_add_f32 v[154:155], v[154:155], v[162:163]
    v_pk_add_f32 v[156:157], v[156:157], v[164:165]
    v_pk_add_f32 v[158:159], v[158:159], v[166:167]
    v_pk_add_f32 v[152:153], v[152:153], v[154:155]
    v_pk_add_f32 v[156:157], v[156:157], v[158:159]
    v_pk_add_f32 v[152:153], v[152:153], v[156:157]
    v_cmp_u_f32_e64 vcc, v152, v153
    v_mul_f32 v16, 0x3ae38e39, v152
    v_mul_f32 v17, 0x3ae38e39, v153
    v_fma_f32 v17, -v16, v16, v17
    v_max_f32_e64 v17, 0, v17
    v_add_f32 v17, 0x3727c5ac, v17
    v_rsq_f32 v18, v17
    s_nop 0
    v_mul_f32 v19, -v18, v16
    s_cbranch_vccnz M_sr1
M_sb1:
    s_nop 0
    v_pk_fma_f32 v[40:41], v[116:117], v[18:19], v[40:41] op_sel_hi:[1,0,1]
    v_pk_fma_f32 v[42:43], v[118:119], v[18:19], v[42:43] op_sel_hi:[1,0,1]
    v_pk_fma_f32 v[44:45], v[120:121], v[18:19], v[44:45] op_sel_hi:[1,0,1]
    v_pk_fma_f32 v[46:47], v[122:123], v[18:19], v[46:47] op_sel_hi:[1,0,1]
    v_pk_fma_f32 v[48:49], v[124:125], v[18:19], v[48:49] op_sel_hi:[1,0,1]
    v_pk_fma_f32 v[50:51], v[126:127], v[18:19], v[50:51] op_sel_hi:[1,0,1]
    v_pk_fma_f32 v[52:53], v[128:129], v[18:19], v[52:53] op_sel_hi:[1,0,1]
    v_pk_fma_f32 v[54:55], v[130:131], v[18:19], v[54:55] op_sel_hi:[1,0,1]
    v_pk_fma_f32 v[56:57], v[132:133], v[18:19], v[56:57] op_sel_hi:[1,0,1]
    v_pk_fma_f32 v[40:41], v[96:97], v[18:19], v[40:41] op_sel:[0,1,0] op_sel_hi:[1,1,1]
    v_pk_fma_f32 v[42:43], v[98:99], v[18:19], v[42:43] op_sel:[0,1,0] op_sel_hi:[1,1,1]
    v_pk_fma_f32 v[44:45], v[100:101], v[18:19], v[44:45] op_sel:[0,1,0] op_sel_hi:[1,1,1]
    v_pk_fma_f32 v[46:47], v[102:103], v[18:19], v[46:47] op_sel:[0,1,0] op_sel_hi:[1,1,1]
    v_pk_fma_f32 v[48:49], v[104:105], v[18:19], v[48:49] op_sel:[0,1,0] op_sel_hi:[1,1,1]
    v_pk_fma_f32 v[50:51], v[106:107], v[18:19], v[50:51] op_sel:[0,1,0] op_sel_hi:[1,1,1]
    v_pk_fma_f32 v[52:53], v[108:109], v[18:19], v[52:53] op_sel:[0,1,0] op_sel_hi:[1,1,1]
    v_pk_fma_f32 v[54:55], v[110:111], v[18:19], v[54:55] op_sel:[0,1,0] op_sel_hi:[1,1,1]
    v_pk_fma_f32 v[56:57], v[112:113], v[18:19], v[56:57] op_sel:[0,1,0] op_sel_hi:[1,1,1]
    v_cvt_pk_bf16_f32 v28, v40, v41
    v_cvt_pk_bf16_f32 v29, v42, v43
    v_cvt_pk_bf16_f32 v30, v44, v45
    v_cvt_pk_bf16_f32 v31, v46, v47
    buffer_store_dwordx4 v[28:31], v243, s[32:35], s48 offen
    v_cvt_pk_bf16_f32 v32, v48, v49
    v_cvt_pk_bf16_f32 v33, v50, v51
    v_cvt_pk_bf16_f32 v34, v52, v53
    v_cvt_pk_bf16_f32 v35, v54, v55
    buffer_store_dwordx4 v[32:35], v243, s[32:35], s48 offen offset:16
    v_cvt_pk_bf16_f32 v36, v56, v57
    buffer_store_dword v36, v243, s[32:35], s48 offen offset:32
    s_endpgm
M_epoch_retry:
    buffer_load_dwordx2 v[234:235], off, s[84:87], 0 sc1
    s_add_u32 s75, s75, 1
    s_waitcnt vmcnt(0)
    s_cmp_lt_u32 s75, 20000
    s_cbranch_scc1 M_epoch
    s_branch M_epoch_ok
M_pfg:
    s_lshl_b32 s4, s7, 10
    s_add_u32 s4, s4, s9
    s_nop 0
    s_add_u32 s4, s4, 0xac0000
    buffer_store_dwordx4 v[32:35], v2, s[24:27], s4 offen sc1
    buffer_store_dwordx4 v[32:35], v0, s[24:27], s4 offen sc1
    s_add_u32 s4, s70, 0xac0000
    buffer_store_dwordx2 v[32:33], v242, s[24:27], s4 offen sc1
    s_add_u32 s4, s4, 18432
    buffer_store_dwordx2 v[32:33], v242, s[24:27], s4 offen sc1
    s_movk_i32 s5, 0
    buffer_store_dwordx4 v[108:111], v124, s[24:27], s5 offen sc1
    s_movk_i32 s5, 4096
    buffer_store_dwordx4 v[112:115], v124, s[24:27], s5 offen sc1
    s_movk_i32 s5, 8192
    buffer_store_dwordx4 v[116:119], v124, s[24:27], s5 offen sc1
    s_movk_i32 s5, 12288
    buffer_store_dwordx4 v[120:123], v124, s[24:27], s5 offen sc1
    s_waitcnt vmcnt(0)
    s_branch M_pfb
M_x0r:
    s_waitcnt vmcnt(0)
    s_add_u32 s4, s58, 14336
    buffer_load_dwordx4 v[120:123], v2, s[24:27], s4 offen sc1
    buffer_load_dwordx4 v[124:127], v0, s[24:27], s4 offen sc1
    v_max_u32 v16, v115, v119
    v_cmp_eq_u32 vcc, -1, v16
    s_cbranch_vccz M_x0s1
    s_add_u32 s4, s58, 15360
    buffer_load_dwordx4 v[112:115], v2, s[24:27], s4 offen sc1
    buffer_load_dwordx4 v[116:119], v0, s[24:27], s4 offen sc1
M_x0s1:
    v_max3_u32 v16, v104, v105, v106
    v_max3_u32 v17, v108, v109, v110
    v_max3_u32 v16, v16, v107, v111
    v_max_u32 v16, v16, v17
    v_cmp_eq_u32_e64 vcc, -1, v16
    s_cbranch_vccz M_x0s2
    s_add_u32 s4, s58, 16384
    buffer_load_dwordx4 v[104:107], v2, s[24:27], s4 offen sc1
    buffer_load_dwordx4 v[108:111], v0, s[24:27], s4 offen sc1
M_x0s2:
    s_add_u32 s75, s75, 1
    s_waitcnt vmcnt(0)
    v_max_u32 v16, v123, v127
    v_cmp_eq_u32 vcc, -1, v16
    s_cmp_lt_u32 s75, 20000
    s_cbranch_scc0 M_x0b
    s_cbranch_vccnz M_x0r
    s_branch M_x0b
M_x1r:
    s_waitcnt vmcnt(0)
    s_add_u32 s4, s58, 15360
    buffer_load_dwordx4 v[112:115], v2, s[24:27], s4 offen sc1
    buffer_load_dwordx4 v[116:119], v0, s[24:27], s4 offen sc1
    v_max3_u32 v16, v104, v105, v106
    v_max3_u32 v17, v108, v109, v110
    v_max3_u32 v16, v16, v107, v111
    v_max_u32 v16, v16, v17
    v_cmp_eq_u32_e64 vcc, -1, v16
    s_cbranch_vccz M_x1s1
    s_add_u32 s4, s58, 16384
    buffer_load_dwordx4 v[104:107], v2, s[24:27], s4 offen sc1
    buffer_load_dwordx4 v[108:111], v0, s[24:27], s4 offen sc1
M_x1s1:
    v_max3_u32 v16, v96, v97, v98
    v_max3_u32 v17, v100, v101, v102
    v_max3_u32 v16, v16, v99, v103
    v_max_u32 v16, v16, v17
    v_cmp_eq_u32_e64 vcc, -1, v16
    s_cbranch_vccz M_x1s2
    s_add_u32 s4, s58, 17408
    buffer_load_dwordx4 v[96:99], v2, s[24:27], s4 offen sc1
    buffer_load_dwordx4 v[100:103], v0, s[24:27], s4 offen sc1
M_x1s2:
    s_add_u32 s75, s75, 1
    s_waitcnt vmcnt(0)
    v_max_u32 v16, v115, v119
    v_cmp_eq_u32 vcc, -1, v16
    s_cmp_lt_u32 s75, 20000
    s_cbranch_scc0 M_x1b
    s_cbranch_vccnz M_x1r
    s_branch M_x1b
M_x2r:
    s_waitcnt vmcnt(0)
    s_add_u32 s4, s58, 16384
    buffer_load_dwordx4 v[104:107], v2, s[24:27], s4 offen sc1
    buffer_load_dwordx4 v[108:111], v0, s[24:27], s4 offen sc1
    v_max3_u32 v16, v96, v97, v98
    v_max3_u32 v17, v100, v101, v102
    v_max3_u32 v16, v16, v99, v103
    v_max_u32 v16, v16, v17
    v_cmp_eq_u32_e64 vcc, -1, v16
    s_cbranch_vccz M_x2s1
    s_add_u32 s4, s58, 17408
    buffer_load_dwordx4 v[96:99], v2, s[24:27], s4 offen sc1
    buffer_load_dwordx4 v[100:103], v0, s[24:27], s4 offen sc1
M_x2s1:
    v_max_u32 v16, v235, v239
    v_cmp_eq_u32 vcc, -1, v16
    s_cbranch_vccz M_x2s2
    s_add_u32 s4, s58, 0
    buffer_load_dwordx4 v[232:235], v2, s[24:27], s4 offen sc1
    buffer_load_dwordx4 v[236:239], v0, s[24:27], s4 offen sc1
M_x2s2:
    v_max_u32 v16, v227, v231
    v_cmp_eq_u32_e64 vcc, -1, v16
    s_cbranch_vccz M_x2s3
    s_add_u32 s4, s58, 1024
    buffer_load_dwordx4 v[224:227], v2, s[24:27], s4 offen sc1
    buffer_load_dwordx4 v[228:231], v0, s[24:27], s4 offen sc1
M_x2s3:
    s_add_u32 s75, s75, 1
    s_waitcnt vmcnt(0)
    v_max3_u32 v16, v104, v105, v106
    v_max3_u32 v17, v108, v109, v110
    v_max3_u32 v16, v16, v107, v111
    v_max_u32 v16, v16, v17
    v_cmp_eq_u32 vcc, -1, v16
    s_cmp_lt_u32 s75, 20000
    s_cbranch_scc0 M_x2b
    s_cbranch_vccnz M_x2r
    s_branch M_x2b
M_x3r:
    s_waitcnt vmcnt(0)
    s_add_u32 s4, s58, 17408
    buffer_load_dwordx4 v[96:99], v2, s[24:27], s4 offen sc1
    buffer_load_dwordx4 v[100:103], v0, s[24:27], s4 offen sc1
    v_max_u32 v16, v235, v239
    v_cmp_eq_u32 vcc, -1, v16
    s_cbranch_vccz M_x3s1
    s_add_u32 s4, s58, 0
    buffer_load_dwordx4 v[232:235], v2, s[24:27], s4 offen sc1
    buffer_load_dwordx4 v[236:239], v0, s[24:27], s4 offen sc1
M_x3s1:
    v_max_u32 v16, v227, v231
    v_cmp_eq_u32_e64 vcc, -1, v16
    s_cbranch_vccz M_x3s2
    s_add_u32 s4, s58, 1024
    buffer_load_dwordx4 v[224:227], v2, s[24:27], s4 offen sc1
    buffer_load_dwordx4 v[228:231], v0, s[24:27], s4 offen sc1
M_x3s2:
    v_max_u32 v16, v219, v223
    v_cmp_eq_u32_e64 vcc, -1, v16
    s_cbranch_vccz M_x3s3
    s_add_u32 s4, s58, 2048
    buffer_load_dwordx4 v[216:219], v2, s[24:27], s4 offen sc1
    buffer_load_dwordx4 v[220:223], v0, s[24:27], s4 offen sc1
M_x3s3:
    s_add_u32 s75, s75, 1
    s_waitcnt vmcnt(0)
    v_max3_u32 v16, v96, v97, v98
    v_max3_u32 v17, v100, v101, v102
    v_max3_u32 v16, v16, v99, v103
    v_max_u32 v16, v16, v17
    v_cmp_eq_u32 vcc, -1, v16
    s_cmp_lt_u32 s75, 20000
    s_cbranch_scc0 M_x3b
    s_cbranch_vccnz M_x3r
    s_branch M_x3b
M_x4r:
    s_waitcnt vmcnt(0)
    s_add_u32 s4, s58, 0
    buffer_load_dwordx4 v[232:235], v2, s[24:27], s4 offen sc1
    buffer_load_dwordx4 v[236:239], v0, s[24:27], s4 offen sc1
    v_max_u32 v16, v227, v231
    v_cmp_eq_u32 vcc, -1, v16
    s_cbranch_vccz M_x4s1
    s_add_u32 s4, s58, 1024
    buffer_load_dwordx4 v[224:227], v2, s[24:27], s4 offen sc1
    buffer_load_dwordx4 v[228:231], v0, s[24:27], s4 offen sc1
M_x4s1:
    v_max_u32 v16, v219, v223
    v_cmp_eq_u32_e64 vcc, -1, v16
    s_cbranch_vccz M_x4s2
    s_add_u32 s4, s58, 2048
    buffer_load_dwordx4 v[216:219], v2, s[24:27], s4 offen sc1
    buffer_load_dwordx4 v[220:223], v0, s[24:27], s4 offen sc1
M_x4s2:
    v_max_u32 v16, v211, v215
    v_cmp_eq_u32_e64 vcc, -1, v16
    s_cbranch_vccz M_x4s3
    s_add_u32 s4, s58, 3072
    buffer_load_dwordx4 v[208:211], v2, s[24:27], s4 offen sc1
    buffer_load_dwordx4 v[212:215], v0, s[24:27], s4 offen sc1
M_x4s3:
    v_max_u32 v16, v203, v207
    v_cmp_eq_u32_e64 vcc, -1, v16
    s_cbranch_vccz M_x4s4
    s_add_u32 s4, s58, 4096
    buffer_load_dwordx4 v[200:203], v2, s[24:27], s4 offen sc1
    buffer_load_dwordx4 v[204:207], v0, s[24:27], s4 offen sc1
M_x4s4:
    s_add_u32 s75, s75, 1
    s_waitcnt vmcnt(0)
    v_max_u32 v16, v235, v239
    v_cmp_eq_u32 vcc, -1, v16
    s_cmp_lt_u32 s75, 20000
    s_cbranch_scc0 M_x4b
    s_cbranch_vccnz M_x4r
    s_branch M_x4b
M_x5r:
    s_waitcnt vmcnt(0)
    s_add_u32 s4, s58, 1024
    buffer_load_dwordx4 v[224:227], v2, s[24:27], s4 offen sc1
    buffer_load_dwordx4 v[228:231], v0, s[24:27], s4 offen sc1
    v_max_u32 v16, v219, v223
    v_cmp_eq_u32_e64 vcc, -1, v16
    s_cbranch_vccz M_x5s1
    s_add_u32 s4, s58, 2048
    buffer_load_dwordx4 v[216:219], v2, s[24:27], s4 offen sc1
    buffer_load_dwordx4 v[220:223], v0, s[24:27], s4 offen sc1
M_x5s1:
    v_max_u32 v16, v211, v215
    v_cmp_eq_u32_e64 vcc, -1, v16
    s_cbranch_vccz M_x5s2
    s_add_u32 s4, s58, 3072
    buffer_load_dwordx4 v[208:211], v2, s[24:27], s4 offen sc1
    buffer_load_dwordx4 v[212:215], v0, s[24:27], s4 offen sc1
M_x5s2:
    v_max_u32 v16, v203, v207
    v_cmp_eq_u32_e64 vcc, -1, v16
    s_cbranch_vccz M_x5s3
    s_add_u32 s4, s58, 4096
    buffer_load_dwordx4 v[200:203], v2, s[24:27], s4 offen sc1
    buffer_load_dwordx4 v[204:207], v0, s[24:27], s4 offen sc1
M_x5s3:
    v_max_u32 v16, v195, v199
    v_cmp_eq_u32_e64 vcc, -1, v16
    s_cbranch_vccz M_x5s4
    s_add_u32 s4, s58, 5120
    buffer_load_dwordx4 v[192:195], v2, s[24:27], s4 offen sc1
    buffer_load_dwordx4 v[196:199], v0, s[24:27], s4 offen sc1
M_x5s4:
    s_add_u32 s75, s75, 1
    s_waitcnt vmcnt(0)
    v_max_u32 v16, v227, v231
    v_cmp_eq_u32 vcc, -1, v16
    s_cmp_lt_u32 s75, 20000
    s_cbranch_scc0 M_x5b
    s_cbranch_vccnz M_x5r
    s_branch M_x5b
M_x6r:
    s_waitcnt vmcnt(0)
    s_add_u32 s4, s58, 2048
    buffer_load_dwordx4 v[216:219], v2, s[24:27], s4 offen sc1
    buffer_load_dwordx4 v[220:223], v0, s[24:27], s4 offen sc1
    v_max_u32 v16, v211, v215
    v_cmp_eq_u32_e64 vcc, -1, v16
    s_cbranch_vccz M_x6s1
    s_add_u32 s4, s58, 3072
    buffer_load_dwordx4 v[208:211], v2, s[24:27], s4 offen sc1
    buffer_load_dwordx4 v[212:215], v0, s[24:27], s4 offen sc1
M_x6s1:
    v_max_u32 v16, v203, v207
    v_cmp_eq_u32_e64 vcc, -1, v16
    s_cbranch_vccz M_x6s2
    s_add_u32 s4, s58, 4096
    buffer_load_dwordx4 v[200:203], v2, s[24:27], s4 offen sc1
    buffer_load_dwordx4 v[204:207], v0, s[24:27], s4 offen sc1
M_x6s2:
    v_max_u32 v16, v195, v199
    v_cmp_eq_u32_e64 vcc, -1, v16
    s_cbranch_vccz M_x6s3
    s_add_u32 s4, s58, 5120
    buffer_load_dwordx4 v[192:195], v2, s[24:27], s4 offen sc1
    buffer_load_dwordx4 v[196:199], v0, s[24:27], s4 offen sc1
M_x6s3:
    v_max_u32 v16, v187, v191
    v_cmp_eq_u32_e64 vcc, -1, v16
    s_cbranch_vccz M_x6s4
    s_add_u32 s4, s58, 6144
    buffer_load_dwordx4 v[184:187], v2, s[24:27], s4 offen sc1
    buffer_load_dwordx4 v[188:191], v0, s[24:27], s4 offen sc1
M_x6s4:
    v_max_u32 v16, v179, v183
    v_cmp_eq_u32_e64 vcc, -1, v16
    s_cbranch_vccz M_x6s5
    s_add_u32 s4, s58, 7168
    buffer_load_dwordx4 v[176:179], v2, s[24:27], s4 offen sc1
    buffer_load_dwordx4 v[180:183], v0, s[24:27], s4 offen sc1
M_x6s5:
    s_add_u32 s75, s75, 1
    s_waitcnt vmcnt(0)
    v_max_u32 v16, v219, v223
    v_cmp_eq_u32 vcc, -1, v16
    s_cmp_lt_u32 s75, 20000
    s_cbranch_scc0 M_x6b
    s_cbranch_vccnz M_x6r
    s_branch M_x6b
M_x7r:
    s_waitcnt vmcnt(0)
    s_add_u32 s4, s58, 3072
    buffer_load_dwordx4 v[208:211], v2, s[24:27], s4 offen sc1
    buffer_load_dwordx4 v[212:215], v0, s[24:27], s4 offen sc1
    v_max_u32 v16, v203, v207
    v_cmp_eq_u32_e64 vcc, -1, v16
    s_cbranch_vccz M_x7s1
    s_add_u32 s4, s58, 4096
    buffer_load_dwordx4 v[200:203], v2, s[24:27], s4 offen sc1
    buffer_load_dwordx4 v[204:207], v0, s[24:27], s4 offen sc1
M_x7s1:
    v_max_u32 v16, v195, v199
    v_cmp_eq_u32_e64 vcc, -1, v16
    s_cbranch_vccz M_x7s2
    s_add_u32 s4, s58, 5120
    buffer_load_dwordx4 v[192:195], v2, s[24:27], s4 offen sc1
    buffer_load_dwordx4 v[196:199], v0, s[24:27], s4 offen sc1
M_x7s2:
    v_max_u32 v16, v187, v191
    v_cmp_eq_u32_e64 vcc, -1, v16
    s_cbranch_vccz M_x7s3
    s_add_u32 s4, s58, 6144
    buffer_load_dwordx4 v[184:187], v2, s[24:27], s4 offen sc1
    buffer_load_dwordx4 v[188:191], v0, s[24:27], s4 offen sc1
M_x7s3:
    v_max_u32 v16, v179, v183
    v_cmp_eq_u32_e64 vcc, -1, v16
    s_cbranch_vccz M_x7s4
    s_add_u32 s4, s58, 7168
    buffer_load_dwordx4 v[176:179], v2, s[24:27], s4 offen sc1
    buffer_load_dwordx4 v[180:183], v0, s[24:27], s4 offen sc1
M_x7s4:
    v_max_u32 v16, v171, v175
    v_cmp_eq_u32_e64 vcc, -1, v16
    s_cbranch_vccz M_x7s5
    s_add_u32 s4, s58, 8192
    buffer_load_dwordx4 v[168:171], v2, s[24:27], s4 offen sc1
    buffer_load_dwordx4 v[172:175], v0, s[24:27], s4 offen sc1
M_x7s5:
    s_add_u32 s75, s75, 1
    s_waitcnt vmcnt(0)
    v_max_u32 v16, v211, v215
    v_cmp_eq_u32 vcc, -1, v16
    s_cmp_lt_u32 s75, 20000
    s_cbranch_scc0 M_x7b
    s_cbranch_vccnz M_x7r
    s_branch M_x7b
M_x8r:
    s_waitcnt vmcnt(0)
    s_add_u32 s4, s58, 4096
    buffer_load_dwordx4 v[200:203], v2, s[24:27], s4 offen sc1
    buffer_load_dwordx4 v[204:207], v0, s[24:27], s4 offen sc1
    v_max_u32 v16, v195, v199
    v_cmp_eq_u32_e64 vcc, -1, v16
    s_cbranch_vccz M_x8s1
    s_add_u32 s4, s58, 5120
    buffer_load_dwordx4 v[192:195], v2, s[24:27], s4 offen sc1
    buffer_load_dwordx4 v[196:199], v0, s[24:27], s4 offen sc1
M_x8s1:
    v_max_u32 v16, v187, v191
    v_cmp_eq_u32_e64 vcc, -1, v16
    s_cbranch_vccz M_x8s2
    s_add_u32 s4, s58, 6144
    buffer_load_dwordx4 v[184:187], v2, s[24:27], s4 offen sc1
    buffer_load_dwordx4 v[188:191], v0, s[24:27], s4 offen sc1
M_x8s2:
    v_max_u32 v16, v179, v183
    v_cmp_eq_u32_e64 vcc, -1, v16
    s_cbranch_vccz M_x8s3
    s_add_u32 s4, s58, 7168
    buffer_load_dwordx4 v[176:179], v2, s[24:27], s4 offen sc1
    buffer_load_dwordx4 v[180:183], v0, s[24:27], s4 offen sc1
M_x8s3:
    v_max_u32 v16, v171, v175
    v_cmp_eq_u32_e64 vcc, -1, v16
    s_cbranch_vccz M_x8s4
    s_add_u32 s4, s58, 8192
    buffer_load_dwordx4 v[168:171], v2, s[24:27], s4 offen sc1
    buffer_load_dwordx4 v[172:175], v0, s[24:27], s4 offen sc1
M_x8s4:
    v_max_u32 v16, v163, v167
    v_cmp_eq_u32_e64 vcc, -1, v16
    s_cbranch_vccz M_x8s5
    s_add_u32 s4, s58, 9216
    buffer_load_dwordx4 v[160:163], v2, s[24:27], s4 offen sc1
    buffer_load_dwordx4 v[164:167], v0, s[24:27], s4 offen sc1
M_x8s5:
    v_max_u32 v16, v155, v159
    v_cmp_eq_u32_e64 vcc, -1, v16
    s_cbranch_vccz M_x8s6
    s_add_u32 s4, s58, 10240
    buffer_load_dwordx4 v[152:155], v2, s[24:27], s4 offen sc1
    buffer_load_dwordx4 v[156:159], v0, s[24:27], s4 offen sc1
M_x8s6:
    s_add_u32 s75, s75, 1
    s_waitcnt vmcnt(0)
    v_max_u32 v16, v203, v207
    v_cmp_eq_u32 vcc, -1, v16
    s_cmp_lt_u32 s75, 20000
    s_cbranch_scc0 M_x8b
    s_cbranch_vccnz M_x8r
    s_branch M_x8b
M_x9r:
    s_waitcnt vmcnt(0)
    s_add_u32 s4, s58, 5120
    buffer_load_dwordx4 v[192:195], v2, s[24:27], s4 offen sc1
    buffer_load_dwordx4 v[196:199], v0, s[24:27], s4 offen sc1
    v_max_u32 v16, v187, v191
    v_cmp_eq_u32_e64 vcc, -1, v16
    s_cbranch_vccz M_x9s1
    s_add_u32 s4, s58, 6144
    buffer_load_dwordx4 v[184:187], v2, s[24:27], s4 offen sc1
    buffer_load_dwordx4 v[188:191], v0, s[24:27], s4 offen sc1
M_x9s1:
    v_max_u32 v16, v179, v183
    v_cmp_eq_u32_e64 vcc, -1, v16
    s_cbranch_vccz M_x9s2
    s_add_u32 s4, s58, 7168
    buffer_load_dwordx4 v[176:179], v2, s[24:27], s4 offen sc1
    buffer_load_dwordx4 v[180:183], v0, s[24:27], s4 offen sc1
M_x9s2:
    v_max_u32 v16, v171, v175
    v_cmp_eq_u32_e64 vcc, -1, v16
    s_cbranch_vccz M_x9s3
    s_add_u32 s4, s58, 8192
    buffer_load_dwordx4 v[168:171], v2, s[24:27], s4 offen sc1
    buffer_load_dwordx4 v[172:175], v0, s[24:27], s4 offen sc1
M_x9s3:
    v_max_u32 v16, v163, v167
    v_cmp_eq_u32_e64 vcc, -1, v16
    s_cbranch_vccz M_x9s4
    s_add_u32 s4, s58, 9216
    buffer_load_dwordx4 v[160:163], v2, s[24:27], s4 offen sc1
    buffer_load_dwordx4 v[164:167], v0, s[24:27], s4 offen sc1
M_x9s4:
    v_max_u32 v16, v155, v159
    v_cmp_eq_u32_e64 vcc, -1, v16
    s_cbranch_vccz M_x9s5
    s_add_u32 s4, s58, 10240
    buffer_load_dwordx4 v[152:155], v2, s[24:27], s4 offen sc1
    buffer_load_dwordx4 v[156:159], v0, s[24:27], s4 offen sc1
M_x9s5:
    v_max_u32 v16, v147, v151
    v_cmp_eq_u32_e64 vcc, -1, v16
    s_cbranch_vccz M_x9s6
    s_add_u32 s4, s58, 11264
    buffer_load_dwordx4 v[144:147], v2, s[24:27], s4 offen sc1
    buffer_load_dwordx4 v[148:151], v0, s[24:27], s4 offen sc1
M_x9s6:
    s_add_u32 s75, s75, 1
    s_waitcnt vmcnt(0)
    v_max_u32 v16, v195, v199
    v_cmp_eq_u32 vcc, -1, v16
    s_cmp_lt_u32 s75, 20000
    s_cbranch_scc0 M_x9b
    s_cbranch_vccnz M_x9r
    s_branch M_x9b
M_x10r:
    s_waitcnt vmcnt(0)
    s_add_u32 s4, s58, 6144
    buffer_load_dwordx4 v[184:187], v2, s[24:27], s4 offen sc1
    buffer_load_dwordx4 v[188:191], v0, s[24:27], s4 offen sc1
    v_max_u32 v16, v179, v183
    v_cmp_eq_u32_e64 vcc, -1, v16
    s_cbranch_vccz M_x10s1
    s_add_u32 s4, s58, 7168
    buffer_load_dwordx4 v[176:179], v2, s[24:27], s4 offen sc1
    buffer_load_dwordx4 v[180:183], v0, s[24:27], s4 offen sc1
M_x10s1:
    v_max_u32 v16, v171, v175
    v_cmp_eq_u32_e64 vcc, -1, v16
    s_cbranch_vccz M_x10s2
    s_add_u32 s4, s58, 8192
    buffer_load_dwordx4 v[168:171], v2, s[24:27], s4 offen sc1
    buffer_load_dwordx4 v[172:175], v0, s[24:27], s4 offen sc1
M_x10s2:
    v_max_u32 v16, v163, v167
    v_cmp_eq_u32_e64 vcc, -1, v16
    s_cbranch_vccz M_x10s3
    s_add_u32 s4, s58, 9216
    buffer_load_dwordx4 v[160:163], v2, s[24:27], s4 offen sc1
    buffer_load_dwordx4 v[164:167], v0, s[24:27], s4 offen sc1
M_x10s3:
    v_max_u32 v16, v155, v159
    v_cmp_eq_u32_e64 vcc, -1, v16
    s_cbranch_vccz M_x10s4
    s_add_u32 s4, s58, 10240
    buffer_load_dwordx4 v[152:155], v2, s[24:27], s4 offen sc1
    buffer_load_dwordx4 v[156:159], v0, s[24:27], s4 offen sc1
M_x10s4:
    v_max_u32 v16, v147, v151
    v_cmp_eq_u32_e64 vcc, -1, v16
    s_cbranch_vccz M_x10s5
    s_add_u32 s4, s58, 11264
    buffer_load_dwordx4 v[144:147], v2, s[24:27], s4 offen sc1
    buffer_load_dwordx4 v[148:151], v0, s[24:27], s4 offen sc1
M_x10s5:
    v_max_u32 v16, v139, v143
    v_cmp_eq_u32_e64 vcc, -1, v16
    s_cbranch_vccz M_x10s6
    s_add_u32 s4, s58, 12288
    buffer_load_dwordx4 v[136:139], v2, s[24:27], s4 offen sc1
    buffer_load_dwordx4 v[140:143], v0, s[24:27], s4 offen sc1
M_x10s6:
    v_max_u32 v16, v131, v135
    v_cmp_eq_u32_e64 vcc, -1, v16
    s_cbranch_vccz M_x10s7
    s_add_u32 s4, s58, 13312
    buffer_load_dwordx4 v[128:131], v2, s[24:27], s4 offen sc1
    buffer_load_dwordx4 v[132:135], v0, s[24:27], s4 offen sc1
M_x10s7:
    s_add_u32 s75, s75, 1
    s_waitcnt vmcnt(0)
    v_max_u32 v16, v187, v191
    v_cmp_eq_u32 vcc, -1, v16
    s_cmp_lt_u32 s75, 20000
    s_cbranch_scc0 M_x10b
    s_cbranch_vccnz M_x10r
    s_branch M_x10b
M_x11r:
    s_waitcnt vmcnt(0)
    s_add_u32 s4, s58, 7168
    buffer_load_dwordx4 v[176:179], v2, s[24:27], s4 offen sc1
    buffer_load_dwordx4 v[180:183], v0, s[24:27], s4 offen sc1
    v_max_u32 v16, v171, v175
    v_cmp_eq_u32_e64 vcc, -1, v16
    s_cbranch_vccz M_x11s1
    s_add_u32 s4, s58, 8192
    buffer_load_dwordx4 v[168:171], v2, s[24:27], s4 offen sc1
    buffer_load_dwordx4 v[172:175], v0, s[24:27], s4 offen sc1
M_x11s1:
    v_max_u32 v16, v163, v167
    v_cmp_eq_u32_e64 vcc, -1, v16
    s_cbranch_vccz M_x11s2
    s_add_u32 s4, s58, 9216
    buffer_load_dwordx4 v[160:163], v2, s[24:27], s4 offen sc1
    buffer_load_dwordx4 v[164:167], v0, s[24:27], s4 offen sc1
M_x11s2:
    v_max_u32 v16, v155, v159
    v_cmp_eq_u32_e64 vcc, -1, v16
    s_cbranch_vccz M_x11s3
    s_add_u32 s4, s58, 10240
    buffer_load_dwordx4 v[152:155], v2, s[24:27], s4 offen sc1
    buffer_load_dwordx4 v[156:159], v0, s[24:27], s4 offen sc1
M_x11s3:
    v_max_u32 v16, v147, v151
    v_cmp_eq_u32_e64 vcc, -1, v16
    s_cbranch_vccz M_x11s4
    s_add_u32 s4, s58, 11264
    buffer_load_dwordx4 v[144:147], v2, s[24:27], s4 offen sc1
    buffer_load_dwordx4 v[148:151], v0, s[24:27], s4 offen sc1
M_x11s4:
    v_max_u32 v16, v139, v143
    v_cmp_eq_u32_e64 vcc, -1, v16
    s_cbranch_vccz M_x11s5
    s_add_u32 s4, s58, 12288
    buffer_load_dwordx4 v[136:139], v2, s[24:27], s4 offen sc1
    buffer_load_dwordx4 v[140:143], v0, s[24:27], s4 offen sc1
M_x11s5:
    v_max_u32 v16, v131, v135
    v_cmp_eq_u32_e64 vcc, -1, v16
    s_cbranch_vccz M_x11s6
    s_add_u32 s4, s58, 13312
    buffer_load_dwordx4 v[128:131], v2, s[24:27], s4 offen sc1
    buffer_load_dwordx4 v[132:135], v0, s[24:27], s4 offen sc1
M_x11s6:
    s_add_u32 s75, s75, 1
    s_waitcnt vmcnt(0)
    v_max_u32 v16, v179, v183
    v_cmp_eq_u32 vcc, -1, v16
    s_cmp_lt_u32 s75, 20000
    s_cbranch_scc0 M_x11b
    s_cbranch_vccnz M_x11r
    s_branch M_x11b
M_x12r:
    s_waitcnt vmcnt(0)
    s_add_u32 s4, s58, 8192
    buffer_load_dwordx4 v[168:171], v2, s[24:27], s4 offen sc1
    buffer_load_dwordx4 v[172:175], v0, s[24:27], s4 offen sc1
    v_max_u32 v16, v163, v167
    v_cmp_eq_u32_e64 vcc, -1, v16
    s_cbranch_vccz M_x12s1
    s_add_u32 s4, s58, 9216
    buffer_load_dwordx4 v[160:163], v2, s[24:27], s4 offen sc1
    buffer_load_dwordx4 v[164:167], v0, s[24:27], s4 offen sc1
M_x12s1:
    v_max_u32 v16, v155, v159
    v_cmp_eq_u32_e64 vcc, -1, v16
    s_cbranch_vccz M_x12s2
    s_add_u32 s4, s58, 10240
    buffer_load_dwordx4 v[152:155], v2, s[24:27], s4 offen sc1
    buffer_load_dwordx4 v[156:159], v0, s[24:27], s4 offen sc1
M_x12s2:
    v_max_u32 v16, v147, v151
    v_cmp_eq_u32_e64 vcc, -1, v16
    s_cbranch_vccz M_x12s3
    s_add_u32 s4, s58, 11264
    buffer_load_dwordx4 v[144:147], v2, s[24:27], s4 offen sc1
    buffer_load_dwordx4 v[148:151], v0, s[24:27], s4 offen sc1
M_x12s3:
    v_max_u32 v16, v139, v143
    v_cmp_eq_u32_e64 vcc, -1, v16
    s_cbranch_vccz M_x12s4
    s_add_u32 s4, s58, 12288
    buffer_load_dwordx4 v[136:139], v2, s[24:27], s4 offen sc1
    buffer_load_dwordx4 v[140:143], v0, s[24:27], s4 offen sc1
M_x12s4:
    v_max_u32 v16, v131, v135
    v_cmp_eq_u32_e64 vcc, -1, v16
    s_cbranch_vccz M_x12s5
    s_add_u32 s4, s58, 13312
    buffer_load_dwordx4 v[128:131], v2, s[24:27], s4 offen sc1
    buffer_load_dwordx4 v[132:135], v0, s[24:27], s4 offen sc1
M_x12s5:
    s_add_u32 s75, s75, 1
    s_waitcnt vmcnt(0)
    v_max_u32 v16, v171, v175
    v_cmp_eq_u32 vcc, -1, v16
    s_cmp_lt_u32 s75, 20000
    s_cbranch_scc0 M_x12b
    s_cbranch_vccnz M_x12r
    s_branch M_x12b
M_x13r:
    s_waitcnt vmcnt(0)
    s_add_u32 s4, s58, 9216
    buffer_load_dwordx4 v[160:163], v2, s[24:27], s4 offen sc1
    buffer_load_dwordx4 v[164:167], v0, s[24:27], s4 offen sc1
    v_max_u32 v16, v155, v159
    v_cmp_eq_u32_e64 vcc, -1, v16
    s_cbranch_vccz M_x13s1
    s_add_u32 s4, s58, 10240
    buffer_load_dwordx4 v[152:155], v2, s[24:27], s4 offen sc1
    buffer_load_dwordx4 v[156:159], v0, s[24:27], s4 offen sc1
M_x13s1:
    v_max_u32 v16, v147, v151
    v_cmp_eq_u32_e64 vcc, -1, v16
    s_cbranch_vccz M_x13s2
    s_add_u32 s4, s58, 11264
    buffer_load_dwordx4 v[144:147], v2, s[24:27], s4 offen sc1
    buffer_load_dwordx4 v[148:151], v0, s[24:27], s4 offen sc1
M_x13s2:
    v_max_u32 v16, v139, v143
    v_cmp_eq_u32_e64 vcc, -1, v16
    s_cbranch_vccz M_x13s3
    s_add_u32 s4, s58, 12288
    buffer_load_dwordx4 v[136:139], v2, s[24:27], s4 offen sc1
    buffer_load_dwordx4 v[140:143], v0, s[24:27], s4 offen sc1
M_x13s3:
    v_max_u32 v16, v131, v135
    v_cmp_eq_u32_e64 vcc, -1, v16
    s_cbranch_vccz M_x13s4
    s_add_u32 s4, s58, 13312
    buffer_load_dwordx4 v[128:131], v2, s[24:27], s4 offen sc1
    buffer_load_dwordx4 v[132:135], v0, s[24:27], s4 offen sc1
M_x13s4:
    s_add_u32 s75, s75, 1
    s_waitcnt vmcnt(0)
    v_max_u32 v16, v163, v167
    v_cmp_eq_u32 vcc, -1, v16
    s_cmp_lt_u32 s75, 20000
    s_cbranch_scc0 M_x13b
    s_cbranch_vccnz M_x13r
    s_branch M_x13b
M_x14r:
    s_waitcnt vmcnt(0)
    s_add_u32 s4, s58, 10240
    buffer_load_dwordx4 v[152:155], v2, s[24:27], s4 offen sc1
    buffer_load_dwordx4 v[156:159], v0, s[24:27], s4 offen sc1
    v_max_u32 v16, v147, v151
    v_cmp_eq_u32_e64 vcc, -1, v16
    s_cbranch_vccz M_x14s1
    s_add_u32 s4, s58, 11264
    buffer_load_dwordx4 v[144:147], v2, s[24:27], s4 offen sc1
    buffer_load_dwordx4 v[148:151], v0, s[24:27], s4 offen sc1
M_x14s1:
    v_max_u32 v16, v139, v143
    v_cmp_eq_u32_e64 vcc, -1, v16
    s_cbranch_vccz M_x14s2
    s_add_u32 s4, s58, 12288
    buffer_load_dwordx4 v[136:139], v2, s[24:27], s4 offen sc1
    buffer_load_dwordx4 v[140:143], v0, s[24:27], s4 offen sc1
M_x14s2:
    v_max_u32 v16, v131, v135
    v_cmp_eq_u32_e64 vcc, -1, v16
    s_cbranch_vccz M_x14s3
    s_add_u32 s4, s58, 13312
    buffer_load_dwordx4 v[128:131], v2, s[24:27], s4 offen sc1
    buffer_load_dwordx4 v[132:135], v0, s[24:27], s4 offen sc1
M_x14s3:
    s_add_u32 s75, s75, 1
    s_waitcnt vmcnt(0)
    v_max_u32 v16, v155, v159
    v_cmp_eq_u32 vcc, -1, v16
    s_cmp_lt_u32 s75, 20000
    s_cbranch_scc0 M_x14b
    s_cbranch_vccnz M_x14r
    s_branch M_x14b
M_x15r:
    s_waitcnt vmcnt(0)
    s_add_u32 s4, s58, 11264
    buffer_load_dwordx4 v[144:147], v2, s[24:27], s4 offen sc1
    buffer_load_dwordx4 v[148:151], v0, s[24:27], s4 offen sc1
    v_max_u32 v16, v139, v143
    v_cmp_eq_u32_e64 vcc, -1, v16
    s_cbranch_vccz M_x15s1
    s_add_u32 s4, s58, 12288
    buffer_load_dwordx4 v[136:139], v2, s[24:27], s4 offen sc1
    buffer_load_dwordx4 v[140:143], v0, s[24:27], s4 offen sc1
M_x15s1:
    v_max_u32 v16, v131, v135
    v_cmp_eq_u32_e64 vcc, -1, v16
    s_cbranch_vccz M_x15s2
    s_add_u32 s4, s58, 13312
    buffer_load_dwordx4 v[128:131], v2, s[24:27], s4 offen sc1
    buffer_load_dwordx4 v[132:135], v0, s[24:27], s4 offen sc1
M_x15s2:
    s_add_u32 s75, s75, 1
    s_waitcnt vmcnt(0)
    v_max_u32 v16, v147, v151
    v_cmp_eq_u32 vcc, -1, v16
    s_cmp_lt_u32 s75, 20000
    s_cbranch_scc0 M_x15b
    s_cbranch_vccnz M_x15r
    s_branch M_x15b
M_x16r:
    s_waitcnt vmcnt(0)
    s_add_u32 s4, s58, 12288
    buffer_load_dwordx4 v[136:139], v2, s[24:27], s4 offen sc1
    buffer_load_dwordx4 v[140:143], v0, s[24:27], s4 offen sc1
    v_max_u32 v16, v131, v135
    v_cmp_eq_u32_e64 vcc, -1, v16
    s_cbranch_vccz M_x16s1
    s_add_u32 s4, s58, 13312
    buffer_load_dwordx4 v[128:131], v2, s[24:27], s4 offen sc1
    buffer_load_dwordx4 v[132:135], v0, s[24:27], s4 offen sc1
M_x16s1:
    s_add_u32 s75, s75, 1
    s_waitcnt vmcnt(0)
    v_max_u32 v16, v139, v143
    v_cmp_eq_u32 vcc, -1, v16
    s_cmp_lt_u32 s75, 20000
    s_cbranch_scc0 M_x16b
    s_cbranch_vccnz M_x16r
    s_branch M_x16b
M_x17r:
    s_waitcnt vmcnt(0)
    s_add_u32 s4, s58, 13312
    buffer_load_dwordx4 v[128:131], v2, s[24:27], s4 offen sc1
    buffer_load_dwordx4 v[132:135], v0, s[24:27], s4 offen sc1
    s_add_u32 s75, s75, 1
    s_waitcnt vmcnt(0)
    v_max_u32 v16, v131, v135
    v_cmp_eq_u32 vcc, -1, v16
    s_cmp_lt_u32 s75, 20000
    s_cbranch_scc0 M_x17b
    s_cbranch_vccnz M_x17r
    s_branch M_x17b
M_pbr:
    s_waitcnt vmcnt(0)
    buffer_load_dwordx2 v[34:35], v33, s[24:27], s46 offen sc1
    s_add_u32 s75, s75, 1
    s_waitcnt vmcnt(0)
    v_xor_b32 v35, s89, v35
    v_cmp_ne_u32 vcc, s88, v34
    v_cmp_lt_u32 s[62:63], 15, v35
    s_nop 0
    s_or_b64 vcc, vcc, s[62:63]
    s_cmp_lt_u32 s75, 20000
    s_cbranch_scc0 M_pbb
    s_cbranch_vccnz M_pbr
    s_branch M_pbb
M_plg:
    s_lshl_b32 s4, s7, 10
    s_add_u32 s4, s4, s9
    s_nop 0
    s_add_u32 s4, s4, 0xec0000
    buffer_store_dwordx4 v[60:63], v2, s[24:27], s4 offen sc1
    buffer_store_dwordx4 v[60:63], v0, s[24:27], s4 offen sc1
    s_add_u32 s4, s70, 0xec0000
    buffer_store_dwordx2 v[60:61], v242, s[24:27], s4 offen sc1
    s_add_u32 s4, s4, 18432
    buffer_store_dwordx2 v[60:61], v242, s[24:27], s4 offen sc1
    s_lshl_b32 s4, s17, 11
    s_add_u32 s4, s4, s50
    s_lshl_b32 s5, s3, 9
    s_add_u32 s4, s4, s5
    buffer_store_dwordx4 v[60:63], v64, s[24:27], s4 offen sc1
    buffer_store_dwordx4 v[60:63], v244, s[24:27], s71 offen sc1
    buffer_store_dwordx4 v[60:63], v244, s[24:27], s71 offen offset:256 sc1
    buffer_store_dword v60, v245, s[24:27], s72 offen sc1
    s_branch M_plb
M_gr:
    v_max3_u32 v24, v139, v143, v147
    v_cmp_eq_u32_e64 vcc, -1, v24
    s_cbranch_vccz M_gs0
    s_add_u32 s4, s74, s59
    s_add_u32 s4, s4, 0
    buffer_load_dwordx4 v[136:139], v252, s[24:27], s4 offen offset:0 sc1
    buffer_load_dwordx4 v[140:143], v252, s[24:27], s4 offen offset:256 sc1
    buffer_load_dwordx4 v[144:147], v253, s[24:27], s4 offen offset:512 sc1
M_gs0:
    v_max3_u32 v25, v151, v155, v159
    v_cmp_eq_u32_e64 vcc, -1, v25
    s_cbranch_vccz M_gs1
    s_add_u32 s4, s74, s59
    s_add_u32 s4, s4, 12288
    buffer_load_dwordx4 v[148:151], v252, s[24:27], s4 offen offset:0 sc1
    buffer_load_dwordx4 v[152:155], v252, s[24:27], s4 offen offset:256 sc1
    buffer_load_dwordx4 v[156:159], v253, s[24:27], s4 offen offset:512 sc1
M_gs1:
    v_max3_u32 v26, v163, v167, v171
    v_cmp_eq_u32_e64 vcc, -1, v26
    s_cbranch_vccz M_gs2
    s_add_u32 s4, s74, s59
    s_add_u32 s4, s4, 24576
    buffer_load_dwordx4 v[160:163], v252, s[24:27], s4 offen offset:0 sc1
    buffer_load_dwordx4 v[164:167], v252, s[24:27], s4 offen offset:256 sc1
    buffer_load_dwordx4 v[168:171], v253, s[24:27], s4 offen offset:512 sc1
M_gs2:
    v_max3_u32 v27, v175, v179, v183
    v_cmp_eq_u32_e64 vcc, -1, v27
    s_cbranch_vccz M_gs3
    s_add_u32 s4, s74, s59
    s_add_u32 s4, s4, 36864
    buffer_load_dwordx4 v[172:175], v252, s[24:27], s4 offen offset:0 sc1
    buffer_load_dwordx4 v[176:179], v252, s[24:27], s4 offen offset:256 sc1
    buffer_load_dwordx4 v[180:183], v253, s[24:27], s4 offen offset:512 sc1
M_gs3:
    s_add_u32 s75, s75, 1
    s_waitcnt vmcnt(0)
    v_max3_u32 v24, v139, v143, v147
    v_max3_u32 v25, v151, v155, v159
    v_max3_u32 v26, v163, v167, v171
    v_max3_u32 v27, v175, v179, v183
    v_max3_u32 v28, v24, v25, v26
    v_max_u32 v28, v28, v27
    v_cmp_eq_u32 vcc, -1, v28
    s_cmp_lt_u32 s75, 20000
    s_cbranch_scc0 M_gb
    s_cbranch_vccnz M_gr
    s_branch M_gb
M_pog:
    buffer_store_dwordx4 v[20:23], v2, s[24:27], s76 offen sc1
    buffer_store_dwordx2 v[24:25], v242, s[24:27], s77 offen sc1
    buffer_store_dwordx4 v[28:31], v0, s[24:27], s76 offen sc1
    buffer_store_dwordx2 v[32:33], v242, s[24:27], s5 offen sc1
    s_branch M_pob
M_o0r:
    s_waitcnt vmcnt(0)
    s_add_u32 s4, s77, 0
    buffer_load_dwordx4 v[96:99], v2, s[24:27], s4 offen offset:0 sc1
    v_cmp_eq_u32_e64 vcc, -1, v103
    s_cbranch_vccz M_o0s1
    s_add_u32 s4, s77, 0
    buffer_load_dwordx4 v[100:103], v2, s[24:27], s4 offen offset:1024 sc1
M_o0s1:
    v_cmp_eq_u32_e64 vcc, -1, v107
    s_cbranch_vccz M_o0s2
    s_add_u32 s4, s77, 0
    buffer_load_dwordx4 v[104:107], v2, s[24:27], s4 offen offset:2048 sc1
M_o0s2:
    v_cmp_eq_u32_e64 vcc, -1, v111
    s_cbranch_vccz M_o0s3
    s_add_u32 s4, s77, 0
    buffer_load_dwordx4 v[108:111], v2, s[24:27], s4 offen offset:3072 sc1
M_o0s3:
    v_cmp_eq_u32 vcc, -1, v115
    s_cbranch_vccz M_o0s4
    s_add_u32 s4, s77, 4096
    buffer_load_dwordx4 v[112:115], v2, s[24:27], s4 offen offset:0 sc1
M_o0s4:
    v_cmp_eq_u32 vcc, -1, v119
    s_cbranch_vccz M_o0s5
    s_add_u32 s4, s77, 4096
    buffer_load_dwordx4 v[116:119], v2, s[24:27], s4 offen offset:1024 sc1
M_o0s5:
    v_cmp_eq_u32 vcc, -1, v123
    s_cbranch_vccz M_o0s6
    s_add_u32 s4, s77, 4096
    buffer_load_dwordx4 v[120:123], v2, s[24:27], s4 offen offset:2048 sc1
M_o0s6:
    v_cmp_eq_u32 vcc, -1, v127
    s_cbranch_vccz M_o0s7
    s_add_u32 s4, s77, 4096
    buffer_load_dwordx4 v[124:127], v2, s[24:27], s4 offen offset:3072 sc1
M_o0s7:
    v_cmp_eq_u32 vcc, -1, v131
    s_cbranch_vccz M_o0s8
    s_add_u32 s4, s77, 8192
    buffer_load_dwordx4 v[128:131], v2, s[24:27], s4 offen offset:0 sc1
M_o0s8:
    v_cmp_eq_u32 vcc, -1, v135
    s_cbranch_vccz M_o0s9
    s_add_u32 s4, s77, 8192
    buffer_load_dwordx4 v[132:135], v2, s[24:27], s4 offen offset:1024 sc1
M_o0s9:
    v_cmp_eq_u32 vcc, -1, v139
    s_cbranch_vccz M_o0s10
    s_add_u32 s4, s77, 8192
    buffer_load_dwordx4 v[136:139], v2, s[24:27], s4 offen offset:2048 sc1
M_o0s10:
    v_cmp_eq_u32 vcc, -1, v143
    s_cbranch_vccz M_o0s11
    s_add_u32 s4, s77, 8192
    buffer_load_dwordx4 v[140:143], v2, s[24:27], s4 offen offset:3072 sc1
M_o0s11:
    s_add_u32 s75, s75, 1
    s_waitcnt vmcnt(0)
    v_cmp_eq_u32_e64 vcc, -1, v99
    s_cmp_lt_u32 s75, 20000
    s_cbranch_scc0 M_o0b
    s_cbranch_vccnz M_o0r
    s_branch M_o0b
M_o1r:
    s_waitcnt vmcnt(0)
    s_add_u32 s4, s77, 0
    buffer_load_dwordx4 v[100:103], v2, s[24:27], s4 offen offset:1024 sc1
    v_cmp_eq_u32 vcc, -1, v107
    s_cbranch_vccz M_o1s1
    s_add_u32 s4, s77, 0
    buffer_load_dwordx4 v[104:107], v2, s[24:27], s4 offen offset:2048 sc1
M_o1s1:
    v_cmp_eq_u32_e64 vcc, -1, v111
    s_cbranch_vccz M_o1s2
    s_add_u32 s4, s77, 0
    buffer_load_dwordx4 v[108:111], v2, s[24:27], s4 offen offset:3072 sc1
M_o1s2:
    v_cmp_eq_u32 vcc, -1, v115
    s_cbranch_vccz M_o1s3
    s_add_u32 s4, s77, 4096
    buffer_load_dwordx4 v[112:115], v2, s[24:27], s4 offen offset:0 sc1
M_o1s3:
    v_cmp_eq_u32 vcc, -1, v119
    s_cbranch_vccz M_o1s4
    s_add_u32 s4, s77, 4096
    buffer_load_dwordx4 v[116:119], v2, s[24:27], s4 offen offset:1024 sc1
M_o1s4:
    v_cmp_eq_u32 vcc, -1, v123
    s_cbranch_vccz M_o1s5
    s_add_u32 s4, s77, 4096
    buffer_load_dwordx4 v[120:123], v2, s[24:27], s4 offen offset:2048 sc1
M_o1s5:
    v_cmp_eq_u32 vcc, -1, v127
    s_cbranch_vccz M_o1s6
    s_add_u32 s4, s77, 4096
    buffer_load_dwordx4 v[124:127], v2, s[24:27], s4 offen offset:3072 sc1
M_o1s6:
    v_cmp_eq_u32 vcc, -1, v131
    s_cbranch_vccz M_o1s7
    s_add_u32 s4, s77, 8192
    buffer_load_dwordx4 v[128:131], v2, s[24:27], s4 offen offset:0 sc1
M_o1s7:
    v_cmp_eq_u32 vcc, -1, v135
    s_cbranch_vccz M_o1s8
    s_add_u32 s4, s77, 8192
    buffer_load_dwordx4 v[132:135], v2, s[24:27], s4 offen offset:1024 sc1
M_o1s8:
    v_cmp_eq_u32 vcc, -1, v139
    s_cbranch_vccz M_o1s9
    s_add_u32 s4, s77, 8192
    buffer_load_dwordx4 v[136:139], v2, s[24:27], s4 offen offset:2048 sc1
M_o1s9:
    v_cmp_eq_u32 vcc, -1, v143
    s_cbranch_vccz M_o1s10
    s_add_u32 s4, s77, 8192
    buffer_load_dwordx4 v[140:143], v2, s[24:27], s4 offen offset:3072 sc1
M_o1s10:
    v_cmp_eq_u32 vcc, -1, v147
    s_cbranch_vccz M_o1s11
    s_add_u32 s4, s77, 12288
    buffer_load_dwordx4 v[144:147], v2, s[24:27], s4 offen offset:0 sc1
M_o1s11:
    v_cmp_eq_u32 vcc, -1, v151
    s_cbranch_vccz M_o1s12
    s_add_u32 s4, s77, 12288
    buffer_load_dwordx4 v[148:151], v2, s[24:27], s4 offen offset:1024 sc1
M_o1s12:
    v_cmp_eq_u32 vcc, -1, v155
    s_cbranch_vccz M_o1s13
    s_add_u32 s4, s77, 12288
    buffer_load_dwordx4 v[152:155], v2, s[24:27], s4 offen offset:2048 sc1
M_o1s13:
    s_add_u32 s75, s75, 1
    s_waitcnt vmcnt(0)
    v_cmp_eq_u32_e64 vcc, -1, v103
    s_cmp_lt_u32 s75, 20000
    s_cbranch_scc0 M_o1b
    s_cbranch_vccnz M_o1r
    s_branch M_o1b
M_o2r:
    s_waitcnt vmcnt(0)
    s_add_u32 s4, s77, 0
    buffer_load_dwordx4 v[104:107], v2, s[24:27], s4 offen offset:2048 sc1
    v_cmp_eq_u32 vcc, -1, v111
    s_cbranch_vccz M_o2s1
    s_add_u32 s4, s77, 0
    buffer_load_dwordx4 v[108:111], v2, s[24:27], s4 offen offset:3072 sc1
M_o2s1:
    v_cmp_eq_u32 vcc, -1, v115
    s_cbranch_vccz M_o2s2
    s_add_u32 s4, s77, 4096
    buffer_load_dwordx4 v[112:115], v2, s[24:27], s4 offen offset:0 sc1
M_o2s2:
    v_cmp_eq_u32 vcc, -1, v119
    s_cbranch_vccz M_o2s3
    s_add_u32 s4, s77, 4096
    buffer_load_dwordx4 v[116:119], v2, s[24:27], s4 offen offset:1024 sc1
M_o2s3:
    v_cmp_eq_u32 vcc, -1, v123
    s_cbranch_vccz M_o2s4
    s_add_u32 s4, s77, 4096
    buffer_load_dwordx4 v[120:123], v2, s[24:27], s4 offen offset:2048 sc1
M_o2s4:
    v_cmp_eq_u32 vcc, -1, v127
    s_cbranch_vccz M_o2s5
    s_add_u32 s4, s77, 4096
    buffer_load_dwordx4 v[124:127], v2, s[24:27], s4 offen offset:3072 sc1
M_o2s5:
    v_cmp_eq_u32 vcc, -1, v131
    s_cbranch_vccz M_o2s6
    s_add_u32 s4, s77, 8192
    buffer_load_dwordx4 v[128:131], v2, s[24:27], s4 offen offset:0 sc1
M_o2s6:
    v_cmp_eq_u32 vcc, -1, v135
    s_cbranch_vccz M_o2s7
    s_add_u32 s4, s77, 8192
    buffer_load_dwordx4 v[132:135], v2, s[24:27], s4 offen offset:1024 sc1
M_o2s7:
    v_cmp_eq_u32 vcc, -1, v139
    s_cbranch_vccz M_o2s8
    s_add_u32 s4, s77, 8192
    buffer_load_dwordx4 v[136:139], v2, s[24:27], s4 offen offset:2048 sc1
M_o2s8:
    v_cmp_eq_u32 vcc, -1, v143
    s_cbranch_vccz M_o2s9
    s_add_u32 s4, s77, 8192
    buffer_load_dwordx4 v[140:143], v2, s[24:27], s4 offen offset:3072 sc1
M_o2s9:
    v_cmp_eq_u32 vcc, -1, v147
    s_cbranch_vccz M_o2s10
    s_add_u32 s4, s77, 12288
    buffer_load_dwordx4 v[144:147], v2, s[24:27], s4 offen offset:0 sc1
M_o2s10:
    v_cmp_eq_u32 vcc, -1, v151
    s_cbranch_vccz M_o2s11
    s_add_u32 s4, s77, 12288
    buffer_load_dwordx4 v[148:151], v2, s[24:27], s4 offen offset:1024 sc1
M_o2s11:
    v_cmp_eq_u32 vcc, -1, v155
    s_cbranch_vccz M_o2s12
    s_add_u32 s4, s77, 12288
    buffer_load_dwordx4 v[152:155], v2, s[24:27], s4 offen offset:2048 sc1
M_o2s12:
    v_cmp_eq_u32 vcc, -1, v159
    s_cbranch_vccz M_o2s13
    s_add_u32 s4, s77, 12288
    buffer_load_dwordx4 v[156:159], v2, s[24:27], s4 offen offset:3072 sc1
M_o2s13:
    v_max_u32 v16, v161, v163
    v_cmp_eq_u32_e64 vcc, -1, v16
    s_cbranch_vccz M_o2s14
    buffer_load_dwordx2 v[160:161], v251, s[24:27], s15 offen offset:0 sc1
    buffer_load_dwordx2 v[162:163], v251, s[24:27], s15 offen offset:128 sc1
M_o2s14:
    s_add_u32 s75, s75, 1
    s_waitcnt vmcnt(0)
    v_cmp_eq_u32_e64 vcc, -1, v107
    s_cmp_lt_u32 s75, 20000
    s_cbranch_scc0 M_o2b
    s_cbranch_vccnz M_o2r
    s_branch M_o2b
M_o3r:
    s_waitcnt vmcnt(0)
    s_add_u32 s4, s77, 0
    buffer_load_dwordx4 v[108:111], v2, s[24:27], s4 offen offset:3072 sc1
    v_cmp_eq_u32_e64 vcc, -1, v115
    s_cbranch_vccz M_o3s1
    s_add_u32 s4, s77, 4096
    buffer_load_dwordx4 v[112:115], v2, s[24:27], s4 offen offset:0 sc1
M_o3s1:
    v_cmp_eq_u32 vcc, -1, v119
    s_cbranch_vccz M_o3s2
    s_add_u32 s4, s77, 4096
    buffer_load_dwordx4 v[116:119], v2, s[24:27], s4 offen offset:1024 sc1
M_o3s2:
    v_cmp_eq_u32 vcc, -1, v123
    s_cbranch_vccz M_o3s3
    s_add_u32 s4, s77, 4096
    buffer_load_dwordx4 v[120:123], v2, s[24:27], s4 offen offset:2048 sc1
M_o3s3:
    v_cmp_eq_u32 vcc, -1, v127
    s_cbranch_vccz M_o3s4
    s_add_u32 s4, s77, 4096
    buffer_load_dwordx4 v[124:127], v2, s[24:27], s4 offen offset:3072 sc1
M_o3s4:
    v_cmp_eq_u32 vcc, -1, v131
    s_cbranch_vccz M_o3s5
    s_add_u32 s4, s77, 8192
    buffer_load_dwordx4 v[128:131], v2, s[24:27], s4 offen offset:0 sc1
M_o3s5:
    v_cmp_eq_u32 vcc, -1, v135
    s_cbranch_vccz M_o3s6
    s_add_u32 s4, s77, 8192
    buffer_load_dwordx4 v[132:135], v2, s[24:27], s4 offen offset:1024 sc1
M_o3s6:
    v_cmp_eq_u32 vcc, -1, v139
    s_cbranch_vccz M_o3s7
    s_add_u32 s4, s77, 8192
    buffer_load_dwordx4 v[136:139], v2, s[24:27], s4 offen offset:2048 sc1
M_o3s7:
    v_cmp_eq_u32 vcc, -1, v143
    s_cbranch_vccz M_o3s8
    s_add_u32 s4, s77, 8192
    buffer_load_dwordx4 v[140:143], v2, s[24:27], s4 offen offset:3072 sc1
M_o3s8:
    v_cmp_eq_u32 vcc, -1, v147
    s_cbranch_vccz M_o3s9
    s_add_u32 s4, s77, 12288
    buffer_load_dwordx4 v[144:147], v2, s[24:27], s4 offen offset:0 sc1
M_o3s9:
    v_cmp_eq_u32 vcc, -1, v151
    s_cbranch_vccz M_o3s10
    s_add_u32 s4, s77, 12288
    buffer_load_dwordx4 v[148:151], v2, s[24:27], s4 offen offset:1024 sc1
M_o3s10:
    v_cmp_eq_u32 vcc, -1, v155
    s_cbranch_vccz M_o3s11
    s_add_u32 s4, s77, 12288
    buffer_load_dwordx4 v[152:155], v2, s[24:27], s4 offen offset:2048 sc1
M_o3s11:
    v_cmp_eq_u32 vcc, -1, v159
    s_cbranch_vccz M_o3s12
    s_add_u32 s4, s77, 12288
    buffer_load_dwordx4 v[156:159], v2, s[24:27], s4 offen offset:3072 sc1
M_o3s12:
    v_max_u32 v16, v161, v163
    v_cmp_eq_u32_e64 vcc, -1, v16
    s_cbranch_vccz M_o3s13
    buffer_load_dwordx2 v[160:161], v251, s[24:27], s15 offen offset:0 sc1
    buffer_load_dwordx2 v[162:163], v251, s[24:27], s15 offen offset:128 sc1
M_o3s13:
    v_max_u32 v16, v165, v167
    v_cmp_eq_u32_e64 vcc, -1, v16
    s_cbranch_vccz M_o3s14
    buffer_load_dwordx2 v[164:165], v251, s[24:27], s15 offen offset:1024 sc1
    buffer_load_dwordx2 v[166:167], v251, s[24:27], s15 offen offset:1152 sc1
M_o3s14:
    s_add_u32 s75, s75, 1
    s_waitcnt vmcnt(0)
    v_cmp_eq_u32_e64 vcc, -1, v111
    s_cmp_lt_u32 s75, 20000
    s_cbranch_scc0 M_o3b
    s_cbranch_vccnz M_o3r
    s_branch M_o3b
M_o4r:
    s_waitcnt vmcnt(0)
    s_add_u32 s4, s77, 4096
    buffer_load_dwordx4 v[112:115], v2, s[24:27], s4 offen offset:0 sc1
    v_cmp_eq_u32 vcc, -1, v119
    s_cbranch_vccz M_o4s1
    s_add_u32 s4, s77, 4096
    buffer_load_dwordx4 v[116:119], v2, s[24:27], s4 offen offset:1024 sc1
M_o4s1:
    v_cmp_eq_u32 vcc, -1, v123
    s_cbranch_vccz M_o4s2
    s_add_u32 s4, s77, 4096
    buffer_load_dwordx4 v[120:123], v2, s[24:27], s4 offen offset:2048 sc1
M_o4s2:
    v_cmp_eq_u32 vcc, -1, v127
    s_cbranch_vccz M_o4s3
    s_add_u32 s4, s77, 4096
    buffer_load_dwordx4 v[124:127], v2, s[24:27], s4 offen offset:3072 sc1
M_o4s3:
    v_cmp_eq_u32 vcc, -1, v131
    s_cbranch_vccz M_o4s4
    s_add_u32 s4, s77, 8192
    buffer_load_dwordx4 v[128:131], v2, s[24:27], s4 offen offset:0 sc1
M_o4s4:
    v_cmp_eq_u32 vcc, -1, v135
    s_cbranch_vccz M_o4s5
    s_add_u32 s4, s77, 8192
    buffer_load_dwordx4 v[132:135], v2, s[24:27], s4 offen offset:1024 sc1
M_o4s5:
    v_cmp_eq_u32 vcc, -1, v139
    s_cbranch_vccz M_o4s6
    s_add_u32 s4, s77, 8192
    buffer_load_dwordx4 v[136:139], v2, s[24:27], s4 offen offset:2048 sc1
M_o4s6:
    v_cmp_eq_u32 vcc, -1, v143
    s_cbranch_vccz M_o4s7
    s_add_u32 s4, s77, 8192
    buffer_load_dwordx4 v[140:143], v2, s[24:27], s4 offen offset:3072 sc1
M_o4s7:
    v_cmp_eq_u32 vcc, -1, v147
    s_cbranch_vccz M_o4s8
    s_add_u32 s4, s77, 12288
    buffer_load_dwordx4 v[144:147], v2, s[24:27], s4 offen offset:0 sc1
M_o4s8:
    v_cmp_eq_u32 vcc, -1, v151
    s_cbranch_vccz M_o4s9
    s_add_u32 s4, s77, 12288
    buffer_load_dwordx4 v[148:151], v2, s[24:27], s4 offen offset:1024 sc1
M_o4s9:
    v_cmp_eq_u32 vcc, -1, v155
    s_cbranch_vccz M_o4s10
    s_add_u32 s4, s77, 12288
    buffer_load_dwordx4 v[152:155], v2, s[24:27], s4 offen offset:2048 sc1
M_o4s10:
    v_cmp_eq_u32 vcc, -1, v159
    s_cbranch_vccz M_o4s11
    s_add_u32 s4, s77, 12288
    buffer_load_dwordx4 v[156:159], v2, s[24:27], s4 offen offset:3072 sc1
M_o4s11:
    v_max_u32 v16, v161, v163
    v_cmp_eq_u32_e64 vcc, -1, v16
    s_cbranch_vccz M_o4s12
    buffer_load_dwordx2 v[160:161], v251, s[24:27], s15 offen offset:0 sc1
    buffer_load_dwordx2 v[162:163], v251, s[24:27], s15 offen offset:128 sc1
M_o4s12:
    v_max_u32 v16, v165, v167
    v_cmp_eq_u32_e64 vcc, -1, v16
    s_cbranch_vccz M_o4s13
    buffer_load_dwordx2 v[164:165], v251, s[24:27], s15 offen offset:1024 sc1
    buffer_load_dwordx2 v[166:167], v251, s[24:27], s15 offen offset:1152 sc1
M_o4s13:
    s_add_u32 s75, s75, 1
    s_waitcnt vmcnt(0)
    v_cmp_eq_u32_e64 vcc, -1, v115
    s_cmp_lt_u32 s75, 20000
    s_cbranch_scc0 M_o4b
    s_cbranch_vccnz M_o4r
    s_branch M_o4b
M_o5r:
    s_waitcnt vmcnt(0)
    s_add_u32 s4, s77, 4096
    buffer_load_dwordx4 v[116:119], v2, s[24:27], s4 offen offset:1024 sc1
    v_cmp_eq_u32 vcc, -1, v123
    s_cbranch_vccz M_o5s1
    s_add_u32 s4, s77, 4096
    buffer_load_dwordx4 v[120:123], v2, s[24:27], s4 offen offset:2048 sc1
M_o5s1:
    v_cmp_eq_u32 vcc, -1, v127
    s_cbranch_vccz M_o5s2
    s_add_u32 s4, s77, 4096
    buffer_load_dwordx4 v[124:127], v2, s[24:27], s4 offen offset:3072 sc1
M_o5s2:
    v_cmp_eq_u32 vcc, -1, v131
    s_cbranch_vccz M_o5s3
    s_add_u32 s4, s77, 8192
    buffer_load_dwordx4 v[128:131], v2, s[24:27], s4 offen offset:0 sc1
M_o5s3:
    v_cmp_eq_u32 vcc, -1, v135
    s_cbranch_vccz M_o5s4
    s_add_u32 s4, s77, 8192
    buffer_load_dwordx4 v[132:135], v2, s[24:27], s4 offen offset:1024 sc1
M_o5s4:
    v_cmp_eq_u32 vcc, -1, v139
    s_cbranch_vccz M_o5s5
    s_add_u32 s4, s77, 8192
    buffer_load_dwordx4 v[136:139], v2, s[24:27], s4 offen offset:2048 sc1
M_o5s5:
    v_cmp_eq_u32 vcc, -1, v143
    s_cbranch_vccz M_o5s6
    s_add_u32 s4, s77, 8192
    buffer_load_dwordx4 v[140:143], v2, s[24:27], s4 offen offset:3072 sc1
M_o5s6:
    v_cmp_eq_u32 vcc, -1, v147
    s_cbranch_vccz M_o5s7
    s_add_u32 s4, s77, 12288
    buffer_load_dwordx4 v[144:147], v2, s[24:27], s4 offen offset:0 sc1
M_o5s7:
    v_cmp_eq_u32 vcc, -1, v151
    s_cbranch_vccz M_o5s8
    s_add_u32 s4, s77, 12288
    buffer_load_dwordx4 v[148:151], v2, s[24:27], s4 offen offset:1024 sc1
M_o5s8:
    v_cmp_eq_u32 vcc, -1, v155
    s_cbranch_vccz M_o5s9
    s_add_u32 s4, s77, 12288
    buffer_load_dwordx4 v[152:155], v2, s[24:27], s4 offen offset:2048 sc1
M_o5s9:
    v_cmp_eq_u32 vcc, -1, v159
    s_cbranch_vccz M_o5s10
    s_add_u32 s4, s77, 12288
    buffer_load_dwordx4 v[156:159], v2, s[24:27], s4 offen offset:3072 sc1
M_o5s10:
    v_max_u32 v16, v161, v163
    v_cmp_eq_u32_e64 vcc, -1, v16
    s_cbranch_vccz M_o5s11
    buffer_load_dwordx2 v[160:161], v251, s[24:27], s15 offen offset:0 sc1
    buffer_load_dwordx2 v[162:163], v251, s[24:27], s15 offen offset:128 sc1
M_o5s11:
    v_max_u32 v16, v165, v167
    v_cmp_eq_u32_e64 vcc, -1, v16
    s_cbranch_vccz M_o5s12
    buffer_load_dwordx2 v[164:165], v251, s[24:27], s15 offen offset:1024 sc1
    buffer_load_dwordx2 v[166:167], v251, s[24:27], s15 offen offset:1152 sc1
M_o5s12:
    s_add_u32 s75, s75, 1
    s_waitcnt vmcnt(0)
    v_cmp_eq_u32_e64 vcc, -1, v119
    s_cmp_lt_u32 s75, 20000
    s_cbranch_scc0 M_o5b
    s_cbranch_vccnz M_o5r
    s_branch M_o5b
M_o6r:
    s_waitcnt vmcnt(0)
    s_add_u32 s4, s77, 4096
    buffer_load_dwordx4 v[120:123], v2, s[24:27], s4 offen offset:2048 sc1
    v_cmp_eq_u32 vcc, -1, v127
    s_cbranch_vccz M_o6s1
    s_add_u32 s4, s77, 4096
    buffer_load_dwordx4 v[124:127], v2, s[24:27], s4 offen offset:3072 sc1
M_o6s1:
    v_cmp_eq_u32 vcc, -1, v131
    s_cbranch_vccz M_o6s2
    s_add_u32 s4, s77, 8192
    buffer_load_dwordx4 v[128:131], v2, s[24:27], s4 offen offset:0 sc1
M_o6s2:
    v_cmp_eq_u32 vcc, -1, v135
    s_cbranch_vccz M_o6s3
    s_add_u32 s4, s77, 8192
    buffer_load_dwordx4 v[132:135], v2, s[24:27], s4 offen offset:1024 sc1
M_o6s3:
    v_cmp_eq_u32 vcc, -1, v139
    s_cbranch_vccz M_o6s4
    s_add_u32 s4, s77, 8192
    buffer_load_dwordx4 v[136:139], v2, s[24:27], s4 offen offset:2048 sc1
M_o6s4:
    v_cmp_eq_u32 vcc, -1, v143
    s_cbranch_vccz M_o6s5
    s_add_u32 s4, s77, 8192
    buffer_load_dwordx4 v[140:143], v2, s[24:27], s4 offen offset:3072 sc1
M_o6s5:
    v_cmp_eq_u32 vcc, -1, v147
    s_cbranch_vccz M_o6s6
    s_add_u32 s4, s77, 12288
    buffer_load_dwordx4 v[144:147], v2, s[24:27], s4 offen offset:0 sc1
M_o6s6:
    v_cmp_eq_u32 vcc, -1, v151
    s_cbranch_vccz M_o6s7
    s_add_u32 s4, s77, 12288
    buffer_load_dwordx4 v[148:151], v2, s[24:27], s4 offen offset:1024 sc1
M_o6s7:
    v_cmp_eq_u32 vcc, -1, v155
    s_cbranch_vccz M_o6s8
    s_add_u32 s4, s77, 12288
    buffer_load_dwordx4 v[152:155], v2, s[24:27], s4 offen offset:2048 sc1
M_o6s8:
    v_cmp_eq_u32 vcc, -1, v159
    s_cbranch_vccz M_o6s9
    s_add_u32 s4, s77, 12288
    buffer_load_dwordx4 v[156:159], v2, s[24:27], s4 offen offset:3072 sc1
M_o6s9:
    v_max_u32 v16, v161, v163
    v_cmp_eq_u32_e64 vcc, -1, v16
    s_cbranch_vccz M_o6s10
    buffer_load_dwordx2 v[160:161], v251, s[24:27], s15 offen offset:0 sc1
    buffer_load_dwordx2 v[162:163], v251, s[24:27], s15 offen offset:128 sc1
M_o6s10:
    v_max_u32 v16, v165, v167
    v_cmp_eq_u32_e64 vcc, -1, v16
    s_cbranch_vccz M_o6s11
    buffer_load_dwordx2 v[164:165], v251, s[24:27], s15 offen offset:1024 sc1
    buffer_load_dwordx2 v[166:167], v251, s[24:27], s15 offen offset:1152 sc1
M_o6s11:
    s_add_u32 s75, s75, 1
    s_waitcnt vmcnt(0)
    v_cmp_eq_u32_e64 vcc, -1, v123
    s_cmp_lt_u32 s75, 20000
    s_cbranch_scc0 M_o6b
    s_cbranch_vccnz M_o6r
    s_branch M_o6b
M_o7r:
    s_waitcnt vmcnt(0)
    s_add_u32 s4, s77, 4096
    buffer_load_dwordx4 v[124:127], v2, s[24:27], s4 offen offset:3072 sc1
    v_cmp_eq_u32 vcc, -1, v131
    s_cbranch_vccz M_o7s1
    s_add_u32 s4, s77, 8192
    buffer_load_dwordx4 v[128:131], v2, s[24:27], s4 offen offset:0 sc1
M_o7s1:
    v_cmp_eq_u32 vcc, -1, v135
    s_cbranch_vccz M_o7s2
    s_add_u32 s4, s77, 8192
    buffer_load_dwordx4 v[132:135], v2, s[24:27], s4 offen offset:1024 sc1
M_o7s2:
    v_cmp_eq_u32 vcc, -1, v139
    s_cbranch_vccz M_o7s3
    s_add_u32 s4, s77, 8192
    buffer_load_dwordx4 v[136:139], v2, s[24:27], s4 offen offset:2048 sc1
M_o7s3:
    v_cmp_eq_u32 vcc, -1, v143
    s_cbranch_vccz M_o7s4
    s_add_u32 s4, s77, 8192
    buffer_load_dwordx4 v[140:143], v2, s[24:27], s4 offen offset:3072 sc1
M_o7s4:
    v_cmp_eq_u32 vcc, -1, v147
    s_cbranch_vccz M_o7s5
    s_add_u32 s4, s77, 12288
    buffer_load_dwordx4 v[144:147], v2, s[24:27], s4 offen offset:0 sc1
M_o7s5:
    v_cmp_eq_u32 vcc, -1, v151
    s_cbranch_vccz M_o7s6
    s_add_u32 s4, s77, 12288
    buffer_load_dwordx4 v[148:151], v2, s[24:27], s4 offen offset:1024 sc1
M_o7s6:
    v_cmp_eq_u32 vcc, -1, v155
    s_cbranch_vccz M_o7s7
    s_add_u32 s4, s77, 12288
    buffer_load_dwordx4 v[152:155], v2, s[24:27], s4 offen offset:2048 sc1
M_o7s7:
    v_cmp_eq_u32 vcc, -1, v159
    s_cbranch_vccz M_o7s8
    s_add_u32 s4, s77, 12288
    buffer_load_dwordx4 v[156:159], v2, s[24:27], s4 offen offset:3072 sc1
M_o7s8:
    v_max_u32 v16, v161, v163
    v_cmp_eq_u32_e64 vcc, -1, v16
    s_cbranch_vccz M_o7s9
    buffer_load_dwordx2 v[160:161], v251, s[24:27], s15 offen offset:0 sc1
    buffer_load_dwordx2 v[162:163], v251, s[24:27], s15 offen offset:128 sc1
M_o7s9:
    v_max_u32 v16, v165, v167
    v_cmp_eq_u32_e64 vcc, -1, v16
    s_cbranch_vccz M_o7s10
    buffer_load_dwordx2 v[164:165], v251, s[24:27], s15 offen offset:1024 sc1
    buffer_load_dwordx2 v[166:167], v251, s[24:27], s15 offen offset:1152 sc1
M_o7s10:
    s_add_u32 s75, s75, 1
    s_waitcnt vmcnt(0)
    v_cmp_eq_u32_e64 vcc, -1, v127
    s_cmp_lt_u32 s75, 20000
    s_cbranch_scc0 M_o7b
    s_cbranch_vccnz M_o7r
    s_branch M_o7b
M_o8r:
    s_waitcnt vmcnt(0)
    s_add_u32 s4, s77, 8192
    buffer_load_dwordx4 v[128:131], v2, s[24:27], s4 offen offset:0 sc1
    v_cmp_eq_u32 vcc, -1, v135
    s_cbranch_vccz M_o8s1
    s_add_u32 s4, s77, 8192
    buffer_load_dwordx4 v[132:135], v2, s[24:27], s4 offen offset:1024 sc1
M_o8s1:
    v_cmp_eq_u32 vcc, -1, v139
    s_cbranch_vccz M_o8s2
    s_add_u32 s4, s77, 8192
    buffer_load_dwordx4 v[136:139], v2, s[24:27], s4 offen offset:2048 sc1
M_o8s2:
    v_cmp_eq_u32 vcc, -1, v143
    s_cbranch_vccz M_o8s3
    s_add_u32 s4, s77, 8192
    buffer_load_dwordx4 v[140:143], v2, s[24:27], s4 offen offset:3072 sc1
M_o8s3:
    v_cmp_eq_u32 vcc, -1, v147
    s_cbranch_vccz M_o8s4
    s_add_u32 s4, s77, 12288
    buffer_load_dwordx4 v[144:147], v2, s[24:27], s4 offen offset:0 sc1
M_o8s4:
    v_cmp_eq_u32 vcc, -1, v151
    s_cbranch_vccz M_o8s5
    s_add_u32 s4, s77, 12288
    buffer_load_dwordx4 v[148:151], v2, s[24:27], s4 offen offset:1024 sc1
M_o8s5:
    v_cmp_eq_u32 vcc, -1, v155
    s_cbranch_vccz M_o8s6
    s_add_u32 s4, s77, 12288
    buffer_load_dwordx4 v[152:155], v2, s[24:27], s4 offen offset:2048 sc1
M_o8s6:
    v_cmp_eq_u32 vcc, -1, v159
    s_cbranch_vccz M_o8s7
    s_add_u32 s4, s77, 12288
    buffer_load_dwordx4 v[156:159], v2, s[24:27], s4 offen offset:3072 sc1
M_o8s7:
    v_max_u32 v16, v161, v163
    v_cmp_eq_u32_e64 vcc, -1, v16
    s_cbranch_vccz M_o8s8
    buffer_load_dwordx2 v[160:161], v251, s[24:27], s15 offen offset:0 sc1
    buffer_load_dwordx2 v[162:163], v251, s[24:27], s15 offen offset:128 sc1
M_o8s8:
    v_max_u32 v16, v165, v167
    v_cmp_eq_u32_e64 vcc, -1, v16
    s_cbranch_vccz M_o8s9
    buffer_load_dwordx2 v[164:165], v251, s[24:27], s15 offen offset:1024 sc1
    buffer_load_dwordx2 v[166:167], v251, s[24:27], s15 offen offset:1152 sc1
M_o8s9:
    s_add_u32 s75, s75, 1
    s_waitcnt vmcnt(0)
    v_cmp_eq_u32_e64 vcc, -1, v131
    s_cmp_lt_u32 s75, 20000
    s_cbranch_scc0 M_o8b
    s_cbranch_vccnz M_o8r
    s_branch M_o8b
M_o9r:
    s_waitcnt vmcnt(0)
    s_add_u32 s4, s77, 8192
    buffer_load_dwordx4 v[132:135], v2, s[24:27], s4 offen offset:1024 sc1
    v_cmp_eq_u32 vcc, -1, v139
    s_cbranch_vccz M_o9s1
    s_add_u32 s4, s77, 8192
    buffer_load_dwordx4 v[136:139], v2, s[24:27], s4 offen offset:2048 sc1
M_o9s1:
    v_cmp_eq_u32 vcc, -1, v143
    s_cbranch_vccz M_o9s2
    s_add_u32 s4, s77, 8192
    buffer_load_dwordx4 v[140:143], v2, s[24:27], s4 offen offset:3072 sc1
M_o9s2:
    v_cmp_eq_u32 vcc, -1, v147
    s_cbranch_vccz M_o9s3
    s_add_u32 s4, s77, 12288
    buffer_load_dwordx4 v[144:147], v2, s[24:27], s4 offen offset:0 sc1
M_o9s3:
    v_cmp_eq_u32 vcc, -1, v151
    s_cbranch_vccz M_o9s4
    s_add_u32 s4, s77, 12288
    buffer_load_dwordx4 v[148:151], v2, s[24:27], s4 offen offset:1024 sc1
M_o9s4:
    v_cmp_eq_u32 vcc, -1, v155
    s_cbranch_vccz M_o9s5
    s_add_u32 s4, s77, 12288
    buffer_load_dwordx4 v[152:155], v2, s[24:27], s4 offen offset:2048 sc1
M_o9s5:
    v_cmp_eq_u32 vcc, -1, v159
    s_cbranch_vccz M_o9s6
    s_add_u32 s4, s77, 12288
    buffer_load_dwordx4 v[156:159], v2, s[24:27], s4 offen offset:3072 sc1
M_o9s6:
    v_max_u32 v16, v161, v163
    v_cmp_eq_u32_e64 vcc, -1, v16
    s_cbranch_vccz M_o9s7
    buffer_load_dwordx2 v[160:161], v251, s[24:27], s15 offen offset:0 sc1
    buffer_load_dwordx2 v[162:163], v251, s[24:27], s15 offen offset:128 sc1
M_o9s7:
    v_max_u32 v16, v165, v167
    v_cmp_eq_u32_e64 vcc, -1, v16
    s_cbranch_vccz M_o9s8
    buffer_load_dwordx2 v[164:165], v251, s[24:27], s15 offen offset:1024 sc1
    buffer_load_dwordx2 v[166:167], v251, s[24:27], s15 offen offset:1152 sc1
M_o9s8:
    s_add_u32 s75, s75, 1
    s_waitcnt vmcnt(0)
    v_cmp_eq_u32_e64 vcc, -1, v135
    s_cmp_lt_u32 s75, 20000
    s_cbranch_scc0 M_o9b
    s_cbranch_vccnz M_o9r
    s_branch M_o9b
M_o10r:
    s_waitcnt vmcnt(0)
    s_add_u32 s4, s77, 8192
    buffer_load_dwordx4 v[136:139], v2, s[24:27], s4 offen offset:2048 sc1
    v_cmp_eq_u32 vcc, -1, v143
    s_cbranch_vccz M_o10s1
    s_add_u32 s4, s77, 8192
    buffer_load_dwordx4 v[140:143], v2, s[24:27], s4 offen offset:3072 sc1
M_o10s1:
    v_cmp_eq_u32 vcc, -1, v147
    s_cbranch_vccz M_o10s2
    s_add_u32 s4, s77, 12288
    buffer_load_dwordx4 v[144:147], v2, s[24:27], s4 offen offset:0 sc1
M_o10s2:
    v_cmp_eq_u32 vcc, -1, v151
    s_cbranch_vccz M_o10s3
    s_add_u32 s4, s77, 12288
    buffer_load_dwordx4 v[148:151], v2, s[24:27], s4 offen offset:1024 sc1
M_o10s3:
    v_cmp_eq_u32 vcc, -1, v155
    s_cbranch_vccz M_o10s4
    s_add_u32 s4, s77, 12288
    buffer_load_dwordx4 v[152:155], v2, s[24:27], s4 offen offset:2048 sc1
M_o10s4:
    v_cmp_eq_u32 vcc, -1, v159
    s_cbranch_vccz M_o10s5
    s_add_u32 s4, s77, 12288
    buffer_load_dwordx4 v[156:159], v2, s[24:27], s4 offen offset:3072 sc1
M_o10s5:
    v_max_u32 v16, v161, v163
    v_cmp_eq_u32_e64 vcc, -1, v16
    s_cbranch_vccz M_o10s6
    buffer_load_dwordx2 v[160:161], v251, s[24:27], s15 offen offset:0 sc1
    buffer_load_dwordx2 v[162:163], v251, s[24:27], s15 offen offset:128 sc1
M_o10s6:
    v_max_u32 v16, v165, v167
    v_cmp_eq_u32_e64 vcc, -1, v16
    s_cbranch_vccz M_o10s7
    buffer_load_dwordx2 v[164:165], v251, s[24:27], s15 offen offset:1024 sc1
    buffer_load_dwordx2 v[166:167], v251, s[24:27], s15 offen offset:1152 sc1
M_o10s7:
    s_add_u32 s75, s75, 1
    s_waitcnt vmcnt(0)
    v_cmp_eq_u32_e64 vcc, -1, v139
    s_cmp_lt_u32 s75, 20000
    s_cbranch_scc0 M_o10b
    s_cbranch_vccnz M_o10r
    s_branch M_o10b
M_o11r:
    s_waitcnt vmcnt(0)
    s_add_u32 s4, s77, 8192
    buffer_load_dwordx4 v[140:143], v2, s[24:27], s4 offen offset:3072 sc1
    v_cmp_eq_u32 vcc, -1, v147
    s_cbranch_vccz M_o11s1
    s_add_u32 s4, s77, 12288
    buffer_load_dwordx4 v[144:147], v2, s[24:27], s4 offen offset:0 sc1
M_o11s1:
    v_cmp_eq_u32 vcc, -1, v151
    s_cbranch_vccz M_o11s2
    s_add_u32 s4, s77, 12288
    buffer_load_dwordx4 v[148:151], v2, s[24:27], s4 offen offset:1024 sc1
M_o11s2:
    v_cmp_eq_u32 vcc, -1, v155
    s_cbranch_vccz M_o11s3
    s_add_u32 s4, s77, 12288
    buffer_load_dwordx4 v[152:155], v2, s[24:27], s4 offen offset:2048 sc1
M_o11s3:
    v_cmp_eq_u32 vcc, -1, v159
    s_cbranch_vccz M_o11s4
    s_add_u32 s4, s77, 12288
    buffer_load_dwordx4 v[156:159], v2, s[24:27], s4 offen offset:3072 sc1
M_o11s4:
    v_max_u32 v16, v161, v163
    v_cmp_eq_u32_e64 vcc, -1, v16
    s_cbranch_vccz M_o11s5
    buffer_load_dwordx2 v[160:161], v251, s[24:27], s15 offen offset:0 sc1
    buffer_load_dwordx2 v[162:163], v251, s[24:27], s15 offen offset:128 sc1
M_o11s5:
    v_max_u32 v16, v165, v167
    v_cmp_eq_u32_e64 vcc, -1, v16
    s_cbranch_vccz M_o11s6
    buffer_load_dwordx2 v[164:165], v251, s[24:27], s15 offen offset:1024 sc1
    buffer_load_dwordx2 v[166:167], v251, s[24:27], s15 offen offset:1152 sc1
M_o11s6:
    s_add_u32 s75, s75, 1
    s_waitcnt vmcnt(0)
    v_cmp_eq_u32_e64 vcc, -1, v143
    s_cmp_lt_u32 s75, 20000
    s_cbranch_scc0 M_o11b
    s_cbranch_vccnz M_o11r
    s_branch M_o11b
M_o12r:
    s_waitcnt vmcnt(0)
    s_add_u32 s4, s77, 12288
    buffer_load_dwordx4 v[144:147], v2, s[24:27], s4 offen offset:0 sc1
    v_cmp_eq_u32 vcc, -1, v151
    s_cbranch_vccz M_o12s1
    s_add_u32 s4, s77, 12288
    buffer_load_dwordx4 v[148:151], v2, s[24:27], s4 offen offset:1024 sc1
M_o12s1:
    v_cmp_eq_u32 vcc, -1, v155
    s_cbranch_vccz M_o12s2
    s_add_u32 s4, s77, 12288
    buffer_load_dwordx4 v[152:155], v2, s[24:27], s4 offen offset:2048 sc1
M_o12s2:
    v_cmp_eq_u32 vcc, -1, v159
    s_cbranch_vccz M_o12s3
    s_add_u32 s4, s77, 12288
    buffer_load_dwordx4 v[156:159], v2, s[24:27], s4 offen offset:3072 sc1
M_o12s3:
    v_max_u32 v16, v161, v163
    v_cmp_eq_u32_e64 vcc, -1, v16
    s_cbranch_vccz M_o12s4
    buffer_load_dwordx2 v[160:161], v251, s[24:27], s15 offen offset:0 sc1
    buffer_load_dwordx2 v[162:163], v251, s[24:27], s15 offen offset:128 sc1
M_o12s4:
    v_max_u32 v16, v165, v167
    v_cmp_eq_u32_e64 vcc, -1, v16
    s_cbranch_vccz M_o12s5
    buffer_load_dwordx2 v[164:165], v251, s[24:27], s15 offen offset:1024 sc1
    buffer_load_dwordx2 v[166:167], v251, s[24:27], s15 offen offset:1152 sc1
M_o12s5:
    s_add_u32 s75, s75, 1
    s_waitcnt vmcnt(0)
    v_cmp_eq_u32_e64 vcc, -1, v147
    s_cmp_lt_u32 s75, 20000
    s_cbranch_scc0 M_o12b
    s_cbranch_vccnz M_o12r
    s_branch M_o12b
M_o13r:
    s_waitcnt vmcnt(0)
    s_add_u32 s4, s77, 12288
    buffer_load_dwordx4 v[148:151], v2, s[24:27], s4 offen offset:1024 sc1
    v_cmp_eq_u32 vcc, -1, v155
    s_cbranch_vccz M_o13s1
    s_add_u32 s4, s77, 12288
    buffer_load_dwordx4 v[152:155], v2, s[24:27], s4 offen offset:2048 sc1
M_o13s1:
    v_cmp_eq_u32 vcc, -1, v159
    s_cbranch_vccz M_o13s2
    s_add_u32 s4, s77, 12288
    buffer_load_dwordx4 v[156:159], v2, s[24:27], s4 offen offset:3072 sc1
M_o13s2:
    v_max_u32 v16, v161, v163
    v_cmp_eq_u32_e64 vcc, -1, v16
    s_cbranch_vccz M_o13s3
    buffer_load_dwordx2 v[160:161], v251, s[24:27], s15 offen offset:0 sc1
    buffer_load_dwordx2 v[162:163], v251, s[24:27], s15 offen offset:128 sc1
M_o13s3:
    v_max_u32 v16, v165, v167
    v_cmp_eq_u32_e64 vcc, -1, v16
    s_cbranch_vccz M_o13s4
    buffer_load_dwordx2 v[164:165], v251, s[24:27], s15 offen offset:1024 sc1
    buffer_load_dwordx2 v[166:167], v251, s[24:27], s15 offen offset:1152 sc1
M_o13s4:
    s_add_u32 s75, s75, 1
    s_waitcnt vmcnt(0)
    v_cmp_eq_u32_e64 vcc, -1, v151
    s_cmp_lt_u32 s75, 20000
    s_cbranch_scc0 M_o13b
    s_cbranch_vccnz M_o13r
    s_branch M_o13b
M_o14r:
    s_waitcnt vmcnt(0)
    s_add_u32 s4, s77, 12288
    buffer_load_dwordx4 v[152:155], v2, s[24:27], s4 offen offset:2048 sc1
    v_cmp_eq_u32 vcc, -1, v159
    s_cbranch_vccz M_o14s1
    s_add_u32 s4, s77, 12288
    buffer_load_dwordx4 v[156:159], v2, s[24:27], s4 offen offset:3072 sc1
M_o14s1:
    v_max_u32 v16, v161, v163
    v_cmp_eq_u32_e64 vcc, -1, v16
    s_cbranch_vccz M_o14s2
    buffer_load_dwordx2 v[160:161], v251, s[24:27], s15 offen offset:0 sc1
    buffer_load_dwordx2 v[162:163], v251, s[24:27], s15 offen offset:128 sc1
M_o14s2:
    v_max_u32 v16, v165, v167
    v_cmp_eq_u32_e64 vcc, -1, v16
    s_cbranch_vccz M_o14s3
    buffer_load_dwordx2 v[164:165], v251, s[24:27], s15 offen offset:1024 sc1
    buffer_load_dwordx2 v[166:167], v251, s[24:27], s15 offen offset:1152 sc1
M_o14s3:
    s_add_u32 s75, s75, 1
    s_waitcnt vmcnt(0)
    v_cmp_eq_u32_e64 vcc, -1, v155
    s_cmp_lt_u32 s75, 20000
    s_cbranch_scc0 M_o14b
    s_cbranch_vccnz M_o14r
    s_branch M_o14b
M_o15r:
    s_waitcnt vmcnt(0)
    s_add_u32 s4, s77, 12288
    buffer_load_dwordx4 v[156:159], v2, s[24:27], s4 offen offset:3072 sc1
    v_max_u32 v16, v161, v163
    v_cmp_eq_u32_e64 vcc, -1, v16
    s_cbranch_vccz M_o15s1
    buffer_load_dwordx2 v[160:161], v251, s[24:27], s15 offen offset:0 sc1
    buffer_load_dwordx2 v[162:163], v251, s[24:27], s15 offen offset:128 sc1
M_o15s1:
    v_max_u32 v16, v165, v167
    v_cmp_eq_u32_e64 vcc, -1, v16
    s_cbranch_vccz M_o15s2
    buffer_load_dwordx2 v[164:165], v251, s[24:27], s15 offen offset:1024 sc1
    buffer_load_dwordx2 v[166:167], v251, s[24:27], s15 offen offset:1152 sc1
M_o15s2:
    s_add_u32 s75, s75, 1
    s_waitcnt vmcnt(0)
    v_cmp_eq_u32_e64 vcc, -1, v159
    s_cmp_lt_u32 s75, 20000
    s_cbranch_scc0 M_o15b
    s_cbranch_vccnz M_o15r
    s_branch M_o15b
M_o16r:
    s_waitcnt vmcnt(0)
    buffer_load_dwordx2 v[160:161], v251, s[24:27], s15 offen offset:0 sc1
    buffer_load_dwordx2 v[162:163], v251, s[24:27], s15 offen offset:128 sc1
    v_max_u32 v16, v165, v167
    v_cmp_eq_u32_e64 vcc, -1, v16
    s_cbranch_vccz M_o16s1
    buffer_load_dwordx2 v[164:165], v251, s[24:27], s15 offen offset:1024 sc1
    buffer_load_dwordx2 v[166:167], v251, s[24:27], s15 offen offset:1152 sc1
M_o16s1:
    s_add_u32 s75, s75, 1
    s_waitcnt vmcnt(0)
    v_max_u32 v16, v161, v163
    v_cmp_eq_u32 vcc, -1, v16
    s_cmp_lt_u32 s75, 20000
    s_cbranch_scc0 M_o16b
    s_cbranch_vccnz M_o16r
    s_branch M_o16b
M_o17r:
    s_waitcnt vmcnt(0)
    buffer_load_dwordx2 v[164:165], v251, s[24:27], s15 offen offset:1024 sc1
    buffer_load_dwordx2 v[166:167], v251, s[24:27], s15 offen offset:1152 sc1
    s_add_u32 s75, s75, 1
    s_waitcnt vmcnt(0)
    v_max_u32 v16, v165, v167
    v_cmp_eq_u32 vcc, -1, v16
    s_cmp_lt_u32 s75, 20000
    s_cbranch_scc0 M_o17b
    s_cbranch_vccnz M_o17r
    s_branch M_o17b
M_yretry:
    buffer_load_dwordx4 v[168:171], v246, s[24:27], s49 offen sc1
    s_add_u32 s4, s49, 0x8000
    buffer_load_dwordx4 v[172:175], v246, s[24:27], s4 offen sc1
    s_add_u32 s4, s49, 0x10000
    buffer_load_dwordx4 v[176:179], v247, s[24:27], s4 offen sc1
    s_add_u32 s76, s76, 1
    s_waitcnt vmcnt(0)
    v_max3_u32 v16, v168, v172, v176
    v_cmp_eq_u32 vcc, -1, v16
    s_cmp_lt_u32 s76, 20000
    s_cbranch_scc0 M_ygo
    s_cbranch_vccnz M_yretry
M_ygo:
    v_mfma_f32_16x16x32_bf16 v[96:99], v[168:171], a[20:23], 0
    v_mfma_f32_16x16x32_bf16 v[100:103], v[168:171], a[24:27], 0
    v_mfma_f32_16x16x32_bf16 v[104:107], v[172:175], a[20:23], 0
    v_mfma_f32_16x16x32_bf16 v[108:111], v[172:175], a[24:27], 0
    v_mfma_f32_16x16x32_bf16 v[112:115], v[176:179], a[20:23], 0
    s_nop 7
    s_nop 3
    s_branch M_yok
M_ps0g:
    buffer_store_dwordx2 v[18:19], v248, s[24:27], s15 offen sc1
    s_branch M_ps0b
M_sr0:
    s_mov_b32 s4, s50
    s_nop 0
    buffer_load_dwordx2 v[152:153], v248, s[24:27], s4 offen offset:0 sc1
    buffer_load_dwordx2 v[154:155], v248, s[24:27], s4 offen offset:2048 sc1
    s_add_u32 s4, s4, 4096
    buffer_load_dwordx2 v[156:157], v248, s[24:27], s4 offen offset:0 sc1
    buffer_load_dwordx2 v[158:159], v248, s[24:27], s4 offen offset:2048 sc1
    s_add_u32 s4, s4, 4096
    buffer_load_dwordx2 v[160:161], v248, s[24:27], s4 offen offset:0 sc1
    buffer_load_dwordx2 v[162:163], v248, s[24:27], s4 offen offset:2048 sc1
    s_add_u32 s4, s4, 4096
    buffer_load_dwordx2 v[164:165], v248, s[24:27], s4 offen offset:0 sc1
    buffer_load_dwordx2 v[166:167], v248, s[24:27], s4 offen offset:2048 sc1
    s_add_u32 s75, s75, 1
    s_waitcnt vmcnt(0)
    v_pk_add_f32 v[152:153], v[152:153], v[160:161]
    v_pk_add_f32 v[154:155], v[154:155], v[162:163]
    v_pk_add_f32 v[156:157], v[156:157], v[164:165]
    v_pk_add_f32 v[158:159], v[158:159], v[166:167]
    v_pk_add_f32 v[152:153], v[152:153], v[154:155]
    v_pk_add_f32 v[156:157], v[156:157], v[158:159]
    v_pk_add_f32 v[152:153], v[152:153], v[156:157]
    v_cmp_u_f32 vcc, v152, v153
    v_mov_b32 v136, v152
    v_mov_b32 v137, v153
    v_mov_b32 v138, v152
    v_mov_b32_e64 v139, v153
    s_cmp_lt_u32 s75, 20000
    s_cbranch_scc0 M_sb0
    s_cbranch_vccnz M_sr0
    s_branch M_sb0
M_pxg:
    buffer_store_dwordx4 v[28:31], v244, s[24:27], s71 offen sc1
    buffer_store_dwordx4 v[32:35], v244, s[24:27], s71 offen offset:256 sc1
    buffer_store_dword v36, v245, s[24:27], s72 offen sc1
    s_branch M_pxb
M_ps1g:
    buffer_store_dwordx2 v[18:19], v20, s[24:27], s15 offen sc1
    s_branch M_ps1b
M_sr1:
    s_mov_b32 s4, s50
    buffer_load_dwordx2 v[152:153], v21, s[24:27], s4 offen offset:0 sc1
    buffer_load_dwordx2 v[154:155], v21, s[24:27], s4 offen offset:2048 sc1
    s_add_u32 s4, s4, 4096
    buffer_load_dwordx2 v[156:157], v21, s[24:27], s4 offen offset:0 sc1
    buffer_load_dwordx2 v[158:159], v21, s[24:27], s4 offen offset:2048 sc1
    s_add_u32 s4, s4, 4096
    buffer_load_dwordx2 v[160:161], v21, s[24:27], s4 offen offset:0 sc1
    buffer_load_dwordx2 v[162:163], v21, s[24:27], s4 offen offset:2048 sc1
    s_add_u32 s4, s4, 4096
    buffer_load_dwordx2 v[164:165], v21, s[24:27], s4 offen offset:0 sc1
    buffer_load_dwordx2 v[166:167], v21, s[24:27], s4 offen offset:2048 sc1
    s_add_u32 s75, s75, 1
    s_waitcnt vmcnt(0)
    v_pk_add_f32 v[152:153], v[152:153], v[160:161]
    v_pk_add_f32 v[154:155], v[154:155], v[162:163]
    v_pk_add_f32 v[156:157], v[156:157], v[164:165]
    v_pk_add_f32 v[158:159], v[158:159], v[166:167]
    v_pk_add_f32 v[152:153], v[152:153], v[154:155]
    v_pk_add_f32 v[156:157], v[156:157], v[158:159]
    v_pk_add_f32 v[152:153], v[152:153], v[156:157]
    v_cmp_u_f32_e64 vcc, v152, v153
    v_mul_f32 v16, 0x3ae38e39, v152
    v_mul_f32 v17, 0x3ae38e39, v153
    v_fma_f32 v17, -v16, v16, v17
    v_max_f32_e64 v17, 0, v17
    v_add_f32 v17, 0x3727c5ac, v17
    v_rsq_f32 v18, v17
    s_nop 0
    v_mul_f32 v19, -v18, v16
    s_cmp_lt_u32 s75, 20000
    s_cbranch_scc0 M_sb1
    s_cbranch_vccnz M_sr1
    s_branch M_sb1
M_end:
    s_endpgm

.section .rodata,"a"
.p2align 6
.amdhsa_kernel interleave_layers__linear_kernel_hedgehog__ssm_conv_h3__prompt_kernel
  .amdhsa_next_free_vgpr 508
  .amdhsa_next_free_sgpr 102
  .amdhsa_accum_offset 256
  .amdhsa_group_segment_fixed_size 0
  .amdhsa_kernarg_size 104
  .amdhsa_user_sgpr_count 2
  .amdhsa_user_sgpr_kernarg_segment_ptr 1
  .amdhsa_system_sgpr_workgroup_id_x 1
.end_amdhsa_kernel
```
